```python
import torch

def _softmax(x, axis=-1):
    return torch.softmax(x, dim=axis)

def _gelu(x):
    return torch.nn.functional.gelu(x, approximate='tanh')

def _silu(x):
    return torch.nn.functional.silu(x)

def _sigmoid(x):
    return torch.sigmoid(x)

def _layernorm(x, axis=-1, eps=1e-05):
    m = x.mean(dim=axis, keepdim=True)
    v = x.var(dim=axis, keepdim=True, unbiased=False)
    return (x - m) / torch.sqrt(v + eps)

def _scatter_add(tgt, idx, src, axis=0):
    return tgt.clone().index_add_(axis, idx, src)

def _segment_sum(src, seg, n):
    out = torch.zeros((n,) + src.shape[1:], dtype=src.dtype)
    return out.index_add_(0, seg, src)

def _pad(x, pw):
    flat = tuple((v for pair in reversed(pw) for v in pair))
    return torch.nn.functional.pad(x, flat)
kernel_name = 'gather_scatter__molecular_angular_painn__graph'

def setup_inputs():

    _w = lambda a: (lambda t: t.to(torch.bfloat16) if t.is_floating_point() else t)(torch.as_tensor(a))
    N, deg, D = (12500, 64, 64)
    n_rbf = max(16, 4)
    E = N * deg
    cutoff = 5.0
    freqs = (torch.arange(1, n_rbf + 1) * torch.pi / cutoff).to(float)
    return {'sv': _w((lambda *s: torch.randn(*s, dtype=torch.bfloat16) * 0.4)(N, 4, D) * 0.3), 'pos': _w((lambda *s: torch.randn(*s, dtype=torch.bfloat16) * 0.8)(N, 3) * 1.2), 'src': _w((lambda lo, hi, *s: torch.randint(lo, hi, s))(0, N, E).to(torch.int64)), 'dst': _w((lambda lo, hi, *s: torch.randint(lo, hi, s))(0, N, E).to(torch.int64)), 'freqs': _w(freqs), 'w_phi1': _w((lambda *s: torch.randn(*s, dtype=torch.bfloat16) * 3.2)(D, D) / D ** 0.5), 'w_phi2': _w((lambda *s: torch.randn(*s, dtype=torch.bfloat16) * 0.8)(D, 3 * D) / D ** 0.5), 'w_rbf': _w((lambda *s: torch.randn(*s, dtype=torch.bfloat16) * 0.8)(n_rbf, 3 * D) / n_rbf ** 0.5)}

def reference(sv, pos, src, dst, freqs, w_phi1, w_phi2, w_rbf):
    N, _, D = sv.shape
    E = src.shape[0]
    PI, cutoff = (3.141592653589793, 5.0)
    s, v = (sv[:, 0, :].clone(), sv[:, 1:, :].clone())
    r_vec = pos[src] - pos[dst]
    d = torch.sqrt((r_vec * r_vec).sum(-1) + 1e-08)
    r_hat = r_vec / d[:, None]
    rbf = torch.sin(d[:, None] * freqs[None, :]) / d[:, None]
    fcut = 0.5 * (torch.cos(PI * d / cutoff) + 1.0)
    fcut = torch.where(d < cutoff, fcut, 0.0 * d)
    Wf = rbf @ w_rbf * fcut[:, None]
    phi = (_silu(s @ w_phi1) @ w_phi2)[src]
    m = phi * Wf
    m_s, m_vv, m_vr = (m[:, :D].clone(), m[:, D:2 * D].clone(), m[:, 2 * D:].clone())
    ds = _segment_sum(m_s, dst, N)
    dv_e = m_vv[:, None, :] * v[src] + m_vr[:, None, :] * r_hat[:, :, None]
    dv = _segment_sum(dv_e.reshape(E, 3 * D), dst, N).reshape(N, 3, D)
    return sv + torch.concatenate([ds[:, None, :], dv], axis=1)
```

```asm
; @launch grid=(256,1,1) block=(512,1,1) lds=163776
.amdgcn_target "amdgcn-amd-amdhsa--gfx950"
.text
.globl gather_scatter__molecular_angular_painn__graph_kernel
.p2align 8
.type gather_scatter__molecular_angular_painn__graph_kernel,@function
gather_scatter__molecular_angular_painn__graph_kernel:
  s_cmp_ge_u32 s2, 256
  s_cbranch_scc1 K2_exit
  s_load_dwordx2 s[4:5], s[0:1], 0
  s_load_dwordx2 s[10:11], s[0:1], 8
  s_load_dwordx2 s[6:7], s[0:1], 64
  s_load_dwordx2 s[8:9], s[0:1], 80
  s_load_dwordx4 s[64:67], s[0:1], 16
  s_load_dwordx4 s[68:71], s[0:1], 40
  s_load_dwordx2 s[72:73], s[0:1], 32
  s_load_dwordx2 s[74:75], s[0:1], 56
  s_load_dwordx2 s[76:77], s[0:1], 72
  v_lshrrev_b32 v10, 6, v0
  v_and_b32 v11, 63, v0
  v_readfirstlane_b32 s40, v10
  v_mov_b32 v29, 0
  v_lshlrev_b32 v2, 2, v0
  v_mov_b32 v3, 0
  v_add_u32 v2, 106144, v2
  v_cmp_gt_u32 vcc, 256, v0
  s_nop 1
  s_and_saveexec_b64 s[80:81], vcc
  ds_write_b32 v2, v3
  s_mov_b64 exec, s[80:81]
  s_mul_i32 s80, s2, 12544
  v_lshlrev_b32 v1, 4, v0
  v_add_u32 v1, s80, v1
  v_add_u32 v62, 0x2000, v1
  s_waitcnt lgkmcnt(0)
  s_mov_b32 s12, s66
  s_mov_b32 s13, s67
  s_mov_b32 s14, 0x30d400
  s_mov_b32 s15, 0x20000
  s_mov_b32 s16, s64
  s_mov_b32 s17, s65
  s_mov_b32 s18, 0x30d400
  s_mov_b32 s19, 0x20000
  buffer_load_dwordx4 v[4:7], v1, s[12:15], 0 offen
  buffer_load_dwordx4 v[20:23], v62, s[12:15], 0 offen
  buffer_load_dwordx4 v[16:19], v1, s[16:19], 0 offen
  buffer_load_dwordx4 v[84:87], v62, s[16:19], 0 offen
  s_mov_b32 s36, s76
  s_mov_b32 s37, s77
  s_mov_b32 s38, 0x100
  s_mov_b32 s39, 0x20000
  s_mov_b32 s20, s4
  s_mov_b32 s21, s5
  s_mov_b32 s22, 0x61a800
  s_mov_b32 s23, 0x20000
  s_mov_b32 s32, s10
  s_mov_b32 s33, s11
  s_mov_b32 s34, 0x124f8
  s_mov_b32 s35, 0x20000
  s_or_b32 s80, s2, s40
  s_cmp_lg_u32 s80, 0
  s_cbranch_scc1 FA_nononce
  s_memrealtime s[82:83]
  s_waitcnt lgkmcnt(0)
  s_or_b32 s82, s82, 1
  v_mov_b32 v24, s82
  v_mov_b32 v25, 0
  s_mov_b64 exec, 1
  buffer_store_dword v24, v25, s[36:39], 0 offen sc1
  s_mov_b64 exec, -1
FA_nononce:
  s_cmp_lt_u32 s2, 196
  s_cselect_b32 s97, 1, 0
  s_cmp_eq_u32 s97, 0
  s_cbranch_scc1 FA_in_done
  s_cmp_lt_u32 s40, 4
  s_cbranch_scc1 FA_in_done
  s_mov_b32 s44, s68
  s_mov_b32 s45, s69
  s_mov_b32 s46, 0x2000
  s_mov_b32 s47, 0x20000
  s_mov_b32 s48, s70
  s_mov_b32 s49, s71
  s_mov_b32 s50, 0x6000
  s_mov_b32 s51, 0x20000
  s_sub_u32 s86, s40, 4
  s_lshl_b32 s87, s2, 6
  s_lshl_b32 s85, s86, 4
  s_add_u32 s98, s87, s85
  v_and_b32 v92, 15, v11
  v_lshrrev_b32 v93, 4, v11
  v_add_u32 v94, s98, v92
  v_lshlrev_b32 v94, 9, v94
  v_lshl_add_u32 v95, v93, 4, v94
  v_lshl_add_u32 v94, v93, 5, v94
  buffer_load_dwordx4 v[96:99], v95, s[20:23], 0 offen
  buffer_load_dwordx4 v[100:103], v95, s[20:23], 0 offen offset:64
  buffer_load_dwordx4 v[104:107], v94, s[20:23], 0 offen offset:128
  buffer_load_dwordx4 v[108:111], v94, s[20:23], 0 offen offset:144
  buffer_load_dwordx4 v[112:115], v94, s[20:23], 0 offen offset:256
  buffer_load_dwordx4 v[116:119], v94, s[20:23], 0 offen offset:272
  buffer_load_dwordx4 v[120:123], v94, s[20:23], 0 offen offset:384
  buffer_load_dwordx4 v[124:127], v94, s[20:23], 0 offen offset:400
  v_add_u32 v90, 0xffffff00, v0
  v_lshlrev_b32 v91, 4, v90
  v_lshrrev_b32 v89, 3, v90
  v_mul_u32_u24 v89, 384, v89
  v_and_b32 v88, 7, v90
  v_lshlrev_b32 v88, 4, v88
  v_add3_u32 v89, v89, v88, 64
  v_add_u32 v89, 64, v89
  s_lshl_b32 s85, s86, 10
  s_add_u32 s85, s85, 77472
  s_mov_b32 m0, s85
  s_movk_i32 s84, 0x1000
  buffer_load_dwordx4 v91, s[44:47], 0 offen lds
  s_add_u32 s85, s85, 4096
  s_mov_b32 m0, s85
  s_add_u32 s85, s85, 4096
  buffer_load_dwordx4 v91, s[44:47], s84 offen lds
  s_mov_b32 m0, s85
  s_movk_i32 s84, 0x3000
  buffer_load_dwordx4 v89, s[48:51], 0 offen lds
  s_add_u32 s85, s85, 4096
  s_mov_b32 m0, s85
  s_nop 0
  buffer_load_dwordx4 v89, s[48:51], s84 offen lds
FA_in_done:
  v_lshlrev_b32 v15, 4, v11
  s_lshl_b32 s81, s40, 10
  s_add_u32 s82, s81, 1600
  s_mov_b32 m0, s82
  s_add_u32 s82, s82, 8192
  buffer_load_dwordx4 v15, s[32:35], s81 offen lds
  s_add_u32 s81, s81, 8192
  s_mov_b32 m0, s82
  s_add_u32 s82, s82, 8192
  buffer_load_dwordx4 v15, s[32:35], s81 offen lds
  s_add_u32 s81, s81, 8192
  s_mov_b32 m0, s82
  s_add_u32 s82, s82, 8192
  buffer_load_dwordx4 v15, s[32:35], s81 offen lds
  s_add_u32 s81, s81, 8192
  s_mov_b32 m0, s82
  s_add_u32 s82, s82, 8192
  buffer_load_dwordx4 v15, s[32:35], s81 offen lds
  s_add_u32 s81, s81, 8192
  s_mov_b32 m0, s82
  s_add_u32 s82, s82, 8192
  buffer_load_dwordx4 v15, s[32:35], s81 offen lds
  s_add_u32 s81, s81, 8192
  s_mov_b32 m0, s82
  s_add_u32 s82, s82, 8192
  buffer_load_dwordx4 v15, s[32:35], s81 offen lds
  s_add_u32 s81, s81, 8192
  s_mov_b32 m0, s82
  s_add_u32 s82, s82, 8192
  buffer_load_dwordx4 v15, s[32:35], s81 offen lds
  s_add_u32 s81, s81, 8192
  s_mov_b32 m0, s82
  s_add_u32 s82, s82, 8192
  buffer_load_dwordx4 v15, s[32:35], s81 offen lds
  s_add_u32 s81, s81, 8192
  s_mov_b32 m0, s82
  s_add_u32 s82, s82, 8192
  buffer_load_dwordx4 v15, s[32:35], s81 offen lds
  s_add_u32 s81, s81, 8192
  s_cmp_ge_u32 s40, 2
  s_cbranch_scc1 K2_posdone1
  s_mov_b32 m0, s82
  s_add_u32 s82, s82, 8192
  buffer_load_dwordx4 v15, s[32:35], s81 offen lds
  s_add_u32 s81, s81, 8192
K2_posdone1:
  s_add_u32 s24, s8, 0x800000
  s_addc_u32 s25, s9, 0
  s_mov_b32 s26, 0x400000
  s_mov_b32 s27, 0x20000
  s_add_u32 s28, s8, 0x700000
  s_addc_u32 s29, s9, 0
  s_mov_b32 s30, 0x80000
  s_mov_b32 s31, 0x20000
  s_mov_b32 s80, 3200000
  v_cmp_gt_u32 s[60:61], s80, v1
  v_cmp_gt_u32 s[62:63], s80, v62
  v_cmp_gt_u32 vcc, 272, v0
  s_nop 1
  s_and_b64 s[62:63], s[62:63], vcc
  v_mov_b32 v61, 1
  s_mov_b32 s81, -49
  s_mov_b32 s82, 106144
  s_barrier
  s_waitcnt vmcnt(9)
  v_mul_u32_u24 v24, 42800, v4
  v_lshrrev_b32 v24, 21, v24
  v_lshl_add_u32 v40, v24, 2, s82
  v_mul_u32_u24 v25, 42800, v5
  v_lshrrev_b32 v25, 21, v25
  v_lshl_add_u32 v41, v25, 2, s82
  v_mul_u32_u24 v26, 42800, v6
  v_lshrrev_b32 v26, 21, v26
  v_lshl_add_u32 v42, v26, 2, s82
  v_mul_u32_u24 v27, 42800, v7
  v_lshrrev_b32 v27, 21, v27
  v_lshl_add_u32 v43, v27, 2, s82
  v_mul_u32_u24 v28, 42800, v20
  v_lshrrev_b32 v28, 21, v28
  v_lshl_add_u32 v44, v28, 2, s82
  v_mul_u32_u24 v29, 42800, v21
  v_lshrrev_b32 v29, 21, v29
  v_lshl_add_u32 v45, v29, 2, s82
  v_mul_u32_u24 v30, 42800, v22
  v_lshrrev_b32 v30, 21, v30
  v_lshl_add_u32 v46, v30, 2, s82
  v_mul_u32_u24 v31, 42800, v23
  v_lshrrev_b32 v31, 21, v31
  v_lshl_add_u32 v47, v31, 2, s82
  s_mov_b64 exec, s[60:61]
  ds_add_rtn_u32 v48, v40, v61
  ds_add_rtn_u32 v49, v41, v61
  ds_add_rtn_u32 v50, v42, v61
  ds_add_rtn_u32 v51, v43, v61
  s_mov_b64 exec, s[62:63]
  ds_add_rtn_u32 v52, v44, v61
  ds_add_rtn_u32 v53, v45, v61
  ds_add_rtn_u32 v54, v46, v61
  ds_add_rtn_u32 v55, v47, v61
  s_mov_b64 exec, -1
  v_mad_i32_i24 v32, v24, s81, v4
  v_lshl_or_b32 v32, v16, 8, v32
  v_mad_i32_i24 v33, v25, s81, v5
  v_lshl_or_b32 v33, v17, 8, v33
  v_mad_i32_i24 v34, v26, s81, v6
  v_lshl_or_b32 v34, v18, 8, v34
  v_mad_i32_i24 v35, v27, s81, v7
  v_lshl_or_b32 v35, v19, 8, v35
  v_mad_i32_i24 v36, v28, s81, v20
  v_lshl_or_b32 v36, v84, 8, v36
  v_mad_i32_i24 v37, v29, s81, v21
  v_lshl_or_b32 v37, v85, 8, v37
  v_mad_i32_i24 v38, v30, s81, v22
  v_lshl_or_b32 v38, v86, 8, v38
  v_mad_i32_i24 v39, v31, s81, v23
  v_lshl_or_b32 v39, v87, 8, v39
  s_cmp_lg_u32 s40, 7
  s_cbranch_scc1 FA_nopollnonce
  s_mov_b32 s83, 0
  v_mov_b32 v63, 0
FA_pollnonce:
  buffer_load_dword v64, v63, s[36:39], 0 offen sc1
  s_waitcnt vmcnt(0)
  v_readfirstlane_b32 s84, v64
  s_nop 1
  s_cmp_lg_u32 s84, 0
  s_cbranch_scc1 FA_gotnonce
  s_sleep 2
  s_add_u32 s83, s83, 1
  s_cmp_lt_u32 s83, 131072
  s_cbranch_scc1 FA_pollnonce
FA_gotnonce:
  ds_write_b32 v63, v64 offset:520
  ds_write_b32 v63, v63 offset:524
FA_nopollnonce:
  s_waitcnt lgkmcnt(0)
  s_barrier
  v_mov_b32 v63, 0
  ds_read_b32 v64, v63 offset:520
  s_cmp_lg_u32 s40, 0
  s_cbranch_scc1 FA_scan_done
  v_lshlrev_b32 v66, 4, v11
  v_add_u32 v66, 106144, v66
  ds_read_b128 v[68:71], v66
  s_waitcnt lgkmcnt(0)
  v_add_u32 v57, v68, v69
  v_add_u32 v58, v57, v70
  v_add_u32 v59, v58, v71
  v_mov_b32 v56, v59
  s_nop 1
  v_add_u32_dpp v56, v56, v56 row_shr:1 row_mask:0xf bank_mask:0xf bound_ctrl:0
  s_nop 1
  v_add_u32_dpp v56, v56, v56 row_shr:2 row_mask:0xf bank_mask:0xf bound_ctrl:0
  s_nop 1
  v_add_u32_dpp v56, v56, v56 row_shr:4 row_mask:0xf bank_mask:0xf bound_ctrl:0
  s_nop 1
  v_add_u32_dpp v56, v56, v56 row_shr:8 row_mask:0xf bank_mask:0xf bound_ctrl:0
  s_nop 1
  v_add_u32_dpp v56, v56, v56 row_bcast:15 row_mask:0xa bank_mask:0xf
  s_nop 1
  v_add_u32_dpp v56, v56, v56 row_bcast:31 row_mask:0xc bank_mask:0xf
  v_sub_u32 v72, v56, v59
  v_add_u32 v73, v72, v68
  v_add_u32 v74, v72, v57
  v_add_u32 v75, v72, v58
  ds_write_b128 v66, v[72:75] offset:1024
  v_lshl_or_b32 v76, v68, 16, v72
  v_lshl_or_b32 v77, v69, 16, v73
  v_lshl_or_b32 v78, v70, 16, v74
  v_lshl_or_b32 v79, v71, 16, v75
  s_lshl_b32 s83, s2, 10
  v_lshlrev_b32 v63, 4, v11
  v_add_u32 v63, s83, v63
  buffer_store_dwordx4 v[76:79], v63, s[28:31], 0 offen sc1
FA_scan_done:
  s_waitcnt lgkmcnt(0)
  v_readfirstlane_b32 s96, v64
  s_barrier
  ds_read_b32 v24, v40 offset:1024
  ds_read_b32 v25, v41 offset:1024
  ds_read_b32 v26, v42 offset:1024
  ds_read_b32 v27, v43 offset:1024
  ds_read_b32 v28, v44 offset:1024
  ds_read_b32 v29, v45 offset:1024
  ds_read_b32 v30, v46 offset:1024
  ds_read_b32 v31, v47 offset:1024
  s_waitcnt lgkmcnt(0)
  s_mov_b32 s82, 108192
  v_add_u32 v24, v24, v48
  v_lshl_add_u32 v24, v24, 2, s82
  v_add_u32 v25, v25, v49
  v_lshl_add_u32 v25, v25, 2, s82
  v_add_u32 v26, v26, v50
  v_lshl_add_u32 v26, v26, 2, s82
  v_add_u32 v27, v27, v51
  v_lshl_add_u32 v27, v27, 2, s82
  v_add_u32 v28, v28, v52
  v_lshl_add_u32 v28, v28, 2, s82
  v_add_u32 v29, v29, v53
  v_lshl_add_u32 v29, v29, 2, s82
  v_add_u32 v30, v30, v54
  v_lshl_add_u32 v30, v30, 2, s82
  v_add_u32 v31, v31, v55
  v_lshl_add_u32 v31, v31, 2, s82
  s_mov_b64 exec, s[60:61]
  ds_write_b32 v24, v32
  ds_write_b32 v25, v33
  ds_write_b32 v26, v34
  ds_write_b32 v27, v35
  s_mov_b64 exec, s[62:63]
  ds_write_b32 v28, v36
  ds_write_b32 v29, v37
  ds_write_b32 v30, v38
  ds_write_b32 v31, v39
  s_mov_b64 exec, -1
  s_waitcnt lgkmcnt(0)
  s_barrier
  v_lshlrev_b32 v2, 4, v0
  v_add_u32 v3, 108192, v2
  ds_read_b128 v[4:7], v3
  ds_read_b128 v[16:19], v3 offset:8192
  s_lshl_b32 s80, s2, 14
  v_add_u32 v2, s80, v2
  v_add_u32 v3, 0x2000, v2
  s_waitcnt lgkmcnt(1)
  buffer_store_dwordx4 v[4:7], v2, s[24:27], 0 offen sc1
  s_waitcnt lgkmcnt(0)
  v_cmp_gt_u32 vcc, 272, v0
  s_nop 1
  s_and_saveexec_b64 s[82:83], vcc
  s_cbranch_execz FA_nost2
  buffer_store_dwordx4 v[16:19], v3, s[24:27], 0 offen sc1
FA_nost2:
  s_mov_b64 exec, s[82:83]
  s_waitcnt vmcnt(0)
  s_barrier
  s_and_b32 s59, s2, 7
  s_lshl_b32 s59, s59, 5
  s_lshr_b32 s80, s2, 3
  s_add_u32 s59, s59, s80
  s_cmp_ge_u32 s40, 4
  s_cbranch_scc1 FA_notw0
  s_cmp_lg_u32 s40, 0
  s_cbranch_scc1 FA_join
  s_add_u32 s44, s8, 0x7c0000
  s_addc_u32 s45, s9, 0
  s_mov_b32 s46, 0x4000
  s_mov_b32 s47, 0x20000
  v_mov_b32 v4, s96
  v_mov_b32 v5, s96
  s_lshl_b32 s80, s2, 3
  v_and_b32 v6, 63, v0
  v_lshlrev_b32 v6, 11, v6
  v_add_u32 v6, s80, v6
  s_mov_b64 exec, 0xff
  buffer_store_dwordx2 v[4:5], v6, s[44:47], 0 offen sc1
  s_mov_b64 exec, -1
  s_and_b32 s80, s2, 7
  s_lshl_b32 s80, s80, 11
  v_lshlrev_b32 v63, 5, v11
  v_add_u32 v63, s80, v63
  s_mov_b32 s81, 0
POLL_rdy:
  buffer_load_dwordx4 v[32:35], v63, s[44:47], 0 offen sc1
  buffer_load_dwordx4 v[36:39], v63, s[44:47], 0 offen offset:16 sc1
POLLCHK_rdy:
  s_waitcnt vmcnt(0)
  v_cmp_eq_u32 vcc, s96, v33
  v_cmp_eq_u32 s[82:83], s96, v35
  s_nop 1
  s_and_b64 vcc, vcc, s[82:83]
  v_cmp_eq_u32 s[82:83], s96, v37
  s_nop 1
  s_and_b64 vcc, vcc, s[82:83]
  v_cmp_eq_u32 s[82:83], s96, v39
  s_nop 1
  s_and_b64 vcc, vcc, s[82:83]
  s_cmp_eq_u64 vcc, -1
  s_cbranch_scc1 POLLOK_rdy
  s_sleep 1
  s_add_u32 s81, s81, 1
  s_cmp_lt_u32 s81, 131072
  s_cbranch_scc1 POLL_rdy
POLLOK_rdy:
  s_lshl_b32 s80, s59, 2
  v_lshlrev_b32 v63, 12, v11
  v_add_u32 v63, s80, v63
  buffer_load_dword v32, v63, s[28:31], 0 offen offset:0 sc1
  buffer_load_dword v33, v63, s[28:31], 0 offen offset:1024 sc1
  buffer_load_dword v34, v63, s[28:31], 0 offen offset:2048 sc1
  buffer_load_dword v35, v63, s[28:31], 0 offen offset:3072 sc1
  v_lshlrev_b32 v62, 4, v11
  s_add_u32 s44, s8, 0x780000
  s_addc_u32 s45, s9, 0
  s_mov_b32 s46, 0x4000
  s_mov_b32 s47, 0x20000
  s_and_b32 s48, s2, 7
  s_lshl_b32 s48, s48, 11
  v_lshlrev_b32 v63, 5, v11
  v_add_u32 v63, s48, v63
  buffer_load_dwordx4 v[40:43], v63, s[44:47], 0 offen sc1
  buffer_load_dwordx4 v[44:47], v63, s[44:47], 0 offen offset:16 sc1
  s_mov_b32 s49, 0
  s_branch POLLCHK_donel
POLL_donel:
  buffer_load_dwordx4 v[40:43], v63, s[44:47], 0 offen sc1
  buffer_load_dwordx4 v[44:47], v63, s[44:47], 0 offen offset:16 sc1
POLLCHK_donel:
  s_waitcnt vmcnt(0)
  v_cmp_eq_u32 vcc, s96, v41
  v_cmp_eq_u32 s[50:51], s96, v43
  s_nop 1
  s_and_b64 vcc, vcc, s[50:51]
  v_cmp_eq_u32 s[50:51], s96, v45
  s_nop 1
  s_and_b64 vcc, vcc, s[50:51]
  v_cmp_eq_u32 s[50:51], s96, v47
  s_nop 1
  s_and_b64 vcc, vcc, s[50:51]
  s_or_b32 vcc_lo, vcc_lo, -1
  s_or_b32 vcc_hi, vcc_hi, 0x1ffff
  s_cmp_eq_u64 vcc, -1
  s_cbranch_scc1 POLLOK_donel
  s_sleep 1
  s_add_u32 s49, s49, 1
  s_cmp_lt_u32 s49, 131072
  s_cbranch_scc1 POLL_donel
POLLOK_donel:
  ds_write_b128 v62, v[32:35] offset:576
  s_branch FA_join
FA_notw0:
  s_cmp_eq_u32 s97, 0
  s_cbranch_scc1 FA_tables
  v_and_b32 v2, 15, v11
  v_lshrrev_b32 v3, 4, v11
  v_lshrrev_b32 v92, 2, v11
  v_and_b32 v92, 3, v92
  v_and_b32 v93, 3, v11
  v_lshlrev_b32 v93, 5, v93
  v_lshl_add_u32 v94, v3, 3, v92
  v_lshl_add_u32 v94, v94, 7, v93
  v_add_u32 v94, 77472, v94
  v_lshl_add_u32 v95, v3, 4, v92
  v_lshl_add_u32 v95, v95, 7, v93
  v_add_u32 v95, 85664, v95
  ds_read_b64_tr_b16 v[4:5], v94 offset:0
  ds_read_b64_tr_b16 v[6:7], v94 offset:512
  ds_read_b64_tr_b16 v[8:9], v94 offset:4096
  ds_read_b64_tr_b16 v[10:11], v94 offset:4608
  ds_read_b64_tr_b16 v[12:13], v94 offset:8
  ds_read_b64_tr_b16 v[14:15], v94 offset:520
  ds_read_b64_tr_b16 v[16:17], v94 offset:4104
  ds_read_b64_tr_b16 v[18:19], v94 offset:4616
  ds_read_b64_tr_b16 v[20:21], v94 offset:16
  ds_read_b64_tr_b16 v[22:23], v94 offset:528
  ds_read_b64_tr_b16 v[24:25], v94 offset:4112
  ds_read_b64_tr_b16 v[26:27], v94 offset:4624
  ds_read_b64_tr_b16 v[28:29], v94 offset:24
  ds_read_b64_tr_b16 v[30:31], v94 offset:536
  ds_read_b64_tr_b16 v[32:33], v94 offset:4120
  ds_read_b64_tr_b16 v[34:35], v94 offset:4632
  s_waitcnt lgkmcnt(8)
  v_mfma_f32_16x16x32_bf16 v[68:71], v[4:7], v[96:99], 0
  v_mfma_f32_16x16x32_bf16 v[68:71], v[8:11], v[100:103], v[68:71]
  v_mfma_f32_16x16x32_bf16 v[72:75], v[12:15], v[96:99], 0
  v_mfma_f32_16x16x32_bf16 v[72:75], v[16:19], v[100:103], v[72:75]
  s_waitcnt lgkmcnt(0)
  v_mfma_f32_16x16x32_bf16 v[76:79], v[20:23], v[96:99], 0
  v_mfma_f32_16x16x32_bf16 v[76:79], v[24:27], v[100:103], v[76:79]
  v_mfma_f32_16x16x32_bf16 v[80:83], v[28:31], v[96:99], 0
  v_mfma_f32_16x16x32_bf16 v[80:83], v[32:35], v[100:103], v[80:83]
  ds_read_b64_tr_b16 v[36:37], v95 offset:0
  ds_read_b64_tr_b16 v[38:39], v95 offset:512
  ds_read_b64_tr_b16 v[40:41], v95 offset:1024
  ds_read_b64_tr_b16 v[42:43], v95 offset:1536
  ds_read_b64_tr_b16 v[44:45], v95 offset:8
  ds_read_b64_tr_b16 v[46:47], v95 offset:520
  ds_read_b64_tr_b16 v[48:49], v95 offset:1032
  ds_read_b64_tr_b16 v[50:51], v95 offset:1544
  ds_read_b64_tr_b16 v[52:53], v95 offset:16
  ds_read_b64_tr_b16 v[54:55], v95 offset:528
  ds_read_b64_tr_b16 v[56:57], v95 offset:1040
  ds_read_b64_tr_b16 v[58:59], v95 offset:1552
  ds_read_b64_tr_b16 v[60:61], v95 offset:24
  ds_read_b64_tr_b16 v[62:63], v95 offset:536
  ds_read_b64_tr_b16 v[64:65], v95 offset:1048
  ds_read_b64_tr_b16 v[66:67], v95 offset:1560
  s_mov_b32 s80, 0xbfb8aa3b
  v_cvt_pk_bf16_f32 v68, 0, v68
  v_cvt_pk_bf16_f32 v69, 0, v69
  v_cvt_pk_bf16_f32 v70, 0, v70
  v_cvt_pk_bf16_f32 v71, 0, v71
  v_cvt_pk_bf16_f32 v72, 0, v72
  v_cvt_pk_bf16_f32 v73, 0, v73
  v_cvt_pk_bf16_f32 v74, 0, v74
  v_cvt_pk_bf16_f32 v75, 0, v75
  v_cvt_pk_bf16_f32 v76, 0, v76
  v_cvt_pk_bf16_f32 v77, 0, v77
  v_cvt_pk_bf16_f32 v78, 0, v78
  v_cvt_pk_bf16_f32 v79, 0, v79
  v_cvt_pk_bf16_f32 v80, 0, v80
  v_cvt_pk_bf16_f32 v81, 0, v81
  v_cvt_pk_bf16_f32 v82, 0, v82
  v_cvt_pk_bf16_f32 v83, 0, v83
  v_mul_f32 v4, s80, v68
  v_mul_f32 v5, s80, v69
  v_mul_f32 v6, s80, v70
  v_mul_f32 v7, s80, v71
  v_mul_f32 v8, s80, v72
  v_mul_f32 v9, s80, v73
  v_mul_f32 v10, s80, v74
  v_mul_f32 v11, s80, v75
  v_mul_f32 v12, s80, v76
  v_mul_f32 v13, s80, v77
  v_mul_f32 v14, s80, v78
  v_mul_f32 v15, s80, v79
  v_mul_f32 v16, s80, v80
  v_mul_f32 v17, s80, v81
  v_mul_f32 v18, s80, v82
  v_mul_f32 v19, s80, v83
  v_exp_f32 v4, v4
  v_exp_f32 v5, v5
  v_exp_f32 v6, v6
  v_exp_f32 v7, v7
  v_exp_f32 v8, v8
  v_exp_f32 v9, v9
  v_exp_f32 v10, v10
  v_exp_f32 v11, v11
  v_exp_f32 v12, v12
  v_exp_f32 v13, v13
  v_exp_f32 v14, v14
  v_exp_f32 v15, v15
  v_exp_f32 v16, v16
  v_exp_f32 v17, v17
  v_exp_f32 v18, v18
  v_exp_f32 v19, v19
  v_add_f32 v4, 1.0, v4
  v_add_f32 v5, 1.0, v5
  v_add_f32 v6, 1.0, v6
  v_add_f32 v7, 1.0, v7
  v_add_f32 v8, 1.0, v8
  v_add_f32 v9, 1.0, v9
  v_add_f32 v10, 1.0, v10
  v_add_f32 v11, 1.0, v11
  v_add_f32 v12, 1.0, v12
  v_add_f32 v13, 1.0, v13
  v_add_f32 v14, 1.0, v14
  v_add_f32 v15, 1.0, v15
  v_add_f32 v16, 1.0, v16
  v_add_f32 v17, 1.0, v17
  v_add_f32 v18, 1.0, v18
  v_add_f32 v19, 1.0, v19
  v_rcp_f32 v4, v4
  v_rcp_f32 v5, v5
  v_rcp_f32 v6, v6
  v_rcp_f32 v7, v7
  v_rcp_f32 v8, v8
  v_rcp_f32 v9, v9
  v_rcp_f32 v10, v10
  v_rcp_f32 v11, v11
  v_rcp_f32 v12, v12
  v_rcp_f32 v13, v13
  v_rcp_f32 v14, v14
  v_rcp_f32 v15, v15
  v_rcp_f32 v16, v16
  v_rcp_f32 v17, v17
  v_rcp_f32 v18, v18
  v_rcp_f32 v19, v19
  v_mul_f32 v4, v68, v4
  v_mul_f32 v5, v69, v5
  v_mul_f32 v6, v70, v6
  v_mul_f32 v7, v71, v7
  v_mul_f32 v8, v72, v8
  v_mul_f32 v9, v73, v9
  v_mul_f32 v10, v74, v10
  v_mul_f32 v11, v75, v11
  v_mul_f32 v12, v76, v12
  v_mul_f32 v13, v77, v13
  v_mul_f32 v14, v78, v14
  v_mul_f32 v15, v79, v15
  v_mul_f32 v16, v80, v16
  v_mul_f32 v17, v81, v17
  v_mul_f32 v18, v82, v18
  v_mul_f32 v19, v83, v19
  v_cvt_pk_bf16_f32 v84, v4, v5
  v_cvt_pk_bf16_f32 v85, v6, v7
  v_cvt_pk_bf16_f32 v86, v8, v9
  v_cvt_pk_bf16_f32 v87, v10, v11
  v_cvt_pk_bf16_f32 v88, v12, v13
  v_cvt_pk_bf16_f32 v89, v14, v15
  v_cvt_pk_bf16_f32 v90, v16, v17
  v_cvt_pk_bf16_f32 v91, v18, v19
  s_waitcnt lgkmcnt(0)
  v_mfma_f32_16x16x32_bf16 v[68:71], v[36:39], v[84:87], 0
  v_mfma_f32_16x16x32_bf16 v[68:71], v[40:43], v[88:91], v[68:71]
  v_mfma_f32_16x16x32_bf16 v[72:75], v[44:47], v[84:87], 0
  v_mfma_f32_16x16x32_bf16 v[72:75], v[48:51], v[88:91], v[72:75]
  v_mfma_f32_16x16x32_bf16 v[76:79], v[52:55], v[84:87], 0
  v_mfma_f32_16x16x32_bf16 v[76:79], v[56:59], v[88:91], v[76:79]
  v_mfma_f32_16x16x32_bf16 v[80:83], v[60:63], v[84:87], 0
  v_mfma_f32_16x16x32_bf16 v[80:83], v[64:67], v[88:91], v[80:83]
  s_sub_u32 s81, s40, 4
  s_lshl_b32 s81, s81, 12
  s_add_u32 s81, s81, 131232
  v_lshlrev_b32 v92, 4, v2
  v_lshl_add_u32 v93, v2, 8, s81
  v_lshl_add_u32 v20, v3, 6, 0
  v_xor_b32 v20, v20, v92
  v_add_u32 v20, v20, v93
  v_lshl_add_u32 v21, v3, 6, 16
  v_xor_b32 v21, v21, v92
  v_add_u32 v21, v21, v93
  v_lshl_add_u32 v22, v3, 6, 32
  v_xor_b32 v22, v22, v92
  v_add_u32 v22, v22, v93
  v_lshl_add_u32 v23, v3, 6, 48
  v_xor_b32 v23, v23, v92
  v_add_u32 v23, v23, v93
  v_add_u32 v24, 0, v3
  v_lshlrev_b32 v28, 4, v24
  v_xor_b32 v28, v28, v92
  v_lshl_add_u32 v24, v24, 8, v28
  v_add_u32 v24, s81, v24
  v_add_u32 v25, 4, v3
  v_lshlrev_b32 v28, 4, v25
  v_xor_b32 v28, v28, v92
  v_lshl_add_u32 v25, v25, 8, v28
  v_add_u32 v25, s81, v25
  v_add_u32 v26, 8, v3
  v_lshlrev_b32 v28, 4, v26
  v_xor_b32 v28, v28, v92
  v_lshl_add_u32 v26, v26, 8, v28
  v_add_u32 v26, s81, v26
  v_add_u32 v27, 12, v3
  v_lshlrev_b32 v28, 4, v27
  v_xor_b32 v28, v28, v92
  v_lshl_add_u32 v27, v27, 8, v28
  v_add_u32 v27, s81, v27
  s_lshl_b32 s82, s98, 8
  v_lshl_add_u32 v29, v3, 8, v92
  v_add_u32 v29, s82, v29
  v_cvt_pk_bf16_f32 v68, 0, v68
  v_cvt_pk_bf16_f32 v69, 0, v69
  v_cvt_pk_bf16_f32 v70, 0, v70
  v_cvt_pk_bf16_f32 v71, 0, v71
  v_cvt_pk_bf16_f32 v72, 0, v72
  v_cvt_pk_bf16_f32 v73, 0, v73
  v_cvt_pk_bf16_f32 v74, 0, v74
  v_cvt_pk_bf16_f32 v75, 0, v75
  v_cvt_pk_bf16_f32 v76, 0, v76
  v_cvt_pk_bf16_f32 v77, 0, v77
  v_cvt_pk_bf16_f32 v78, 0, v78
  v_cvt_pk_bf16_f32 v79, 0, v79
  v_cvt_pk_bf16_f32 v80, 0, v80
  v_cvt_pk_bf16_f32 v81, 0, v81
  v_cvt_pk_bf16_f32 v82, 0, v82
  v_cvt_pk_bf16_f32 v83, 0, v83
  v_mov_b32 v36, v84
  v_mov_b32 v37, v85
  v_mov_b32 v40, v86
  v_mov_b32 v41, v87
  v_mov_b32 v44, v88
  v_mov_b32 v45, v89
  v_mov_b32 v48, v90
  v_mov_b32 v49, v91
  v_lshlrev_b32 v4, 16, v104
  v_and_b32 v5, 0xffff0000, v104
  v_lshlrev_b32 v6, 16, v105
  v_and_b32 v7, 0xffff0000, v105
  v_mul_f32 v4, v4, v68
  v_mul_f32 v5, v5, v69
  v_mul_f32 v6, v6, v70
  v_mul_f32 v7, v7, v71
  v_cvt_pk_bf16_f32 v38, v4, v5
  v_cvt_pk_bf16_f32 v39, v6, v7
  v_lshlrev_b32 v8, 16, v106
  v_and_b32 v9, 0xffff0000, v106
  v_lshlrev_b32 v10, 16, v107
  v_and_b32 v11, 0xffff0000, v107
  v_mul_f32 v8, v8, v72
  v_mul_f32 v9, v9, v73
  v_mul_f32 v10, v10, v74
  v_mul_f32 v11, v11, v75
  v_cvt_pk_bf16_f32 v42, v8, v9
  v_cvt_pk_bf16_f32 v43, v10, v11
  v_lshlrev_b32 v4, 16, v108
  v_and_b32 v5, 0xffff0000, v108
  v_lshlrev_b32 v6, 16, v109
  v_and_b32 v7, 0xffff0000, v109
  v_mul_f32 v4, v4, v76
  v_mul_f32 v5, v5, v77
  v_mul_f32 v6, v6, v78
  v_mul_f32 v7, v7, v79
  v_cvt_pk_bf16_f32 v46, v4, v5
  v_cvt_pk_bf16_f32 v47, v6, v7
  v_lshlrev_b32 v8, 16, v110
  v_and_b32 v9, 0xffff0000, v110
  v_lshlrev_b32 v10, 16, v111
  v_and_b32 v11, 0xffff0000, v111
  v_mul_f32 v8, v8, v80
  v_mul_f32 v9, v9, v81
  v_mul_f32 v10, v10, v82
  v_mul_f32 v11, v11, v83
  v_cvt_pk_bf16_f32 v50, v8, v9
  v_cvt_pk_bf16_f32 v51, v10, v11
  ds_write_b128 v20, v[36:39]
  ds_write_b128 v21, v[40:43]
  ds_write_b128 v22, v[44:47]
  ds_write_b128 v23, v[48:51]
  v_lshlrev_b32 v4, 16, v112
  v_and_b32 v5, 0xffff0000, v112
  v_lshlrev_b32 v6, 16, v113
  v_and_b32 v7, 0xffff0000, v113
  v_mul_f32 v4, v4, v68
  v_mul_f32 v5, v5, v69
  v_mul_f32 v6, v6, v70
  v_mul_f32 v7, v7, v71
  v_cvt_pk_bf16_f32 v52, v4, v5
  v_cvt_pk_bf16_f32 v53, v6, v7
  v_lshlrev_b32 v8, 16, v114
  v_and_b32 v9, 0xffff0000, v114
  v_lshlrev_b32 v10, 16, v115
  v_and_b32 v11, 0xffff0000, v115
  v_mul_f32 v8, v8, v72
  v_mul_f32 v9, v9, v73
  v_mul_f32 v10, v10, v74
  v_mul_f32 v11, v11, v75
  v_cvt_pk_bf16_f32 v56, v8, v9
  v_cvt_pk_bf16_f32 v57, v10, v11
  v_lshlrev_b32 v4, 16, v116
  v_and_b32 v5, 0xffff0000, v116
  v_lshlrev_b32 v6, 16, v117
  v_and_b32 v7, 0xffff0000, v117
  v_mul_f32 v4, v4, v76
  v_mul_f32 v5, v5, v77
  v_mul_f32 v6, v6, v78
  v_mul_f32 v7, v7, v79
  v_cvt_pk_bf16_f32 v60, v4, v5
  v_cvt_pk_bf16_f32 v61, v6, v7
  v_lshlrev_b32 v8, 16, v118
  v_and_b32 v9, 0xffff0000, v118
  v_lshlrev_b32 v10, 16, v119
  v_and_b32 v11, 0xffff0000, v119
  v_mul_f32 v8, v8, v80
  v_mul_f32 v9, v9, v81
  v_mul_f32 v10, v10, v82
  v_mul_f32 v11, v11, v83
  v_cvt_pk_bf16_f32 v64, v8, v9
  v_cvt_pk_bf16_f32 v65, v10, v11
  s_waitcnt lgkmcnt(0)
  ds_read_b128 v[36:39], v24
  ds_read_b128 v[40:43], v25
  ds_read_b128 v[44:47], v26
  ds_read_b128 v[48:51], v27
  v_lshlrev_b32 v4, 16, v120
  v_and_b32 v5, 0xffff0000, v120
  v_lshlrev_b32 v6, 16, v121
  v_and_b32 v7, 0xffff0000, v121
  v_mul_f32 v4, v4, v68
  v_mul_f32 v5, v5, v69
  v_mul_f32 v6, v6, v70
  v_mul_f32 v7, v7, v71
  v_cvt_pk_bf16_f32 v54, v4, v5
  v_cvt_pk_bf16_f32 v55, v6, v7
  v_lshlrev_b32 v8, 16, v122
  v_and_b32 v9, 0xffff0000, v122
  v_lshlrev_b32 v10, 16, v123
  v_and_b32 v11, 0xffff0000, v123
  v_mul_f32 v8, v8, v72
  v_mul_f32 v9, v9, v73
  v_mul_f32 v10, v10, v74
  v_mul_f32 v11, v11, v75
  v_cvt_pk_bf16_f32 v58, v8, v9
  v_cvt_pk_bf16_f32 v59, v10, v11
  v_lshlrev_b32 v4, 16, v124
  v_and_b32 v5, 0xffff0000, v124
  v_lshlrev_b32 v6, 16, v125
  v_and_b32 v7, 0xffff0000, v125
  v_mul_f32 v4, v4, v76
  v_mul_f32 v5, v5, v77
  v_mul_f32 v6, v6, v78
  v_mul_f32 v7, v7, v79
  v_cvt_pk_bf16_f32 v62, v4, v5
  v_cvt_pk_bf16_f32 v63, v6, v7
  v_lshlrev_b32 v8, 16, v126
  v_and_b32 v9, 0xffff0000, v126
  v_lshlrev_b32 v10, 16, v127
  v_and_b32 v11, 0xffff0000, v127
  v_mul_f32 v8, v8, v80
  v_mul_f32 v9, v9, v81
  v_mul_f32 v10, v10, v82
  v_mul_f32 v11, v11, v83
  v_cvt_pk_bf16_f32 v66, v8, v9
  v_cvt_pk_bf16_f32 v67, v10, v11
  s_waitcnt lgkmcnt(0)
  ds_write_b128 v20, v[52:55]
  ds_write_b128 v21, v[56:59]
  ds_write_b128 v22, v[60:63]
  ds_write_b128 v23, v[64:67]
  s_waitcnt lgkmcnt(0)
  ds_read_b128 v[52:55], v24
  ds_read_b128 v[56:59], v25
  ds_read_b128 v[60:63], v26
  ds_read_b128 v[64:67], v27
  s_waitcnt lgkmcnt(0)
  s_mov_b32 s52, s8
  s_mov_b32 s53, s9
  s_mov_b32 s54, 0x30d400
  s_mov_b32 s55, 0x20000
  s_add_u32 s56, s8, 0x320000
  s_addc_u32 s57, s9, 0
  s_mov_b32 s58, 0x30d400
  s_mov_b32 s59, 0x20000
  buffer_store_dwordx4 v[36:39], v29, s[52:55], 0 offen offset:0 sc1
  buffer_store_dwordx4 v[40:43], v29, s[52:55], 0 offen offset:1024 sc1
  buffer_store_dwordx4 v[44:47], v29, s[52:55], 0 offen offset:2048 sc1
  buffer_store_dwordx4 v[48:51], v29, s[52:55], 0 offen offset:3072 sc1
  buffer_store_dwordx4 v[52:55], v29, s[56:59], 0 offen offset:0 sc1
  buffer_store_dwordx4 v[56:59], v29, s[56:59], 0 offen offset:1024 sc1
  buffer_store_dwordx4 v[60:63], v29, s[56:59], 0 offen offset:2048 sc1
  buffer_store_dwordx4 v[64:67], v29, s[56:59], 0 offen offset:3072 sc1
  s_branch FA_join
FA_tables:
  s_mov_b32 s44, s72
  s_mov_b32 s45, s73
  s_mov_b32 s46, 0x20
  s_mov_b32 s47, 0x20000
  s_add_u32 s48, s8, 0x680000
  s_addc_u32 s49, s9, 0
  s_mov_b32 s50, 0x10420
  s_mov_b32 s51, 0x20000
  v_and_b32 v1, 15, v0
  v_lshlrev_b32 v1, 1, v1
  buffer_load_ushort v2, v1, s[44:47], 0 offen
  s_sub_u32 s80, s2, 196
  s_mul_i32 s80, s80, 48
  s_sub_u32 s81, s40, 4
  s_lshl_b32 s81, s81, 2
  s_add_u32 s80, s80, s81
  v_lshrrev_b32 v3, 4, v11
  v_add_u32 v3, s80, v3
  s_mov_b32 s82, 0x3e22f983
  s_mov_b32 s83, 0x40490fdb
  s_mov_b32 s84, 0x3e4ccccd
  s_mov_b32 s85, 0x40a00000
  s_waitcnt vmcnt(0)
  v_lshlrev_b32 v2, 16, v2
  v_add_u32 v12, 0, v3
  v_add_u32 v13, 14464, v12
  v_lshlrev_b32 v13, 16, v13
  v_mul_f32 v14, v13, v2
  v_cvt_pk_bf16_f32 v14, 0, v14
  v_mul_f32 v14, s82, v14
  v_fract_f32 v14, v14
  v_sin_f32 v15, v14
  v_rcp_f32 v16, v13
  v_cvt_pk_bf16_f32 v15, 0, v15
  v_mul_f32 v17, v15, v16
  v_fma_f32 v18, -v17, v13, v15
  v_fma_f32 v17, v18, v16, v17
  v_cvt_pk_bf16_f32 v17, 0, v17
  v_mul_f32 v19, s83, v13
  v_cvt_pk_bf16_f32 v19, 0, v19
  v_mul_f32 v14, s84, v19
  v_fma_f32 v18, -v14, s85, v19
  v_fma_f32 v14, v18, s84, v14
  v_cvt_pk_bf16_f32 v14, 0, v14
  v_mul_f32 v14, s82, v14
  v_cos_f32 v14, v14
  s_nop 0
  v_cvt_pk_bf16_f32 v14, 0, v14
  v_add_f32 v14, 1.0, v14
  v_cvt_pk_bf16_f32 v14, 0, v14
  v_mul_f32 v14, 0.5, v14
  v_cvt_pk_bf16_f32 v14, 0, v14
  v_mul_f32 v17, v17, v14
  v_cvt_pk_bf16_f32 v17, 0, v17
  v_cmp_gt_f32 vcc, s85, v13
  s_nop 1
  v_cndmask_b32 v17, 0, v17, vcc
  v_lshl_add_u32 v12, v12, 5, v1
  buffer_store_short_d16_hi v17, v12, s[48:51], 0 offen sc1
  v_add_u32 v24, 16, v3
  v_add_u32 v25, 14464, v24
  v_lshlrev_b32 v25, 16, v25
  v_mul_f32 v26, v25, v2
  v_cvt_pk_bf16_f32 v26, 0, v26
  v_mul_f32 v26, s82, v26
  v_fract_f32 v26, v26
  v_sin_f32 v27, v26
  v_rcp_f32 v28, v25
  v_cvt_pk_bf16_f32 v27, 0, v27
  v_mul_f32 v29, v27, v28
  v_fma_f32 v30, -v29, v25, v27
  v_fma_f32 v29, v30, v28, v29
  v_cvt_pk_bf16_f32 v29, 0, v29
  v_mul_f32 v31, s83, v25
  v_cvt_pk_bf16_f32 v31, 0, v31
  v_mul_f32 v26, s84, v31
  v_fma_f32 v30, -v26, s85, v31
  v_fma_f32 v26, v30, s84, v26
  v_cvt_pk_bf16_f32 v26, 0, v26
  v_mul_f32 v26, s82, v26
  v_cos_f32 v26, v26
  s_nop 0
  v_cvt_pk_bf16_f32 v26, 0, v26
  v_add_f32 v26, 1.0, v26
  v_cvt_pk_bf16_f32 v26, 0, v26
  v_mul_f32 v26, 0.5, v26
  v_cvt_pk_bf16_f32 v26, 0, v26
  v_mul_f32 v29, v29, v26
  v_cvt_pk_bf16_f32 v29, 0, v29
  v_cmp_gt_f32 vcc, s85, v25
  s_nop 1
  v_cndmask_b32 v29, 0, v29, vcc
  v_lshl_add_u32 v24, v24, 5, v1
  buffer_store_short_d16_hi v29, v24, s[48:51], 0 offen sc1
  v_add_u32 v36, 32, v3
  v_add_u32 v37, 14464, v36
  v_lshlrev_b32 v37, 16, v37
  v_mul_f32 v38, v37, v2
  v_cvt_pk_bf16_f32 v38, 0, v38
  v_mul_f32 v38, s82, v38
  v_fract_f32 v38, v38
  v_sin_f32 v39, v38
  v_rcp_f32 v40, v37
  v_cvt_pk_bf16_f32 v39, 0, v39
  v_mul_f32 v41, v39, v40
  v_fma_f32 v42, -v41, v37, v39
  v_fma_f32 v41, v42, v40, v41
  v_cvt_pk_bf16_f32 v41, 0, v41
  v_mul_f32 v43, s83, v37
  v_cvt_pk_bf16_f32 v43, 0, v43
  v_mul_f32 v38, s84, v43
  v_fma_f32 v42, -v38, s85, v43
  v_fma_f32 v38, v42, s84, v38
  v_cvt_pk_bf16_f32 v38, 0, v38
  v_mul_f32 v38, s82, v38
  v_cos_f32 v38, v38
  s_nop 0
  v_cvt_pk_bf16_f32 v38, 0, v38
  v_add_f32 v38, 1.0, v38
  v_cvt_pk_bf16_f32 v38, 0, v38
  v_mul_f32 v38, 0.5, v38
  v_cvt_pk_bf16_f32 v38, 0, v38
  v_mul_f32 v41, v41, v38
  v_cvt_pk_bf16_f32 v41, 0, v41
  v_cmp_gt_f32 vcc, s85, v37
  s_nop 1
  v_cndmask_b32 v41, 0, v41, vcc
  v_lshl_add_u32 v36, v36, 5, v1
  buffer_store_short_d16_hi v41, v36, s[48:51], 0 offen sc1
  s_cmp_lt_u32 s2, 249
  s_cbranch_scc1 FA_wp_done
  s_sub_u32 s80, s2, 249
  s_lshl_b32 s80, s80, 2
  s_add_u32 s80, s80, s40
  s_sub_u32 s80, s80, 4
  s_mov_b32 s52, s70
  s_mov_b32 s53, s71
  s_mov_b32 s54, 0x6000
  s_mov_b32 s55, 0x20000
  s_mov_b32 s56, s74
  s_mov_b32 s57, s75
  s_mov_b32 s58, 0x1800
  s_mov_b32 s59, 0x20000
  s_add_u32 s60, s8, 0x6a0000
  s_addc_u32 s61, s9, 0
  s_mov_b32 s62, 0x7000
  s_mov_b32 s63, 0x20000
  v_and_b32 v2, 15, v11
  v_lshrrev_b32 v3, 4, v11
  v_lshlrev_b32 v40, 4, v11
  s_lshl_b32 s81, s80, 10
  v_add_u32 v40, s81, v40
  s_and_b32 s82, s80, 3
  v_lshl_add_u32 v6, v2, 2, s82
  s_cmp_ge_u32 s80, 16
  s_cbranch_scc1 FA_wp_rbf
  s_bfe_u32 s83, s80, 0x10002
  s_lshl_b32 s83, s83, 1
  s_lshr_b32 s84, s80, 3
  s_lshl_b32 s84, s84, 8
  v_lshl_add_u32 v5, v3, 4, s83
  v_mul_u32_u24 v5, 384, v5
  v_lshl_add_u32 v5, v6, 1, v5
  v_add_u32 v5, s84, v5
  v_add_u32 v12, 0, v5
  v_add_u32 v13, 1536, v5
  v_add_u32 v14, 3072, v5
  v_add_u32 v15, 4608, v5
  v_add_u32 v16, 384, v5
  v_add_u32 v17, 1920, v5
  v_add_u32 v18, 3456, v5
  v_add_u32 v19, 4992, v5
  buffer_load_ushort v20, v12, s[52:55], 0 offen
  buffer_load_ushort v21, v13, s[52:55], 0 offen
  buffer_load_ushort v22, v14, s[52:55], 0 offen
  buffer_load_ushort v23, v15, s[52:55], 0 offen
  buffer_load_ushort v24, v16, s[52:55], 0 offen
  buffer_load_ushort v25, v17, s[52:55], 0 offen
  buffer_load_ushort v26, v18, s[52:55], 0 offen
  buffer_load_ushort v27, v19, s[52:55], 0 offen
  s_waitcnt vmcnt(0)
  v_lshl_or_b32 v44, v21, 16, v20
  v_lshl_or_b32 v45, v23, 16, v22
  v_lshl_or_b32 v46, v25, 16, v24
  v_lshl_or_b32 v47, v27, 16, v26
  buffer_store_dwordx4 v[44:47], v40, s[60:63], 0 offen sc1
  s_branch FA_wp_done
FA_wp_rbf:
  s_sub_u32 s83, s80, 16
  s_lshr_b32 s83, s83, 2
  s_lshl_b32 s83, s83, 7
  v_lshlrev_b32 v7, 2, v3
  v_mul_u32_u24 v7, 384, v7
  v_lshl_add_u32 v7, v6, 1, v7
  v_add_u32 v7, s83, v7
  buffer_load_ushort v32, v7, s[56:59], 0 offen offset:0
  buffer_load_ushort v33, v7, s[56:59], 0 offen offset:384
  buffer_load_ushort v34, v7, s[56:59], 0 offen offset:768
  buffer_load_ushort v35, v7, s[56:59], 0 offen offset:1152
  s_waitcnt vmcnt(0)
  v_lshlrev_b32 v32, 16, v32
  v_lshlrev_b32 v33, 16, v33
  v_lshlrev_b32 v34, 16, v34
  v_lshlrev_b32 v35, 16, v35
  buffer_store_dwordx4 v[32:35], v40, s[60:63], 0 offen sc1
FA_wp_done:
  s_waitcnt vmcnt(0)
  v_mov_b32 v2, 0
  v_mov_b32 v3, 1
  s_mov_b64 exec, 1
  ds_add_rtn_u32 v4, v2, v3 offset:524
  s_mov_b64 exec, -1
  s_waitcnt lgkmcnt(0)
  v_readfirstlane_b32 s80, v4
  s_nop 1
  s_cmp_lg_u32 s80, 3
  s_cbranch_scc1 FA_join
  s_add_u32 s44, s8, 0x780000
  s_addc_u32 s45, s9, 0
  s_mov_b32 s46, 0x4000
  s_mov_b32 s47, 0x20000
  v_mov_b32 v140, s96
  v_mov_b32 v141, s96
  s_lshl_b32 s80, s2, 3
  v_and_b32 v142, 63, v0
  v_lshlrev_b32 v142, 11, v142
  v_add_u32 v142, s80, v142
  s_mov_b64 exec, 0xff
  buffer_store_dwordx2 v[140:141], v142, s[44:47], 0 offen sc1
  s_mov_b64 exec, -1
DP_skip_A:
FA_join:
  s_waitcnt lgkmcnt(0)
  s_barrier
  v_and_b32 v11, 63, v0
  v_lshlrev_b32 v15, 4, v11
  s_add_u32 s16, s8, 0x680000
  s_addc_u32 s17, s9, 0
  s_mov_b32 s18, 0x10420
  s_mov_b32 s19, 0x20000
  s_add_u32 s44, s8, 0x6a0000
  s_addc_u32 s45, s9, 0
  s_mov_b32 s46, 0x7000
  s_mov_b32 s47, 0x20000
  s_add_u32 s80, s40, 0
  s_lshl_b32 s81, s80, 10
  s_add_u32 s82, s81, 77472
  s_mov_b32 m0, s82
  s_nop 0
  buffer_load_dwordx4 v15, s[44:47], s81 offen sc1 lds
  s_add_u32 s80, s40, 8
  s_lshl_b32 s81, s80, 10
  s_add_u32 s82, s81, 77472
  s_mov_b32 m0, s82
  s_nop 0
  buffer_load_dwordx4 v15, s[44:47], s81 offen sc1 lds
  s_add_u32 s80, s40, 16
  s_lshl_b32 s81, s80, 10
  s_add_u32 s82, s81, 77472
  s_mov_b32 m0, s82
  s_nop 0
  buffer_load_dwordx4 v15, s[44:47], s81 offen sc1 lds
  s_add_u32 s80, s40, 24
  s_cmp_ge_u32 s80, 28
  s_cbranch_scc1 K2_wdone
  s_lshl_b32 s81, s80, 10
  s_add_u32 s82, s81, 77472
  s_mov_b32 m0, s82
  s_nop 0
  buffer_load_dwordx4 v15, s[44:47], s81 offen sc1 lds
K2_wdone:
  s_add_u32 s80, s40, 0
  s_lshl_b32 s81, s80, 10
  s_add_u32 s82, s81, 131232
  s_add_u32 s81, s81, 36864
  s_mov_b32 m0, s82
  v_add_u32 v139, s81, v15
  buffer_load_dwordx4 v139, s[16:19], 0 offen sc1 lds
  s_add_u32 s80, s40, 8
  s_lshl_b32 s81, s80, 10
  s_add_u32 s82, s81, 131232
  s_add_u32 s81, s81, 36864
  s_mov_b32 m0, s82
  v_add_u32 v139, s81, v15
  buffer_load_dwordx4 v139, s[16:19], 0 offen sc1 lds
  s_add_u32 s80, s40, 16
  s_lshl_b32 s81, s80, 10
  s_add_u32 s82, s81, 131232
  s_add_u32 s81, s81, 36864
  s_mov_b32 m0, s82
  v_add_u32 v139, s81, v15
  buffer_load_dwordx4 v139, s[16:19], 0 offen sc1 lds
  s_add_u32 s80, s40, 24
  s_cmp_ge_u32 s80, 30
  s_cbranch_scc1 K2_ldone
  s_lshl_b32 s81, s80, 10
  s_add_u32 s82, s81, 131232
  s_add_u32 s81, s81, 36864
  s_mov_b32 m0, s82
  v_add_u32 v139, s81, v15
  buffer_load_dwordx4 v139, s[16:19], 0 offen sc1 lds
K2_ldone:
  s_cmp_lg_u32 s40, 7
  s_cbranch_scc1 K2_nodmin
  s_mov_b32 m0, 161952
  v_add_u32 v139, 2624, v15
  s_mov_b64 exec, 3
  buffer_load_dwordx4 v139, s[16:19], 0 offen sc1 lds
  s_mov_b64 exec, -1
K2_nodmin:
  v_and_b32 v11, 63, v0
  s_and_b32 s59, s2, 7
  s_lshl_b32 s59, s59, 5
  s_lshr_b32 s80, s2, 3
  s_add_u32 s59, s59, s80
  s_mul_i32 s60, s59, 49
  s_cmp_lg_u32 s40, 7
  s_cbranch_scc1 K2_nopf
  s_getpc_b64 s[28:29]
K2_pc:
  s_mov_b32 s30, CODE_END - K2_pc
  s_mov_b32 s31, 0x20000
  s_lshr_b32 s80, s2, 3
  s_lshl_b32 s80, s80, 11
  v_lshlrev_b32 v65, 7, v11
  v_add_u32 v65, s80, v65
  s_mov_b64 exec, 0xffff
  buffer_load_dword v70, v65, s[28:31], 0 offen
  s_mov_b64 exec, -1
K2_nopf:
  s_add_u32 s16, s8, 0x680000
  s_addc_u32 s17, s9, 0
  s_mov_b32 s18, 0x10420
  s_mov_b32 s19, 0x20000
  s_movk_i32 s54, 3584
  s_add_u32 s36, s8, 0x0
  s_addc_u32 s37, s9, 0
  s_or_b32 s37, s37, 0x1000000
  s_add_u32 s38, s8, 0x320000
  s_addc_u32 s39, s9, 0
  s_or_b32 s39, s39, 0x1000000
  s_mov_b32 s14, 12500
  s_mov_b32 s15, 0x20000
  s_mov_b32 s12, s38
  s_mov_b32 s13, s39
  v_lshlrev_b32 v15, 4, v11
  v_and_b32 v1, 15, v11
  v_lshlrev_b32 v1, 4, v1
  v_lshrrev_b32 v2, 4, v11
  v_lshlrev_b32 v2, 4, v2
  v_bfe_u32 v12, v11, 2, 2
  v_lshlrev_b32 v12, 4, v12
  v_lshrrev_b32 v13, 4, v11
  v_lshl_add_u32 v3, v13, 2, v12
  v_lshrrev_b32 v3, 1, v3
  v_and_b32 v5, 3, v11
  v_lshlrev_b32 v5, 3, v5
  v_add_u32 v5, 131232, v5
  v_lshlrev_b32 v6, 3, v11
  s_sub_u32 s41, 12500, s60
  s_min_u32 s41, s41, 49
  s_lshl_b32 s42, s41, 1
  s_mov_b32 s57, 0x05040100
  s_mov_b32 s58, 0x07060302
  s_mov_b32 s24, s6
  s_mov_b32 s25, s7
  s_mov_b32 s26, 0x61a800
  s_mov_b32 s27, 0x20000
  s_mov_b32 s62, 0
  s_mov_b32 s99, 1
K2_batch:
  s_add_u32 s28, s8, 0x800000
  s_addc_u32 s29, s9, 0
  s_mov_b32 s30, 0x400000
  s_mov_b32 s31, 0x20000
  v_and_b32 v11, 63, v0
  v_lshlrev_b32 v13, 2, v11
  v_lshlrev_b32 v15, 4, v11
  ds_read_b128 v[32:35], v15 offset:576
  v_mov_b32 v14, 0
  s_cmp_lg_u32 s40, 0
  s_cbranch_scc1 K2_nz
  ds_write_b32 v13, v14 offset:0
  ds_write_b32 v14, v14 offset:516
K2_nz:
  s_waitcnt lgkmcnt(0)
  v_lshrrev_b32 v40, 16, v32
  v_and_b32 v32, 0xffff, v32
  v_lshrrev_b32 v41, 16, v33
  v_and_b32 v33, 0xffff, v33
  v_lshrrev_b32 v42, 16, v34
  v_and_b32 v34, 0xffff, v34
  v_lshrrev_b32 v43, 16, v35
  v_and_b32 v35, 0xffff, v35
  v_mov_b32 v48, 0
  v_mov_b32 v49, v40
  v_add_u32 v50, v49, v41
  v_add_u32 v51, v50, v42
  v_add_u32 v57, v51, v43
  v_mov_b32 v58, v57
  s_nop 1
  v_add_u32_dpp v58, v58, v58 row_shr:1 row_mask:0xf bank_mask:0xf bound_ctrl:0
  s_nop 1
  v_add_u32_dpp v58, v58, v58 row_shr:2 row_mask:0xf bank_mask:0xf bound_ctrl:0
  s_nop 1
  v_add_u32_dpp v58, v58, v58 row_shr:4 row_mask:0xf bank_mask:0xf bound_ctrl:0
  s_nop 1
  v_add_u32_dpp v58, v58, v58 row_shr:8 row_mask:0xf bank_mask:0xf bound_ctrl:0
  s_nop 1
  v_add_u32_dpp v58, v58, v58 row_bcast:15 row_mask:0xa bank_mask:0xf
  s_nop 1
  v_add_u32_dpp v58, v58, v58 row_bcast:31 row_mask:0xc bank_mask:0xf
  s_nop 0
  v_readlane_b32 s61, v58, 63
  v_sub_u32 v58, v58, v57
  s_and_b32 s85, s40, 3
  s_lshr_b32 s43, s40, 2
  s_cmp_eq_u32 s85, 1
  s_cselect_b64 s[82:83], -1, 0
  v_cndmask_b32 v40, v40, v41, s[82:83]
  v_cndmask_b32 v32, v32, v33, s[82:83]
  v_cndmask_b32 v48, v48, v49, s[82:83]
  s_cmp_eq_u32 s85, 2
  s_cselect_b64 s[82:83], -1, 0
  v_cndmask_b32 v40, v40, v42, s[82:83]
  v_cndmask_b32 v32, v32, v34, s[82:83]
  v_cndmask_b32 v48, v48, v50, s[82:83]
  s_cmp_eq_u32 s85, 3
  s_cselect_b64 s[82:83], -1, 0
  v_cndmask_b32 v40, v40, v43, s[82:83]
  v_cndmask_b32 v32, v32, v35, s[82:83]
  v_cndmask_b32 v48, v48, v51, s[82:83]
  v_add_u32 v52, v48, v58
  v_lshl_add_u32 v55, v11, 2, s85
  v_lshlrev_b32 v55, 14, v55
  v_lshl_add_u32 v55, v32, 2, v55
  s_sub_u32 s63, s61, s62
  s_min_u32 s63, s63, s54
  s_cmp_lg_u32 s62, 0
  s_cselect_b32 s79, 1, 0
  s_add_u32 s80, s62, s54
  s_cmp_lt_u32 s80, s61
  s_cselect_b32 s80, 2, 0
  s_or_b32 s79, s79, s80
  s_cmp_lg_u32 s79, 0
  s_cbranch_scc1 K2_expslow
  s_lshl_b32 s87, s43, 2
  s_add_u32 s86, s87, 106144
  v_lshl_add_u32 v58, v52, 2, s86
  v_add_u32 v56, s87, v55
  v_subrev_u32 v41, s43, v40
  v_cmpx_lt_i32 vcc, 0, v41
  s_nop 1
  s_cbranch_execz K2_expdone
  ds_write_b32 v58, v56 offset:0
  v_add_u32 v56, 8, v56
  v_cmpx_lt_i32 vcc, 2, v41
  ds_write_b32 v58, v56 offset:8
  v_add_u32 v56, 8, v56
  v_cmpx_lt_i32 vcc, 4, v41
  ds_write_b32 v58, v56 offset:16
  v_add_u32 v56, 8, v56
  v_cmpx_lt_i32 vcc, 6, v41
  ds_write_b32 v58, v56 offset:24
  v_add_u32 v56, 8, v56
  v_cmpx_lt_i32 vcc, 8, v41
  s_nop 1
  s_cbranch_execz K2_expdone
  ds_write_b32 v58, v56 offset:32
  v_add_u32 v56, 8, v56
  v_cmpx_lt_i32 vcc, 10, v41
  ds_write_b32 v58, v56 offset:40
  v_add_u32 v56, 8, v56
  v_cmpx_lt_i32 vcc, 12, v41
  ds_write_b32 v58, v56 offset:48
  v_add_u32 v56, 8, v56
  v_cmpx_lt_i32 vcc, 14, v41
  ds_write_b32 v58, v56 offset:56
  v_add_u32 v56, 8, v56
  v_cmpx_lt_i32 vcc, 16, v41
  s_nop 1
  s_cbranch_execz K2_expdone
  ds_write_b32 v58, v56 offset:64
  v_add_u32 v56, 8, v56
  v_cmpx_lt_i32 vcc, 18, v41
  ds_write_b32 v58, v56 offset:72
  v_add_u32 v56, 8, v56
  v_cmpx_lt_i32 vcc, 20, v41
  ds_write_b32 v58, v56 offset:80
  v_add_u32 v56, 8, v56
  v_cmpx_lt_i32 vcc, 22, v41
  ds_write_b32 v58, v56 offset:88
  v_add_u32 v56, 8, v56
  v_cmpx_lt_i32 vcc, 24, v41
  s_nop 1
  s_cbranch_execz K2_expdone
  ds_write_b32 v58, v56 offset:96
  v_add_u32 v56, 8, v56
  v_cmpx_lt_i32 vcc, 26, v41
  ds_write_b32 v58, v56 offset:104
  v_add_u32 v56, 8, v56
  v_cmpx_lt_i32 vcc, 28, v41
  ds_write_b32 v58, v56 offset:112
  v_add_u32 v56, 8, v56
  v_cmpx_lt_i32 vcc, 30, v41
  ds_write_b32 v58, v56 offset:120
  v_add_u32 v56, 8, v56
  v_cmpx_lt_i32 vcc, 32, v41
  s_nop 1
  s_cbranch_execz K2_expdone
  s_mov_b64 exec, -1
  s_add_u32 s80, s43, 32
  s_branch K2_exploop0
K2_expslow:
  s_mov_b32 s80, s43
K2_exploop0:
  v_subrev_u32 v52, s62, v52
  s_mov_b32 s81, s54
  s_mov_b32 s86, 106144
K2_exp:
  v_cmp_lt_u32 vcc, s80, v40
  s_nop 1
  s_cbranch_vccz K2_expdone
  v_add_u32 v57, s80, v52
  v_cmp_gt_u32 s[82:83], s81, v57
  s_nop 1
  s_and_b64 vcc, vcc, s[82:83]
  s_and_saveexec_b64 s[84:85], vcc
  v_lshl_add_u32 v58, v57, 2, s86
  s_lshl_b32 s87, s80, 2
  v_add_u32 v59, s87, v55
  ds_write_b32 v58, v59
  s_mov_b64 exec, s[84:85]
  s_add_u32 s80, s80, 2
  s_branch K2_exp
K2_expdone:
  s_mov_b64 exec, -1
  s_waitcnt lgkmcnt(0)
  s_barrier
  v_lshlrev_b32 v136, 2, v0
  v_add_u32 v136, 106144, v136
  ds_read_b32 v128, v136 offset:0
  ds_read_b32 v129, v136 offset:2048
  ds_read_b32 v130, v136 offset:4096
  ds_read_b32 v131, v136 offset:6144
  ds_read_b32 v132, v136 offset:8192
  ds_read_b32 v133, v136 offset:10240
  ds_read_b32 v134, v136 offset:12288
  s_sub_i32 s80, s63, 0
  v_cmp_gt_i32 s[64:65], s80, v0
  s_sub_i32 s80, s63, 512
  v_cmp_gt_i32 s[66:67], s80, v0
  s_sub_i32 s80, s63, 1024
  v_cmp_gt_i32 s[68:69], s80, v0
  s_sub_i32 s80, s63, 1536
  v_cmp_gt_i32 s[70:71], s80, v0
  s_sub_i32 s80, s63, 2048
  v_cmp_gt_i32 s[72:73], s80, v0
  s_sub_i32 s80, s63, 2560
  v_cmp_gt_i32 s[74:75], s80, v0
  s_sub_i32 s80, s63, 3072
  v_cmp_gt_i32 s[76:77], s80, v0
  v_mov_b32 v137, 0x7fffff00
  v_mov_b32 v138, 1
  s_waitcnt lgkmcnt(6)
  v_cndmask_b32 v128, v137, v128, s[64:65]
  buffer_load_dword v32, v128, s[28:31], 0 offen sc1
  s_waitcnt lgkmcnt(5)
  v_cndmask_b32 v129, v137, v129, s[66:67]
  buffer_load_dword v33, v129, s[28:31], 0 offen sc1
  s_waitcnt lgkmcnt(4)
  v_cndmask_b32 v130, v137, v130, s[68:69]
  buffer_load_dword v34, v130, s[28:31], 0 offen sc1
  s_waitcnt lgkmcnt(3)
  v_cndmask_b32 v131, v137, v131, s[70:71]
  buffer_load_dword v35, v131, s[28:31], 0 offen sc1
  s_waitcnt lgkmcnt(2)
  v_cndmask_b32 v132, v137, v132, s[72:73]
  buffer_load_dword v36, v132, s[28:31], 0 offen sc1
  s_waitcnt lgkmcnt(1)
  v_cndmask_b32 v133, v137, v133, s[74:75]
  buffer_load_dword v37, v133, s[28:31], 0 offen sc1
  s_waitcnt lgkmcnt(0)
  v_cndmask_b32 v134, v137, v134, s[76:77]
  buffer_load_dword v38, v134, s[28:31], 0 offen sc1
  v_mov_b32 v64, 0
  v_mov_b32 v96, 0
  v_mov_b32 v65, 0
  v_mov_b32 v97, 0
  v_mov_b32 v66, 0
  v_mov_b32 v98, 0
  v_mov_b32 v68, 0
  v_mov_b32 v99, 0
  v_mov_b32 v69, 0
  v_mov_b32 v100, 0
  v_mov_b32 v70, 0
  v_mov_b32 v101, 0
  v_mov_b32 v72, 0
  v_mov_b32 v102, 0
  v_mov_b32 v73, 0
  v_mov_b32 v103, 0
  v_mov_b32 v74, 0
  v_mov_b32 v104, 0
  v_mov_b32 v76, 0
  v_mov_b32 v105, 0
  v_mov_b32 v77, 0
  v_mov_b32 v106, 0
  v_mov_b32 v78, 0
  v_mov_b32 v107, 0
  v_mov_b32 v80, 0
  v_mov_b32 v108, 0
  v_mov_b32 v81, 0
  v_mov_b32 v109, 0
  v_mov_b32 v82, 0
  v_mov_b32 v110, 0
  v_mov_b32 v84, 0
  v_mov_b32 v111, 0
  v_mov_b32 v85, 0
  v_mov_b32 v112, 0
  v_mov_b32 v86, 0
  v_mov_b32 v113, 0
  v_mov_b32 v88, 0
  v_mov_b32 v114, 0
  v_mov_b32 v89, 0
  v_mov_b32 v115, 0
  v_mov_b32 v90, 0
  v_mov_b32 v116, 0
  s_mul_i32 s82, s60, 6
  s_add_u32 s82, s82, 1600
  s_mov_b32 s83, 1600
  s_waitcnt vmcnt(0)
  s_barrier
  s_cmp_eq_u32 s99, 0
  s_cbranch_scc1 K2_notables
  s_cmp_eq_u32 s97, 0
  s_cbranch_scc1 K2_notables
  s_mov_b32 s48, s82
  s_mov_b32 s49, s83
  s_cmp_lg_u32 s40, 1
  s_cbranch_scc1 DP_skip_B
  s_add_u32 s44, s8, 0x780000
  s_addc_u32 s45, s9, 0
  s_mov_b32 s46, 0x4000
  s_mov_b32 s47, 0x20000
  v_mov_b32 v140, s96
  v_mov_b32 v141, s96
  s_lshl_b32 s80, s2, 3
  v_and_b32 v142, 63, v0
  v_lshlrev_b32 v142, 11, v142
  v_add_u32 v142, s80, v142
  s_mov_b64 exec, 0xff
  buffer_store_dwordx2 v[140:141], v142, s[44:47], 0 offen sc1
  s_mov_b64 exec, -1
DP_skip_B:
  s_mov_b32 s82, s48
  s_mov_b32 s83, s49
K2_notables:
  v_lshrrev_b32 v67, 8, v32
  v_and_b32 v48, 63, v32
  v_mad_u32_u24 v128, v67, 6, s83
  v_mad_u32_u24 v139, v48, 6, s82
  v_lshlrev_b32 v48, 2, v48
  ds_read_u16_d16_hi v64, v128 offset:0
  ds_read_u16_d16_hi v65, v128 offset:2
  ds_read_u16_d16_hi v66, v128 offset:4
  ds_read_u16_d16_hi v96, v139 offset:0
  ds_read_u16_d16_hi v97, v139 offset:2
  ds_read_u16_d16_hi v98, v139 offset:4
  s_mov_b64 exec, s[64:65]
  ds_add_rtn_u32 v40, v48, v138 offset:0
  s_mov_b64 exec, -1
  v_lshrrev_b32 v71, 8, v33
  v_and_b32 v49, 63, v33
  v_mad_u32_u24 v129, v71, 6, s83
  v_mad_u32_u24 v139, v49, 6, s82
  v_lshlrev_b32 v49, 2, v49
  ds_read_u16_d16_hi v68, v129 offset:0
  ds_read_u16_d16_hi v69, v129 offset:2
  ds_read_u16_d16_hi v70, v129 offset:4
  ds_read_u16_d16_hi v99, v139 offset:0
  ds_read_u16_d16_hi v100, v139 offset:2
  ds_read_u16_d16_hi v101, v139 offset:4
  s_mov_b64 exec, s[66:67]
  ds_add_rtn_u32 v41, v49, v138 offset:0
  s_mov_b64 exec, -1
  v_lshrrev_b32 v75, 8, v34
  v_and_b32 v50, 63, v34
  v_mad_u32_u24 v130, v75, 6, s83
  v_mad_u32_u24 v139, v50, 6, s82
  v_lshlrev_b32 v50, 2, v50
  ds_read_u16_d16_hi v72, v130 offset:0
  ds_read_u16_d16_hi v73, v130 offset:2
  ds_read_u16_d16_hi v74, v130 offset:4
  ds_read_u16_d16_hi v102, v139 offset:0
  ds_read_u16_d16_hi v103, v139 offset:2
  ds_read_u16_d16_hi v104, v139 offset:4
  s_mov_b64 exec, s[68:69]
  ds_add_rtn_u32 v42, v50, v138 offset:0
  s_mov_b64 exec, -1
  v_lshrrev_b32 v79, 8, v35
  v_and_b32 v51, 63, v35
  v_mad_u32_u24 v131, v79, 6, s83
  v_mad_u32_u24 v139, v51, 6, s82
  v_lshlrev_b32 v51, 2, v51
  ds_read_u16_d16_hi v76, v131 offset:0
  ds_read_u16_d16_hi v77, v131 offset:2
  ds_read_u16_d16_hi v78, v131 offset:4
  ds_read_u16_d16_hi v105, v139 offset:0
  ds_read_u16_d16_hi v106, v139 offset:2
  ds_read_u16_d16_hi v107, v139 offset:4
  s_mov_b64 exec, s[70:71]
  ds_add_rtn_u32 v43, v51, v138 offset:0
  s_mov_b64 exec, -1
  v_lshrrev_b32 v83, 8, v36
  v_and_b32 v52, 63, v36
  v_mad_u32_u24 v132, v83, 6, s83
  v_mad_u32_u24 v139, v52, 6, s82
  v_lshlrev_b32 v52, 2, v52
  ds_read_u16_d16_hi v80, v132 offset:0
  ds_read_u16_d16_hi v81, v132 offset:2
  ds_read_u16_d16_hi v82, v132 offset:4
  ds_read_u16_d16_hi v108, v139 offset:0
  ds_read_u16_d16_hi v109, v139 offset:2
  ds_read_u16_d16_hi v110, v139 offset:4
  s_mov_b64 exec, s[72:73]
  ds_add_rtn_u32 v44, v52, v138 offset:0
  s_mov_b64 exec, -1
  v_lshrrev_b32 v87, 8, v37
  v_and_b32 v53, 63, v37
  v_mad_u32_u24 v133, v87, 6, s83
  v_mad_u32_u24 v139, v53, 6, s82
  v_lshlrev_b32 v53, 2, v53
  ds_read_u16_d16_hi v84, v133 offset:0
  ds_read_u16_d16_hi v85, v133 offset:2
  ds_read_u16_d16_hi v86, v133 offset:4
  ds_read_u16_d16_hi v111, v139 offset:0
  ds_read_u16_d16_hi v112, v139 offset:2
  ds_read_u16_d16_hi v113, v139 offset:4
  s_mov_b64 exec, s[74:75]
  ds_add_rtn_u32 v45, v53, v138 offset:0
  s_mov_b64 exec, -1
  v_lshrrev_b32 v91, 8, v38
  v_and_b32 v54, 63, v38
  v_mad_u32_u24 v134, v91, 6, s83
  v_mad_u32_u24 v139, v54, 6, s82
  v_lshlrev_b32 v54, 2, v54
  ds_read_u16_d16_hi v88, v134 offset:0
  ds_read_u16_d16_hi v89, v134 offset:2
  ds_read_u16_d16_hi v90, v134 offset:4
  ds_read_u16_d16_hi v114, v139 offset:0
  ds_read_u16_d16_hi v115, v139 offset:2
  ds_read_u16_d16_hi v116, v139 offset:4
  s_mov_b64 exec, s[76:77]
  ds_add_rtn_u32 v46, v54, v138 offset:0
  s_mov_b64 exec, -1
  v_mov_b32 v160, 0
  v_mov_b32 v161, 0
  v_mov_b32 v162, 0
  v_mov_b32 v163, 0
  v_mov_b32 v164, 0
  v_mov_b32 v165, 0
  v_mov_b32 v166, 0
  v_mov_b32 v167, 0
  v_mov_b32 v168, 0
  v_mov_b32 v169, 0
  v_mov_b32 v170, 0
  v_mov_b32 v171, 0
  v_mov_b32 v172, 0
  v_mov_b32 v173, 0
  v_mov_b32 v174, 0
  v_mov_b32 v175, 0
  v_mov_b32 v176, 0
  v_mov_b32 v177, 0
  v_mov_b32 v178, 0
  v_mov_b32 v179, 0
  v_mov_b32 v180, 0
  v_mov_b32 v181, 0
  v_mov_b32 v182, 0
  v_mov_b32 v183, 0
  v_mov_b32 v184, 0
  v_mov_b32 v185, 0
  v_mov_b32 v186, 0
  v_mov_b32 v187, 0
  v_mov_b32 v188, 0
  v_mov_b32 v189, 0
  v_mov_b32 v190, 0
  v_mov_b32 v191, 0
  v_mov_b32 v192, 0
  v_mov_b32 v193, 0
  v_mov_b32 v194, 0
  v_mov_b32 v195, 0
  v_mov_b32 v196, 0
  v_mov_b32 v197, 0
  v_mov_b32 v198, 0
  v_mov_b32 v199, 0
  v_mov_b32 v200, 0
  v_mov_b32 v201, 0
  v_mov_b32 v202, 0
  v_mov_b32 v203, 0
  v_mov_b32 v204, 0
  v_mov_b32 v205, 0
  v_mov_b32 v206, 0
  v_mov_b32 v207, 0
  v_mov_b32 v208, 0
  v_mov_b32 v209, 0
  v_mov_b32 v210, 0
  v_mov_b32 v211, 0
  v_mov_b32 v212, 0
  v_mov_b32 v213, 0
  v_mov_b32 v214, 0
  v_mov_b32 v215, 0
  v_mov_b32 v216, 0
  v_mov_b32 v217, 0
  v_mov_b32 v218, 0
  v_mov_b32 v219, 0
  v_mov_b32 v220, 0
  v_mov_b32 v221, 0
  v_mov_b32 v222, 0
  v_mov_b32 v223, 0
  v_mov_b32 v224, 0
  v_mov_b32 v225, 0
  v_mov_b32 v226, 0
  v_mov_b32 v227, 0
  v_mov_b32 v228, 0
  v_mov_b32 v229, 0
  v_mov_b32 v230, 0
  v_mov_b32 v231, 0
  v_mov_b32 v232, 0
  v_mov_b32 v233, 0
  v_mov_b32 v234, 0
  v_mov_b32 v235, 0
  v_mov_b32 v236, 0
  v_mov_b32 v237, 0
  v_mov_b32 v238, 0
  v_mov_b32 v239, 0
  v_mov_b32 v240, 0
  v_mov_b32 v241, 0
  v_mov_b32 v242, 0
  v_mov_b32 v243, 0
  v_mov_b32 v244, 0
  v_mov_b32 v245, 0
  v_mov_b32 v246, 0
  v_mov_b32 v247, 0
  v_mov_b32 v248, 0
  v_mov_b32 v249, 0
  v_mov_b32 v250, 0
  v_mov_b32 v251, 0
  v_mov_b32 v252, 0
  v_mov_b32 v253, 0
  v_mov_b32 v254, 0
  v_mov_b32 v255, 0
  s_mov_b32 s80, 0x322bcc77
  s_mov_b32 s81, 16544
  s_mov_b32 s87, 15616
  s_waitcnt lgkmcnt(0)
  v_sub_f32 v64, v64, v96
  v_sub_f32 v65, v65, v97
  v_sub_f32 v66, v66, v98
  v_cvt_pk_bf16_f32 v64, 0, v64
  v_cvt_pk_bf16_f32 v65, 0, v65
  v_cvt_pk_bf16_f32 v66, 0, v66
  v_mul_f32 v144, v64, v64
  v_mul_f32 v145, v65, v65
  v_mul_f32 v146, v66, v66
  v_cvt_pk_bf16_f32 v144, 0, v144
  v_cvt_pk_bf16_f32 v145, 0, v145
  v_cvt_pk_bf16_f32 v146, 0, v146
  v_add_f32 v144, v144, v145
  v_add_f32 v144, v144, v146
  v_cvt_pk_bf16_f32 v144, 0, v144
  v_add_f32 v144, s80, v144
  v_cvt_pk_bf16_f32 v144, 0, v144
  v_sqrt_f32 v144, v144
  s_nop 0
  v_cvt_pk_bf16_f32 v144, 0, v144
  v_rcp_f32 v145, v144
  v_lshrrev_b32 v146, 16, v144
  v_min_u32 v120, s81, v146
  v_cmp_gt_u32 vcc, s87, v146
  v_subrev_u32 v120, s87, v120
  s_nop 0
  s_and_b64 vcc, vcc, s[64:65]
  s_cbranch_vccnz K2_small_0
K2_smallret_0:
  v_mul_f32 v64, v64, v145
  v_mul_f32 v65, v65, v145
  v_mul_f32 v66, v66, v145
  v_cvt_pk_bf16_f32 v64, 0, v64
  v_cvt_pk_bf16_f32 v65, 0, v65
  v_cvt_pk_bf16_f32 v66, 0, v66
  v_sub_f32 v68, v68, v99
  v_sub_f32 v69, v69, v100
  v_sub_f32 v70, v70, v101
  v_cvt_pk_bf16_f32 v68, 0, v68
  v_cvt_pk_bf16_f32 v69, 0, v69
  v_cvt_pk_bf16_f32 v70, 0, v70
  v_mul_f32 v148, v68, v68
  v_mul_f32 v149, v69, v69
  v_mul_f32 v150, v70, v70
  v_cvt_pk_bf16_f32 v148, 0, v148
  v_cvt_pk_bf16_f32 v149, 0, v149
  v_cvt_pk_bf16_f32 v150, 0, v150
  v_add_f32 v148, v148, v149
  v_add_f32 v148, v148, v150
  v_cvt_pk_bf16_f32 v148, 0, v148
  v_add_f32 v148, s80, v148
  v_cvt_pk_bf16_f32 v148, 0, v148
  v_sqrt_f32 v148, v148
  s_nop 0
  v_cvt_pk_bf16_f32 v148, 0, v148
  v_rcp_f32 v149, v148
  v_lshrrev_b32 v150, 16, v148
  v_min_u32 v121, s81, v150
  v_cmp_gt_u32 vcc, s87, v150
  v_subrev_u32 v121, s87, v121
  s_nop 0
  s_and_b64 vcc, vcc, s[66:67]
  s_cbranch_vccnz K2_small_1
K2_smallret_1:
  v_mul_f32 v68, v68, v149
  v_mul_f32 v69, v69, v149
  v_mul_f32 v70, v70, v149
  v_cvt_pk_bf16_f32 v68, 0, v68
  v_cvt_pk_bf16_f32 v69, 0, v69
  v_cvt_pk_bf16_f32 v70, 0, v70
  v_sub_f32 v72, v72, v102
  v_sub_f32 v73, v73, v103
  v_sub_f32 v74, v74, v104
  v_cvt_pk_bf16_f32 v72, 0, v72
  v_cvt_pk_bf16_f32 v73, 0, v73
  v_cvt_pk_bf16_f32 v74, 0, v74
  v_mul_f32 v144, v72, v72
  v_mul_f32 v145, v73, v73
  v_mul_f32 v146, v74, v74
  v_cvt_pk_bf16_f32 v144, 0, v144
  v_cvt_pk_bf16_f32 v145, 0, v145
  v_cvt_pk_bf16_f32 v146, 0, v146
  v_add_f32 v144, v144, v145
  v_add_f32 v144, v144, v146
  v_cvt_pk_bf16_f32 v144, 0, v144
  v_add_f32 v144, s80, v144
  v_cvt_pk_bf16_f32 v144, 0, v144
  v_sqrt_f32 v144, v144
  s_nop 0
  v_cvt_pk_bf16_f32 v144, 0, v144
  v_rcp_f32 v145, v144
  v_lshrrev_b32 v146, 16, v144
  v_min_u32 v122, s81, v146
  v_cmp_gt_u32 vcc, s87, v146
  v_subrev_u32 v122, s87, v122
  s_nop 0
  s_and_b64 vcc, vcc, s[68:69]
  s_cbranch_vccnz K2_small_2
K2_smallret_2:
  v_mul_f32 v72, v72, v145
  v_mul_f32 v73, v73, v145
  v_mul_f32 v74, v74, v145
  v_cvt_pk_bf16_f32 v72, 0, v72
  v_cvt_pk_bf16_f32 v73, 0, v73
  v_cvt_pk_bf16_f32 v74, 0, v74
  v_sub_f32 v76, v76, v105
  v_sub_f32 v77, v77, v106
  v_sub_f32 v78, v78, v107
  v_cvt_pk_bf16_f32 v76, 0, v76
  v_cvt_pk_bf16_f32 v77, 0, v77
  v_cvt_pk_bf16_f32 v78, 0, v78
  v_mul_f32 v148, v76, v76
  v_mul_f32 v149, v77, v77
  v_mul_f32 v150, v78, v78
  v_cvt_pk_bf16_f32 v148, 0, v148
  v_cvt_pk_bf16_f32 v149, 0, v149
  v_cvt_pk_bf16_f32 v150, 0, v150
  v_add_f32 v148, v148, v149
  v_add_f32 v148, v148, v150
  v_cvt_pk_bf16_f32 v148, 0, v148
  v_add_f32 v148, s80, v148
  v_cvt_pk_bf16_f32 v148, 0, v148
  v_sqrt_f32 v148, v148
  s_nop 0
  v_cvt_pk_bf16_f32 v148, 0, v148
  v_rcp_f32 v149, v148
  v_lshrrev_b32 v150, 16, v148
  v_min_u32 v123, s81, v150
  v_cmp_gt_u32 vcc, s87, v150
  v_subrev_u32 v123, s87, v123
  s_nop 0
  s_and_b64 vcc, vcc, s[70:71]
  s_cbranch_vccnz K2_small_3
K2_smallret_3:
  v_mul_f32 v76, v76, v149
  v_mul_f32 v77, v77, v149
  v_mul_f32 v78, v78, v149
  v_cvt_pk_bf16_f32 v76, 0, v76
  v_cvt_pk_bf16_f32 v77, 0, v77
  v_cvt_pk_bf16_f32 v78, 0, v78
  v_sub_f32 v80, v80, v108
  v_sub_f32 v81, v81, v109
  v_sub_f32 v82, v82, v110
  v_cvt_pk_bf16_f32 v80, 0, v80
  v_cvt_pk_bf16_f32 v81, 0, v81
  v_cvt_pk_bf16_f32 v82, 0, v82
  v_mul_f32 v144, v80, v80
  v_mul_f32 v145, v81, v81
  v_mul_f32 v146, v82, v82
  v_cvt_pk_bf16_f32 v144, 0, v144
  v_cvt_pk_bf16_f32 v145, 0, v145
  v_cvt_pk_bf16_f32 v146, 0, v146
  v_add_f32 v144, v144, v145
  v_add_f32 v144, v144, v146
  v_cvt_pk_bf16_f32 v144, 0, v144
  v_add_f32 v144, s80, v144
  v_cvt_pk_bf16_f32 v144, 0, v144
  v_sqrt_f32 v144, v144
  s_nop 0
  v_cvt_pk_bf16_f32 v144, 0, v144
  v_rcp_f32 v145, v144
  v_lshrrev_b32 v146, 16, v144
  v_min_u32 v124, s81, v146
  v_cmp_gt_u32 vcc, s87, v146
  v_subrev_u32 v124, s87, v124
  s_nop 0
  s_and_b64 vcc, vcc, s[72:73]
  s_cbranch_vccnz K2_small_4
K2_smallret_4:
  v_mul_f32 v80, v80, v145
  v_mul_f32 v81, v81, v145
  v_mul_f32 v82, v82, v145
  v_cvt_pk_bf16_f32 v80, 0, v80
  v_cvt_pk_bf16_f32 v81, 0, v81
  v_cvt_pk_bf16_f32 v82, 0, v82
  v_sub_f32 v84, v84, v111
  v_sub_f32 v85, v85, v112
  v_sub_f32 v86, v86, v113
  v_cvt_pk_bf16_f32 v84, 0, v84
  v_cvt_pk_bf16_f32 v85, 0, v85
  v_cvt_pk_bf16_f32 v86, 0, v86
  v_mul_f32 v148, v84, v84
  v_mul_f32 v149, v85, v85
  v_mul_f32 v150, v86, v86
  v_cvt_pk_bf16_f32 v148, 0, v148
  v_cvt_pk_bf16_f32 v149, 0, v149
  v_cvt_pk_bf16_f32 v150, 0, v150
  v_add_f32 v148, v148, v149
  v_add_f32 v148, v148, v150
  v_cvt_pk_bf16_f32 v148, 0, v148
  v_add_f32 v148, s80, v148
  v_cvt_pk_bf16_f32 v148, 0, v148
  v_sqrt_f32 v148, v148
  s_nop 0
  v_cvt_pk_bf16_f32 v148, 0, v148
  v_rcp_f32 v149, v148
  v_lshrrev_b32 v150, 16, v148
  v_min_u32 v125, s81, v150
  v_cmp_gt_u32 vcc, s87, v150
  v_subrev_u32 v125, s87, v125
  s_nop 0
  s_and_b64 vcc, vcc, s[74:75]
  s_cbranch_vccnz K2_small_5
K2_smallret_5:
  v_mul_f32 v84, v84, v149
  v_mul_f32 v85, v85, v149
  v_mul_f32 v86, v86, v149
  v_cvt_pk_bf16_f32 v84, 0, v84
  v_cvt_pk_bf16_f32 v85, 0, v85
  v_cvt_pk_bf16_f32 v86, 0, v86
  s_cmp_eq_u64 s[76:77], 0
  s_cbranch_scc1 K2_geodone
  v_sub_f32 v88, v88, v114
  v_sub_f32 v89, v89, v115
  v_sub_f32 v90, v90, v116
  v_cvt_pk_bf16_f32 v88, 0, v88
  v_cvt_pk_bf16_f32 v89, 0, v89
  v_cvt_pk_bf16_f32 v90, 0, v90
  v_mul_f32 v144, v88, v88
  v_mul_f32 v145, v89, v89
  v_mul_f32 v146, v90, v90
  v_cvt_pk_bf16_f32 v144, 0, v144
  v_cvt_pk_bf16_f32 v145, 0, v145
  v_cvt_pk_bf16_f32 v146, 0, v146
  v_add_f32 v144, v144, v145
  v_add_f32 v144, v144, v146
  v_cvt_pk_bf16_f32 v144, 0, v144
  v_add_f32 v144, s80, v144
  v_cvt_pk_bf16_f32 v144, 0, v144
  v_sqrt_f32 v144, v144
  s_nop 0
  v_cvt_pk_bf16_f32 v144, 0, v144
  v_rcp_f32 v145, v144
  v_lshrrev_b32 v146, 16, v144
  v_min_u32 v126, s81, v146
  v_cmp_gt_u32 vcc, s87, v146
  v_subrev_u32 v126, s87, v126
  s_nop 0
  s_and_b64 vcc, vcc, s[76:77]
  s_cbranch_vccnz K2_small_6
K2_smallret_6:
  v_mul_f32 v88, v88, v145
  v_mul_f32 v89, v89, v145
  v_mul_f32 v90, v90, v145
  v_cvt_pk_bf16_f32 v88, 0, v88
  v_cvt_pk_bf16_f32 v89, 0, v89
  v_cvt_pk_bf16_f32 v90, 0, v90
K2_geodone:
  s_barrier
  s_cmp_eq_u32 s99, 0
  s_cbranch_scc1 K2_nodone2i
  s_cmp_lg_u32 s40, 0
  s_cbranch_scc1 K2_nodone2i
  s_add_u32 s44, s8, 0x780000
  s_addc_u32 s45, s9, 0
  s_mov_b32 s46, 0x4000
  s_mov_b32 s47, 0x20000
  s_and_b32 s48, s2, 7
  s_lshl_b32 s48, s48, 11
  v_lshlrev_b32 v137, 5, v11
  v_add_u32 v137, s48, v137
  buffer_load_dwordx4 v[96:99], v137, s[44:47], 0 offen sc1
  buffer_load_dwordx4 v[100:103], v137, s[44:47], 0 offen offset:16 sc1
K2_nodone2i:
  ds_read_b32 v140, v13 offset:0
  ds_read_b32 v141, v14 offset:516
  s_waitcnt lgkmcnt(0)
  v_readfirstlane_b32 s80, v141
  s_nop 1
  s_cmp_gt_u32 s80, 56
  s_cbranch_scc1 K2_toosmall
  v_add_u32 v141, 3, v140
  v_and_b32 v141, -4, v141
  v_mov_b32 v142, v141
  s_nop 1
  v_add_u32_dpp v142, v142, v142 row_shr:1 row_mask:0xf bank_mask:0xf bound_ctrl:0
  s_nop 1
  v_add_u32_dpp v142, v142, v142 row_shr:2 row_mask:0xf bank_mask:0xf bound_ctrl:0
  s_nop 1
  v_add_u32_dpp v142, v142, v142 row_shr:4 row_mask:0xf bank_mask:0xf bound_ctrl:0
  s_nop 1
  v_add_u32_dpp v142, v142, v142 row_shr:8 row_mask:0xf bank_mask:0xf bound_ctrl:0
  s_nop 1
  v_add_u32_dpp v142, v142, v142 row_bcast:15 row_mask:0xa bank_mask:0xf
  s_nop 1
  v_add_u32_dpp v142, v142, v142 row_bcast:31 row_mask:0xc bank_mask:0xf
  v_sub_u32 v143, v142, v141
  v_readlane_b32 s87, v142, 63
  v_add_u32 v155, 31, v141
  v_lshrrev_b32 v155, 5, v155
  v_max_u32 v155, 1, v155
  v_mov_b32 v156, v155
  s_nop 1
  v_add_u32_dpp v156, v156, v156 row_shr:1 row_mask:0xf bank_mask:0xf bound_ctrl:0
  s_nop 1
  v_add_u32_dpp v156, v156, v156 row_shr:2 row_mask:0xf bank_mask:0xf bound_ctrl:0
  s_nop 1
  v_add_u32_dpp v156, v156, v156 row_shr:4 row_mask:0xf bank_mask:0xf bound_ctrl:0
  s_nop 1
  v_add_u32_dpp v156, v156, v156 row_shr:8 row_mask:0xf bank_mask:0xf bound_ctrl:0
  s_nop 1
  v_add_u32_dpp v156, v156, v156 row_bcast:15 row_mask:0xa bank_mask:0xf
  s_nop 1
  v_add_u32_dpp v156, v156, v156 row_bcast:31 row_mask:0xc bank_mask:0xf
  v_sub_u32 v156, v156, v155
  v_lshlrev_b32 v135, 4, v143
  v_lshl_or_b32 v135, v156, 16, v135
  ds_bpermute_b32 v128, v48, v135
  ds_bpermute_b32 v129, v49, v135
  ds_bpermute_b32 v130, v50, v135
  ds_bpermute_b32 v131, v51, v135
  ds_bpermute_b32 v132, v52, v135
  ds_bpermute_b32 v133, v53, v135
  ds_bpermute_b32 v134, v54, v135
  v_mov_b32 v147, 8388352
  v_mov_b32 v144, 0
  v_mov_b32 v145, 0
  v_mov_b32 v146, 0
  v_mov_b32 v148, 928
  s_cmp_lt_u32 s40, 5
  s_cbranch_scc1 K2_nopad
  s_cmp_lg_u32 s40, 5
  s_cbranch_scc1 K2_lutpad
  v_add_u32 v149, 0, v140
  v_cmp_lt_u32 vcc, v149, v141
  s_nop 1
  s_and_saveexec_b64 s[80:81], vcc
  v_add_u32 v149, v149, v143
  v_lshlrev_b32 v150, 4, v149
  v_lshlrev_b32 v149, 2, v149
  ds_write_b128 v150, v[144:147] offset:1600
  s_mov_b64 exec, s[80:81]
  v_add_u32 v149, 1, v140
  v_cmp_lt_u32 vcc, v149, v141
  s_nop 1
  s_and_saveexec_b64 s[80:81], vcc
  v_add_u32 v149, v149, v143
  v_lshlrev_b32 v150, 4, v149
  v_lshlrev_b32 v149, 2, v149
  ds_write_b128 v150, v[144:147] offset:1600
  s_mov_b64 exec, s[80:81]
  v_add_u32 v149, 2, v140
  v_cmp_lt_u32 vcc, v149, v141
  s_nop 1
  s_and_saveexec_b64 s[80:81], vcc
  v_add_u32 v149, v149, v143
  v_lshlrev_b32 v150, 4, v149
  v_lshlrev_b32 v149, 2, v149
  ds_write_b128 v150, v[144:147] offset:1600
  s_mov_b64 exec, s[80:81]
  v_add_u32 v149, s87, v11
  v_lshlrev_b32 v150, 4, v149
  s_mov_b32 exec_hi, 0
  ds_write_b128 v150, v[144:147] offset:1600
  s_mov_b64 exec, -1
  s_branch K2_nopad
K2_lutpad:
  s_sub_u32 s80, s40, 6
  s_lshl_b32 s80, s80, 4
  v_lshlrev_b32 v149, 5, v156
  v_add_u32 v149, v149, v140
  v_add_u32 v149, s80, v149
  v_lshlrev_b32 v149, 1, v149
  v_lshlrev_b32 v150, 5, v155
  v_sub_u32 v150, v150, v140
  v_subrev_u32 v150, s80, v150
  v_cmp_gt_u32 vcc, s41, v11
  s_nop 1
  s_and_b64 exec, exec, vcc
  v_cmpx_lt_i32 vcc, 0, v150
  s_nop 1
  s_cbranch_execz K2_padsdone
  ds_write_b16 v149, v148 offset:61888
  v_cmpx_lt_i32 vcc, 1, v150
  ds_write_b16 v149, v148 offset:61890
  v_cmpx_lt_i32 vcc, 2, v150
  ds_write_b16 v149, v148 offset:61892
  v_cmpx_lt_i32 vcc, 3, v150
  ds_write_b16 v149, v148 offset:61894
  v_cmpx_lt_i32 vcc, 4, v150
  ds_write_b16 v149, v148 offset:61896
  v_cmpx_lt_i32 vcc, 5, v150
  ds_write_b16 v149, v148 offset:61898
  v_cmpx_lt_i32 vcc, 6, v150
  ds_write_b16 v149, v148 offset:61900
  v_cmpx_lt_i32 vcc, 7, v150
  ds_write_b16 v149, v148 offset:61902
  v_cmpx_lt_i32 vcc, 8, v150
  s_nop 1
  s_cbranch_execz K2_padsdone
  ds_write_b16 v149, v148 offset:61904
  v_cmpx_lt_i32 vcc, 9, v150
  ds_write_b16 v149, v148 offset:61906
  v_cmpx_lt_i32 vcc, 10, v150
  ds_write_b16 v149, v148 offset:61908
  v_cmpx_lt_i32 vcc, 11, v150
  ds_write_b16 v149, v148 offset:61910
  v_cmpx_lt_i32 vcc, 12, v150
  ds_write_b16 v149, v148 offset:61912
  v_cmpx_lt_i32 vcc, 13, v150
  ds_write_b16 v149, v148 offset:61914
  v_cmpx_lt_i32 vcc, 14, v150
  ds_write_b16 v149, v148 offset:61916
  v_cmpx_lt_i32 vcc, 15, v150
  ds_write_b16 v149, v148 offset:61918
K2_padsdone:
  s_mov_b64 exec, -1
K2_nopad:
  s_waitcnt lgkmcnt(0)
  v_lshrrev_b32 v139, 16, v128
  v_and_b32 v128, 0xffff, v128
  v_lshl_add_u32 v139, v139, 5, v40
  v_lshl_add_u32 v128, v40, 4, v128
  v_lshlrev_b32 v40, 1, v139
  s_mov_b64 exec, s[64:65]
  ds_write_b128 v128, v[64:67] offset:1600
  ds_write_b16 v40, v120 offset:61888
  s_mov_b64 exec, -1
  v_lshrrev_b32 v139, 16, v129
  v_and_b32 v129, 0xffff, v129
  v_lshl_add_u32 v139, v139, 5, v41
  v_lshl_add_u32 v129, v41, 4, v129
  v_lshlrev_b32 v41, 1, v139
  s_mov_b64 exec, s[66:67]
  ds_write_b128 v129, v[68:71] offset:1600
  ds_write_b16 v41, v121 offset:61888
  s_mov_b64 exec, -1
  v_lshrrev_b32 v139, 16, v130
  v_and_b32 v130, 0xffff, v130
  v_lshl_add_u32 v139, v139, 5, v42
  v_lshl_add_u32 v130, v42, 4, v130
  v_lshlrev_b32 v42, 1, v139
  s_mov_b64 exec, s[68:69]
  ds_write_b128 v130, v[72:75] offset:1600
  ds_write_b16 v42, v122 offset:61888
  s_mov_b64 exec, -1
  v_lshrrev_b32 v139, 16, v131
  v_and_b32 v131, 0xffff, v131
  v_lshl_add_u32 v139, v139, 5, v43
  v_lshl_add_u32 v131, v43, 4, v131
  v_lshlrev_b32 v43, 1, v139
  s_mov_b64 exec, s[70:71]
  ds_write_b128 v131, v[76:79] offset:1600
  ds_write_b16 v43, v123 offset:61888
  s_mov_b64 exec, -1
  v_lshrrev_b32 v139, 16, v132
  v_and_b32 v132, 0xffff, v132
  v_lshl_add_u32 v139, v139, 5, v44
  v_lshl_add_u32 v132, v44, 4, v132
  v_lshlrev_b32 v44, 1, v139
  s_mov_b64 exec, s[72:73]
  ds_write_b128 v132, v[80:83] offset:1600
  ds_write_b16 v44, v124 offset:61888
  s_mov_b64 exec, -1
  v_lshrrev_b32 v139, 16, v133
  v_and_b32 v133, 0xffff, v133
  v_lshl_add_u32 v139, v139, 5, v45
  v_lshl_add_u32 v133, v45, 4, v133
  v_lshlrev_b32 v45, 1, v139
  s_mov_b64 exec, s[74:75]
  ds_write_b128 v133, v[84:87] offset:1600
  ds_write_b16 v45, v125 offset:61888
  s_mov_b64 exec, -1
  v_lshrrev_b32 v139, 16, v134
  v_and_b32 v134, 0xffff, v134
  v_lshl_add_u32 v139, v139, 5, v46
  v_lshl_add_u32 v134, v46, 4, v134
  v_lshlrev_b32 v46, 1, v139
  s_mov_b64 exec, s[76:77]
  ds_write_b128 v134, v[88:91] offset:1600
  ds_write_b16 v46, v126 offset:61888
  s_mov_b64 exec, -1
  v_lshrrev_b32 v149, 2, v141
  v_lshlrev_b32 v150, 6, v143
  v_or_b32 v150, v150, v11
  v_lshl_or_b32 v150, v149, 18, v150
  v_cmp_gt_u32 vcc, s41, v11
  v_cmp_lt_u32 s[80:81], 20, v149
  v_cmp_lt_u32 s[82:83], 16, v149
  s_nop 0
  s_and_b64 s[80:81], s[80:81], vcc
  s_and_b64 s[82:83], s[82:83], vcc
  s_andn2_b64 s[84:85], vcc, s[82:83]
  s_andn2_b64 s[82:83], s[82:83], s[80:81]
  s_bcnt1_i32_b64 s86, s[80:81]
  s_bcnt1_i32_b64 s87, s[82:83]
  s_add_u32 s87, s87, s86
  v_mbcnt_lo_u32_b32 v151, s80, 0
  v_mbcnt_hi_u32_b32 v151, s81, v151
  v_mov_b32 v154, s86
  v_mbcnt_lo_u32_b32 v152, s82, v154
  v_mbcnt_hi_u32_b32 v152, s83, v152
  v_mov_b32 v154, s87
  v_mbcnt_lo_u32_b32 v153, s84, v154
  v_mbcnt_hi_u32_b32 v153, s85, v153
  v_mov_b32 v154, v11
  v_cndmask_b32 v154, v154, v153, s[84:85]
  v_cndmask_b32 v154, v154, v152, s[82:83]
  v_cndmask_b32 v154, v154, v151, s[80:81]
  v_lshlrev_b32 v154, 2, v154
  ds_permute_b32 v8, v154, v150
  v_lshlrev_b32 v156, 6, v156
  ds_permute_b32 v7, v154, v156
  v_mov_b32 v17, v1
  v_mov_b32 v19, v1
  v_mov_b32 v21, v1
  v_mov_b32 v23, v1
  v_mov_b32 v25, v1
  v_mov_b32 v27, v1
  v_mov_b32 v29, v1
  v_mov_b32 v31, v1
  s_cmp_eq_u32 s99, 0
  s_cbranch_scc1 K2_nodone2
  s_cmp_lg_u32 s40, 0
  s_cbranch_scc1 K2_nodone2
  s_mov_b32 s49, 0
  s_branch POLLCHK_done2
POLL_done2:
  buffer_load_dwordx4 v[96:99], v137, s[44:47], 0 offen sc1
  buffer_load_dwordx4 v[100:103], v137, s[44:47], 0 offen offset:16 sc1
POLLCHK_done2:
  s_waitcnt vmcnt(0)
  v_cmp_eq_u32 vcc, s96, v97
  v_cmp_eq_u32 s[50:51], s96, v99
  s_nop 1
  s_and_b64 vcc, vcc, s[50:51]
  v_cmp_eq_u32 s[50:51], s96, v101
  s_nop 1
  s_and_b64 vcc, vcc, s[50:51]
  v_cmp_eq_u32 s[50:51], s96, v103
  s_nop 1
  s_and_b64 vcc, vcc, s[50:51]
  s_cmp_eq_u64 vcc, -1
  s_cbranch_scc1 POLLOK_done2
  s_sleep 1
  s_add_u32 s49, s49, 1
  s_cmp_lt_u32 s49, 131072
  s_cbranch_scc1 POLL_done2
POLLOK_done2:
K2_nodone2:
  s_mov_b32 s99, 0
  s_waitcnt vmcnt(0) lgkmcnt(0)
  s_barrier
  s_mov_b32 s53, 0
  s_mov_b32 s55, 0
  s_sub_u32 s73, 6, s40
  s_min_u32 s75, s41, 42
  s_cmp_eq_u32 s40, 7
  s_cselect_b32 s72, 42, s40
  s_cselect_b32 s73, 42, s73
  s_cselect_b32 s74, 1, 7
  s_cselect_b32 s75, s41, s75
  s_movk_i32 s56, 0x100
  s_mov_b32 s12, s38
  s_mov_b32 s13, s39
  s_mov_b32 s80, 93856
  v_lshl_add_u32 v145, v6, 1, s80
  ds_read_b128 v[128:131], v145 offset:4096
  ds_read_b128 v[132:135], v145 offset:5120
  ds_read_b128 v[136:139], v145 offset:6144
  ds_read_b128 v[140:143], v145 offset:7168
  v_lshrrev_b32 v144, 1, v2
  v_and_b32 v146, 8, v144
  v_and_b32 v144, 16, v144
  v_lshlrev_b32 v144, 4, v144
  v_add3_u32 v144, v144, v146, v1
NS_top_init:
  s_bitcmp1_b32 s55, 0
  s_cselect_b32 s85, s73, s72
  s_mul_i32 s84, s55, s74
  s_add_u32 s84, s84, s85
  s_add_u32 s55, s55, 1
  s_cmp_ge_u32 s84, s75
  s_cbranch_scc1 NS_end_init
  v_readlane_b32 s85, v8, s84
  s_nop 1
  s_and_b32 s86, s85, 63
  s_or_b32 s43, s56, s86
  s_bfe_u32 s44, s85, 0xc0006
  s_lshl_b32 s44, s44, 4
  s_lshr_b32 s45, s85, 18
  v_readlane_b32 s78, v7, s84
NS_initdone:
  v_add_u32 v10, s44, v2
  s_nop 0
  v_add_u32 v4, s78, v3
  ds_read_b32 v16, v10 offset:1612
  ds_read_b32 v18, v10 offset:1676
  ds_read_b32 v20, v10 offset:1740
  ds_read_b32 v22, v10 offset:1804
  ds_read_b32 v24, v10 offset:1868
  ds_read_b32 v26, v10 offset:1932
  ds_read_b32 v28, v10 offset:1996
  ds_read_b32 v30, v10 offset:2060
  s_waitcnt lgkmcnt(0)
  s_bitcmp1_b32 s43, 11
  s_cbranch_scc1 LI_dead_fill0
  s_cmp_lt_u32 s45, 8
  s_cbranch_scc1 LI_tail_fill0
  buffer_load_dwordx4 v[160:163], v[16:17], s[12:15], 0 idxen offen sc1
  buffer_load_dwordx4 v[164:167], v[18:19], s[12:15], 0 idxen offen sc1
  buffer_load_dwordx4 v[168:171], v[20:21], s[12:15], 0 idxen offen sc1
  buffer_load_dwordx4 v[172:175], v[22:23], s[12:15], 0 idxen offen sc1
  buffer_load_dwordx4 v[176:179], v[24:25], s[12:15], 0 idxen offen sc1
  buffer_load_dwordx4 v[180:183], v[26:27], s[12:15], 0 idxen offen sc1
  buffer_load_dwordx4 v[184:187], v[28:29], s[12:15], 0 idxen offen sc1
  buffer_load_dwordx4 v[188:191], v[30:31], s[12:15], 0 idxen offen sc1
  s_mov_b32 s46, s43
  s_movk_i32 s49, 8
  s_add_u32 s53, s53, 8
  s_cmp_eq_u32 s45, 8
  s_cbranch_scc1 LI_last_fill0
  s_add_u32 s44, s44, 512
  s_add_u32 s78, s78, 64
  s_sub_u32 s45, s45, 8
  s_andn2_b32 s43, s43, 0x100
LI_end_fill0:
  v_add_u32 v11, s44, v2
  v_add_u32 v13, s78, v3
  ds_read_b32 v16, v11 offset:1612
  ds_read_b32 v18, v11 offset:1676
  ds_read_b32 v20, v11 offset:1740
  ds_read_b32 v22, v11 offset:1804
  ds_read_b32 v24, v11 offset:1868
  ds_read_b32 v26, v11 offset:1932
  ds_read_b32 v28, v11 offset:1996
  ds_read_b32 v30, v11 offset:2060
  s_waitcnt lgkmcnt(0)
  s_bitcmp1_b32 s43, 11
  s_cbranch_scc1 LI_dead_fill1
  s_cmp_lt_u32 s45, 8
  s_cbranch_scc1 LI_tail_fill1
  buffer_load_dwordx4 v[192:195], v[16:17], s[12:15], 0 idxen offen sc1
  buffer_load_dwordx4 v[196:199], v[18:19], s[12:15], 0 idxen offen sc1
  buffer_load_dwordx4 v[200:203], v[20:21], s[12:15], 0 idxen offen sc1
  buffer_load_dwordx4 v[204:207], v[22:23], s[12:15], 0 idxen offen sc1
  buffer_load_dwordx4 v[208:211], v[24:25], s[12:15], 0 idxen offen sc1
  buffer_load_dwordx4 v[212:215], v[26:27], s[12:15], 0 idxen offen sc1
  buffer_load_dwordx4 v[216:219], v[28:29], s[12:15], 0 idxen offen sc1
  buffer_load_dwordx4 v[220:223], v[30:31], s[12:15], 0 idxen offen sc1
  s_mov_b32 s47, s43
  s_movk_i32 s50, 8
  s_add_u32 s53, s53, 8
  s_cmp_eq_u32 s45, 8
  s_cbranch_scc1 LI_last_fill1
  s_add_u32 s44, s44, 512
  s_add_u32 s78, s78, 64
  s_sub_u32 s45, s45, 8
  s_andn2_b32 s43, s43, 0x100
LI_end_fill1:
  v_add_u32 v12, s44, v2
  v_add_u32 v9, s78, v3
  ds_read_b32 v16, v12 offset:1612
  ds_read_b32 v18, v12 offset:1676
  ds_read_b32 v20, v12 offset:1740
  ds_read_b32 v22, v12 offset:1804
  ds_read_b32 v24, v12 offset:1868
  ds_read_b32 v26, v12 offset:1932
  ds_read_b32 v28, v12 offset:1996
  ds_read_b32 v30, v12 offset:2060
  s_waitcnt lgkmcnt(0)
  s_bitcmp1_b32 s43, 11
  s_cbranch_scc1 LI_dead_fill2
  s_cmp_lt_u32 s45, 8
  s_cbranch_scc1 LI_tail_fill2
  buffer_load_dwordx4 v[224:227], v[16:17], s[12:15], 0 idxen offen sc1
  buffer_load_dwordx4 v[228:231], v[18:19], s[12:15], 0 idxen offen sc1
  buffer_load_dwordx4 v[232:235], v[20:21], s[12:15], 0 idxen offen sc1
  buffer_load_dwordx4 v[236:239], v[22:23], s[12:15], 0 idxen offen sc1
  buffer_load_dwordx4 v[240:243], v[24:25], s[12:15], 0 idxen offen sc1
  buffer_load_dwordx4 v[244:247], v[26:27], s[12:15], 0 idxen offen sc1
  buffer_load_dwordx4 v[248:251], v[28:29], s[12:15], 0 idxen offen sc1
  buffer_load_dwordx4 v[252:255], v[30:31], s[12:15], 0 idxen offen sc1
  s_mov_b32 s48, s43
  s_movk_i32 s51, 8
  s_add_u32 s53, s53, 8
  s_cmp_eq_u32 s45, 8
  s_cbranch_scc1 LI_last_fill2
  s_add_u32 s44, s44, 512
  s_add_u32 s78, s78, 64
  s_sub_u32 s45, s45, 8
  s_andn2_b32 s43, s43, 0x100
LI_end_fill2:
YLOOP_0:
  s_mov_b32 s52, s46
  s_and_b32 s81, s52, 0xc00
  s_cbranch_scc1 XENTER_0
  ds_read_u16 v56, v4 offset:61888
  ds_read_u16 v57, v4 offset:61920
  s_add_u32 s80, s50, s51
  s_cmp_lt_u32 s80, 16
  s_cbranch_scc1 WS_Y0
  s_waitcnt vmcnt(16)
WD_Y0:
  s_and_b32 s81, s52, 0x1100
  s_cbranch_scc1 YDISP_0
  v_perm_b32 v48, v164, v160, s57
  v_perm_b32 v49, v172, v168, s57
  v_perm_b32 v50, v180, v176, s57
  v_perm_b32 v51, v188, v184, s57
  s_waitcnt lgkmcnt(0)
  v_lshl_add_u32 v56, v56, 5, v5
  v_lshl_add_u32 v57, v57, 5, v5
  ds_read_b64_tr_b16 v[32:33], v56
  ds_read_b64_tr_b16 v[34:35], v57
  v_add_u32 v10, s44, v2
  v_add_u32 v4, s78, v3
  ds_read_b32 v16, v10 offset:1612
  ds_read_b32 v18, v10 offset:1676
  ds_read_b32 v20, v10 offset:1740
  ds_read_b32 v22, v10 offset:1804
  ds_read_b32 v24, v10 offset:1868
  ds_read_b32 v26, v10 offset:1932
  ds_read_b32 v28, v10 offset:1996
  ds_read_b32 v30, v10 offset:2060
  v_perm_b32 v52, v164, v160, s58
  v_perm_b32 v53, v172, v168, s58
  v_perm_b32 v54, v180, v176, s58
  v_perm_b32 v55, v188, v184, s58
  v_perm_b32 v64, v165, v161, s57
  v_perm_b32 v65, v173, v169, s57
  v_perm_b32 v66, v181, v177, s57
  v_perm_b32 v67, v189, v185, s57
  v_perm_b32 v68, v165, v161, s58
  v_perm_b32 v69, v173, v169, s58
  v_perm_b32 v70, v181, v177, s58
  v_perm_b32 v71, v189, v185, s58
  s_waitcnt lgkmcnt(8)
  v_mfma_f32_16x16x32_bf16 v[80:83], v[32:35], v[48:51], v[80:83]
  v_perm_b32 v48, v166, v162, s57
  v_perm_b32 v49, v174, v170, s57
  v_perm_b32 v50, v182, v178, s57
  v_perm_b32 v51, v190, v186, s57
  v_mfma_f32_16x16x32_bf16 v[84:87], v[32:35], v[52:55], v[84:87]
  v_perm_b32 v52, v166, v162, s58
  v_perm_b32 v53, v174, v170, s58
  v_perm_b32 v54, v182, v178, s58
  v_perm_b32 v55, v190, v186, s58
  v_mfma_f32_16x16x32_bf16 v[88:91], v[32:35], v[64:67], v[88:91]
  v_perm_b32 v64, v167, v163, s57
  v_perm_b32 v65, v175, v171, s57
  v_perm_b32 v66, v183, v179, s57
  v_perm_b32 v67, v191, v187, s57
  v_mfma_f32_16x16x32_bf16 v[92:95], v[32:35], v[68:71], v[92:95]
  v_perm_b32 v68, v167, v163, s58
  v_perm_b32 v69, v175, v171, s58
  v_perm_b32 v70, v183, v179, s58
  v_perm_b32 v71, v191, v187, s58
  s_waitcnt lgkmcnt(0)
  s_bitcmp1_b32 s43, 11
  s_cbranch_scc1 LI_dead_Yrf0
  s_cmp_lt_u32 s45, 8
  s_cbranch_scc1 LI_tail_Yrf0
  buffer_load_dwordx4 v[160:163], v[16:17], s[12:15], 0 idxen offen sc1
  buffer_load_dwordx4 v[164:167], v[18:19], s[12:15], 0 idxen offen sc1
  buffer_load_dwordx4 v[168:171], v[20:21], s[12:15], 0 idxen offen sc1
  buffer_load_dwordx4 v[172:175], v[22:23], s[12:15], 0 idxen offen sc1
  buffer_load_dwordx4 v[176:179], v[24:25], s[12:15], 0 idxen offen sc1
  buffer_load_dwordx4 v[180:183], v[26:27], s[12:15], 0 idxen offen sc1
  buffer_load_dwordx4 v[184:187], v[28:29], s[12:15], 0 idxen offen sc1
  buffer_load_dwordx4 v[188:191], v[30:31], s[12:15], 0 idxen offen sc1
  s_mov_b32 s46, s43
  s_movk_i32 s49, 8
  s_add_u32 s53, s53, 8
  s_cmp_eq_u32 s45, 8
  s_cbranch_scc1 LI_last_Yrf0
  s_add_u32 s44, s44, 512
  s_add_u32 s78, s78, 64
  s_sub_u32 s45, s45, 8
  s_andn2_b32 s43, s43, 0x100
LI_end_Yrf0:
  v_mfma_f32_16x16x32_bf16 v[96:99], v[32:35], v[48:51], v[96:99]
  v_mfma_f32_16x16x32_bf16 v[100:103], v[32:35], v[52:55], v[100:103]
  v_mfma_f32_16x16x32_bf16 v[104:107], v[32:35], v[64:67], v[104:107]
  v_mfma_f32_16x16x32_bf16 v[108:111], v[32:35], v[68:71], v[108:111]
YJOIN_0:
  s_bitcmp1_b32 s52, 9
  s_cbranch_scc1 YEPI_0
YLOOP_1:
  s_mov_b32 s52, s47
  s_and_b32 s81, s52, 0xc00
  s_cbranch_scc1 XENTER_1
  ds_read_u16 v56, v13 offset:61888
  ds_read_u16 v57, v13 offset:61920
  s_add_u32 s80, s51, s49
  s_cmp_lt_u32 s80, 16
  s_cbranch_scc1 WS_Y1
  s_waitcnt vmcnt(16)
WD_Y1:
  s_and_b32 s81, s52, 0x1100
  s_cbranch_scc1 YDISP_1
  v_perm_b32 v48, v196, v192, s57
  v_perm_b32 v49, v204, v200, s57
  v_perm_b32 v50, v212, v208, s57
  v_perm_b32 v51, v220, v216, s57
  s_waitcnt lgkmcnt(0)
  v_lshl_add_u32 v56, v56, 5, v5
  v_lshl_add_u32 v57, v57, 5, v5
  ds_read_b64_tr_b16 v[32:33], v56
  ds_read_b64_tr_b16 v[34:35], v57
  v_add_u32 v11, s44, v2
  v_add_u32 v13, s78, v3
  ds_read_b32 v16, v11 offset:1612
  ds_read_b32 v18, v11 offset:1676
  ds_read_b32 v20, v11 offset:1740
  ds_read_b32 v22, v11 offset:1804
  ds_read_b32 v24, v11 offset:1868
  ds_read_b32 v26, v11 offset:1932
  ds_read_b32 v28, v11 offset:1996
  ds_read_b32 v30, v11 offset:2060
  v_perm_b32 v52, v196, v192, s58
  v_perm_b32 v53, v204, v200, s58
  v_perm_b32 v54, v212, v208, s58
  v_perm_b32 v55, v220, v216, s58
  v_perm_b32 v64, v197, v193, s57
  v_perm_b32 v65, v205, v201, s57
  v_perm_b32 v66, v213, v209, s57
  v_perm_b32 v67, v221, v217, s57
  v_perm_b32 v68, v197, v193, s58
  v_perm_b32 v69, v205, v201, s58
  v_perm_b32 v70, v213, v209, s58
  v_perm_b32 v71, v221, v217, s58
  s_waitcnt lgkmcnt(8)
  v_mfma_f32_16x16x32_bf16 v[80:83], v[32:35], v[48:51], v[80:83]
  v_perm_b32 v48, v198, v194, s57
  v_perm_b32 v49, v206, v202, s57
  v_perm_b32 v50, v214, v210, s57
  v_perm_b32 v51, v222, v218, s57
  v_mfma_f32_16x16x32_bf16 v[84:87], v[32:35], v[52:55], v[84:87]
  v_perm_b32 v52, v198, v194, s58
  v_perm_b32 v53, v206, v202, s58
  v_perm_b32 v54, v214, v210, s58
  v_perm_b32 v55, v222, v218, s58
  v_mfma_f32_16x16x32_bf16 v[88:91], v[32:35], v[64:67], v[88:91]
  v_perm_b32 v64, v199, v195, s57
  v_perm_b32 v65, v207, v203, s57
  v_perm_b32 v66, v215, v211, s57
  v_perm_b32 v67, v223, v219, s57
  v_mfma_f32_16x16x32_bf16 v[92:95], v[32:35], v[68:71], v[92:95]
  v_perm_b32 v68, v199, v195, s58
  v_perm_b32 v69, v207, v203, s58
  v_perm_b32 v70, v215, v211, s58
  v_perm_b32 v71, v223, v219, s58
  s_waitcnt lgkmcnt(0)
  s_bitcmp1_b32 s43, 11
  s_cbranch_scc1 LI_dead_Yrf1
  s_cmp_lt_u32 s45, 8
  s_cbranch_scc1 LI_tail_Yrf1
  buffer_load_dwordx4 v[192:195], v[16:17], s[12:15], 0 idxen offen sc1
  buffer_load_dwordx4 v[196:199], v[18:19], s[12:15], 0 idxen offen sc1
  buffer_load_dwordx4 v[200:203], v[20:21], s[12:15], 0 idxen offen sc1
  buffer_load_dwordx4 v[204:207], v[22:23], s[12:15], 0 idxen offen sc1
  buffer_load_dwordx4 v[208:211], v[24:25], s[12:15], 0 idxen offen sc1
  buffer_load_dwordx4 v[212:215], v[26:27], s[12:15], 0 idxen offen sc1
  buffer_load_dwordx4 v[216:219], v[28:29], s[12:15], 0 idxen offen sc1
  buffer_load_dwordx4 v[220:223], v[30:31], s[12:15], 0 idxen offen sc1
  s_mov_b32 s47, s43
  s_movk_i32 s50, 8
  s_add_u32 s53, s53, 8
  s_cmp_eq_u32 s45, 8
  s_cbranch_scc1 LI_last_Yrf1
  s_add_u32 s44, s44, 512
  s_add_u32 s78, s78, 64
  s_sub_u32 s45, s45, 8
  s_andn2_b32 s43, s43, 0x100
LI_end_Yrf1:
  v_mfma_f32_16x16x32_bf16 v[96:99], v[32:35], v[48:51], v[96:99]
  v_mfma_f32_16x16x32_bf16 v[100:103], v[32:35], v[52:55], v[100:103]
  v_mfma_f32_16x16x32_bf16 v[104:107], v[32:35], v[64:67], v[104:107]
  v_mfma_f32_16x16x32_bf16 v[108:111], v[32:35], v[68:71], v[108:111]
YJOIN_1:
  s_bitcmp1_b32 s52, 9
  s_cbranch_scc1 YEPI_1
YLOOP_2:
  s_mov_b32 s52, s48
  s_and_b32 s81, s52, 0xc00
  s_cbranch_scc1 XENTER_2
  ds_read_u16 v56, v9 offset:61888
  ds_read_u16 v57, v9 offset:61920
  s_add_u32 s80, s49, s50
  s_cmp_lt_u32 s80, 16
  s_cbranch_scc1 WS_Y2
  s_waitcnt vmcnt(16)
WD_Y2:
  s_and_b32 s81, s52, 0x1100
  s_cbranch_scc1 YDISP_2
  v_perm_b32 v48, v228, v224, s57
  v_perm_b32 v49, v236, v232, s57
  v_perm_b32 v50, v244, v240, s57
  v_perm_b32 v51, v252, v248, s57
  s_waitcnt lgkmcnt(0)
  v_lshl_add_u32 v56, v56, 5, v5
  v_lshl_add_u32 v57, v57, 5, v5
  ds_read_b64_tr_b16 v[32:33], v56
  ds_read_b64_tr_b16 v[34:35], v57
  v_add_u32 v12, s44, v2
  v_add_u32 v9, s78, v3
  ds_read_b32 v16, v12 offset:1612
  ds_read_b32 v18, v12 offset:1676
  ds_read_b32 v20, v12 offset:1740
  ds_read_b32 v22, v12 offset:1804
  ds_read_b32 v24, v12 offset:1868
  ds_read_b32 v26, v12 offset:1932
  ds_read_b32 v28, v12 offset:1996
  ds_read_b32 v30, v12 offset:2060
  v_perm_b32 v52, v228, v224, s58
  v_perm_b32 v53, v236, v232, s58
  v_perm_b32 v54, v244, v240, s58
  v_perm_b32 v55, v252, v248, s58
  v_perm_b32 v64, v229, v225, s57
  v_perm_b32 v65, v237, v233, s57
  v_perm_b32 v66, v245, v241, s57
  v_perm_b32 v67, v253, v249, s57
  v_perm_b32 v68, v229, v225, s58
  v_perm_b32 v69, v237, v233, s58
  v_perm_b32 v70, v245, v241, s58
  v_perm_b32 v71, v253, v249, s58
  s_waitcnt lgkmcnt(8)
  v_mfma_f32_16x16x32_bf16 v[80:83], v[32:35], v[48:51], v[80:83]
  v_perm_b32 v48, v230, v226, s57
  v_perm_b32 v49, v238, v234, s57
  v_perm_b32 v50, v246, v242, s57
  v_perm_b32 v51, v254, v250, s57
  v_mfma_f32_16x16x32_bf16 v[84:87], v[32:35], v[52:55], v[84:87]
  v_perm_b32 v52, v230, v226, s58
  v_perm_b32 v53, v238, v234, s58
  v_perm_b32 v54, v246, v242, s58
  v_perm_b32 v55, v254, v250, s58
  v_mfma_f32_16x16x32_bf16 v[88:91], v[32:35], v[64:67], v[88:91]
  v_perm_b32 v64, v231, v227, s57
  v_perm_b32 v65, v239, v235, s57
  v_perm_b32 v66, v247, v243, s57
  v_perm_b32 v67, v255, v251, s57
  v_mfma_f32_16x16x32_bf16 v[92:95], v[32:35], v[68:71], v[92:95]
  v_perm_b32 v68, v231, v227, s58
  v_perm_b32 v69, v239, v235, s58
  v_perm_b32 v70, v247, v243, s58
  v_perm_b32 v71, v255, v251, s58
  s_waitcnt lgkmcnt(0)
  s_bitcmp1_b32 s43, 11
  s_cbranch_scc1 LI_dead_Yrf2
  s_cmp_lt_u32 s45, 8
  s_cbranch_scc1 LI_tail_Yrf2
  buffer_load_dwordx4 v[224:227], v[16:17], s[12:15], 0 idxen offen sc1
  buffer_load_dwordx4 v[228:231], v[18:19], s[12:15], 0 idxen offen sc1
  buffer_load_dwordx4 v[232:235], v[20:21], s[12:15], 0 idxen offen sc1
  buffer_load_dwordx4 v[236:239], v[22:23], s[12:15], 0 idxen offen sc1
  buffer_load_dwordx4 v[240:243], v[24:25], s[12:15], 0 idxen offen sc1
  buffer_load_dwordx4 v[244:247], v[26:27], s[12:15], 0 idxen offen sc1
  buffer_load_dwordx4 v[248:251], v[28:29], s[12:15], 0 idxen offen sc1
  buffer_load_dwordx4 v[252:255], v[30:31], s[12:15], 0 idxen offen sc1
  s_mov_b32 s48, s43
  s_movk_i32 s51, 8
  s_add_u32 s53, s53, 8
  s_cmp_eq_u32 s45, 8
  s_cbranch_scc1 LI_last_Yrf2
  s_add_u32 s44, s44, 512
  s_add_u32 s78, s78, 64
  s_sub_u32 s45, s45, 8
  s_andn2_b32 s43, s43, 0x100
LI_end_Yrf2:
  v_mfma_f32_16x16x32_bf16 v[96:99], v[32:35], v[48:51], v[96:99]
  v_mfma_f32_16x16x32_bf16 v[100:103], v[32:35], v[52:55], v[100:103]
  v_mfma_f32_16x16x32_bf16 v[104:107], v[32:35], v[64:67], v[104:107]
  v_mfma_f32_16x16x32_bf16 v[108:111], v[32:35], v[68:71], v[108:111]
YJOIN_2:
  s_bitcmp1_b32 s52, 9
  s_cbranch_scc1 YEPI_2
  s_branch YLOOP_0
XLOOP_0:
  s_mov_b32 s52, s46
  s_bitcmp1_b32 s52, 11
  s_cbranch_scc1 K2_fin
  ds_read_u16 v56, v4 offset:61888
  ds_read_u16 v57, v4 offset:61920
  ds_read_b128 v[64:67], v10 offset:1600
  ds_read_b128 v[68:71], v10 offset:1664
  ds_read_b128 v[72:75], v10 offset:1728
  ds_read_b128 v[76:79], v10 offset:1792
  s_add_u32 s80, s50, s51
  s_cmp_lt_u32 s80, 16
  s_cbranch_scc1 WS_X0
  s_waitcnt vmcnt(16)
WD_X0:
  s_and_b32 s81, s52, 0x1100
  s_cbranch_scc1 XDISP_0
  s_waitcnt lgkmcnt(4)
  v_lshl_add_u32 v56, v56, 5, v5
  v_lshl_add_u32 v57, v57, 5, v5
  ds_read_b64_tr_b16 v[32:33], v56
  ds_read_b64_tr_b16 v[34:35], v57
  v_perm_b32 v48, v166, v162, s57
  v_perm_b32 v49, v174, v170, s57
  v_perm_b32 v50, v182, v178, s57
  v_perm_b32 v51, v190, v186, s57
  v_perm_b32 v52, v166, v162, s58
  v_perm_b32 v53, v174, v170, s58
  v_perm_b32 v54, v182, v178, s58
  v_perm_b32 v55, v190, v186, s58
  s_waitcnt lgkmcnt(0)
  v_mfma_f32_16x16x32_bf16 v[144:147], v[32:35], v[48:51], v[144:147]
  v_lshlrev_b32 v56, 16, v32
  v_and_b32 v57, 0xffff0000, v32
  v_lshlrev_b32 v58, 16, v33
  v_mfma_f32_16x16x32_bf16 v[148:151], v[32:35], v[52:55], v[148:151]
  v_and_b32 v59, 0xffff0000, v33
  v_lshlrev_b32 v60, 16, v34
  v_and_b32 v61, 0xffff0000, v34
  v_lshlrev_b32 v62, 16, v35
  v_and_b32 v63, 0xffff0000, v35
  v_mul_f32 v64, v64, v56
  v_mul_f32 v65, v65, v56
  v_mul_f32 v66, v66, v56
  v_mul_f32 v68, v68, v57
  v_mul_f32 v69, v69, v57
  v_mul_f32 v70, v70, v57
  v_mul_f32 v72, v72, v58
  v_mul_f32 v73, v73, v58
  v_mul_f32 v74, v74, v58
  v_mul_f32 v76, v76, v59
  v_mul_f32 v77, v77, v59
  v_mul_f32 v78, v78, v59
  v_cvt_pk_bf16_f32 v36, v64, v68
  v_cvt_pk_bf16_f32 v37, v72, v76
  v_cvt_pk_bf16_f32 v40, v65, v69
  v_cvt_pk_bf16_f32 v41, v73, v77
  v_cvt_pk_bf16_f32 v44, v66, v70
  v_cvt_pk_bf16_f32 v45, v74, v78
  ds_read_b128 v[64:67], v10 offset:1856
  ds_read_b128 v[68:71], v10 offset:1920
  ds_read_b128 v[72:75], v10 offset:1984
  ds_read_b128 v[76:79], v10 offset:2048
  v_add_u32 v10, s44, v2
  v_add_u32 v4, s78, v3
  ds_read_b32 v16, v10 offset:1612
  ds_read_b32 v18, v10 offset:1676
  ds_read_b32 v20, v10 offset:1740
  ds_read_b32 v22, v10 offset:1804
  ds_read_b32 v24, v10 offset:1868
  ds_read_b32 v26, v10 offset:1932
  ds_read_b32 v28, v10 offset:1996
  ds_read_b32 v30, v10 offset:2060
  v_perm_b32 v48, v167, v163, s57
  v_perm_b32 v49, v175, v171, s57
  v_perm_b32 v50, v183, v179, s57
  v_perm_b32 v51, v191, v187, s57
  v_perm_b32 v52, v167, v163, s58
  v_perm_b32 v53, v175, v171, s58
  v_perm_b32 v54, v183, v179, s58
  v_perm_b32 v55, v191, v187, s58
  s_waitcnt lgkmcnt(8)
  v_mfma_f32_16x16x32_bf16 v[152:155], v[32:35], v[48:51], v[152:155]
  v_mul_f32 v64, v64, v60
  v_mul_f32 v65, v65, v60
  v_mul_f32 v66, v66, v60
  v_mfma_f32_16x16x32_bf16 v[156:159], v[32:35], v[52:55], v[156:159]
  v_mul_f32 v68, v68, v61
  v_mul_f32 v69, v69, v61
  v_mul_f32 v70, v70, v61
  v_mul_f32 v72, v72, v62
  v_mul_f32 v73, v73, v62
  v_mul_f32 v74, v74, v62
  v_mul_f32 v76, v76, v63
  v_mul_f32 v77, v77, v63
  v_mul_f32 v78, v78, v63
  v_cvt_pk_bf16_f32 v38, v64, v68
  v_cvt_pk_bf16_f32 v39, v72, v76
  v_cvt_pk_bf16_f32 v42, v65, v69
  v_cvt_pk_bf16_f32 v43, v73, v77
  v_cvt_pk_bf16_f32 v46, v66, v70
  v_cvt_pk_bf16_f32 v47, v74, v78
  v_perm_b32 v48, v164, v160, s57
  v_perm_b32 v49, v172, v168, s57
  v_perm_b32 v50, v180, v176, s57
  v_perm_b32 v51, v188, v184, s57
  s_nop 1
  v_mfma_f32_16x16x32_bf16 v[80:83], v[48:51], v[32:35], v[80:83]
  v_perm_b32 v52, v164, v160, s58
  v_mfma_f32_16x16x32_bf16 v[96:99], v[48:51], v[36:39], v[96:99]
  v_perm_b32 v53, v172, v168, s58
  v_mfma_f32_16x16x32_bf16 v[112:115], v[48:51], v[40:43], v[112:115]
  v_perm_b32 v54, v180, v176, s58
  v_mfma_f32_16x16x32_bf16 v[128:131], v[48:51], v[44:47], v[128:131]
  v_perm_b32 v55, v188, v184, s58
  s_nop 1
  v_mfma_f32_16x16x32_bf16 v[84:87], v[52:55], v[32:35], v[84:87]
  v_perm_b32 v48, v165, v161, s57
  v_mfma_f32_16x16x32_bf16 v[100:103], v[52:55], v[36:39], v[100:103]
  v_perm_b32 v49, v173, v169, s57
  v_mfma_f32_16x16x32_bf16 v[116:119], v[52:55], v[40:43], v[116:119]
  v_perm_b32 v50, v181, v177, s57
  v_mfma_f32_16x16x32_bf16 v[132:135], v[52:55], v[44:47], v[132:135]
  v_perm_b32 v51, v189, v185, s57
  s_nop 1
  v_mfma_f32_16x16x32_bf16 v[88:91], v[48:51], v[32:35], v[88:91]
  v_perm_b32 v52, v165, v161, s58
  v_mfma_f32_16x16x32_bf16 v[104:107], v[48:51], v[36:39], v[104:107]
  v_perm_b32 v53, v173, v169, s58
  v_mfma_f32_16x16x32_bf16 v[120:123], v[48:51], v[40:43], v[120:123]
  v_perm_b32 v54, v181, v177, s58
  v_mfma_f32_16x16x32_bf16 v[136:139], v[48:51], v[44:47], v[136:139]
  v_perm_b32 v55, v189, v185, s58
  s_waitcnt lgkmcnt(0)
  s_bitcmp1_b32 s43, 11
  s_cbranch_scc1 LI_dead_Xrf0
  s_cmp_lt_u32 s45, 8
  s_cbranch_scc1 LI_tail_Xrf0
  buffer_load_dwordx4 v[160:163], v[16:17], s[12:15], 0 idxen offen sc1
  buffer_load_dwordx4 v[164:167], v[18:19], s[12:15], 0 idxen offen sc1
  buffer_load_dwordx4 v[168:171], v[20:21], s[12:15], 0 idxen offen sc1
  buffer_load_dwordx4 v[172:175], v[22:23], s[12:15], 0 idxen offen sc1
  buffer_load_dwordx4 v[176:179], v[24:25], s[12:15], 0 idxen offen sc1
  buffer_load_dwordx4 v[180:183], v[26:27], s[12:15], 0 idxen offen sc1
  buffer_load_dwordx4 v[184:187], v[28:29], s[12:15], 0 idxen offen sc1
  buffer_load_dwordx4 v[188:191], v[30:31], s[12:15], 0 idxen offen sc1
  s_mov_b32 s46, s43
  s_movk_i32 s49, 8
  s_add_u32 s53, s53, 8
  s_cmp_eq_u32 s45, 8
  s_cbranch_scc1 LI_last_Xrf0
  s_add_u32 s44, s44, 512
  s_add_u32 s78, s78, 64
  s_sub_u32 s45, s45, 8
  s_andn2_b32 s43, s43, 0x100
LI_end_Xrf0:
  v_mfma_f32_16x16x32_bf16 v[92:95], v[52:55], v[32:35], v[92:95]
  v_mfma_f32_16x16x32_bf16 v[108:111], v[52:55], v[36:39], v[108:111]
  v_mfma_f32_16x16x32_bf16 v[124:127], v[52:55], v[40:43], v[124:127]
  v_mfma_f32_16x16x32_bf16 v[140:143], v[52:55], v[44:47], v[140:143]
XJOIN_0:
  s_bitcmp1_b32 s52, 9
  s_cbranch_scc1 XEPI_0
XLOOP_1:
  s_mov_b32 s52, s47
  s_bitcmp1_b32 s52, 11
  s_cbranch_scc1 K2_fin
  ds_read_u16 v56, v13 offset:61888
  ds_read_u16 v57, v13 offset:61920
  ds_read_b128 v[64:67], v11 offset:1600
  ds_read_b128 v[68:71], v11 offset:1664
  ds_read_b128 v[72:75], v11 offset:1728
  ds_read_b128 v[76:79], v11 offset:1792
  s_add_u32 s80, s51, s49
  s_cmp_lt_u32 s80, 16
  s_cbranch_scc1 WS_X1
  s_waitcnt vmcnt(16)
WD_X1:
  s_and_b32 s81, s52, 0x1100
  s_cbranch_scc1 XDISP_1
  s_waitcnt lgkmcnt(4)
  v_lshl_add_u32 v56, v56, 5, v5
  v_lshl_add_u32 v57, v57, 5, v5
  ds_read_b64_tr_b16 v[32:33], v56
  ds_read_b64_tr_b16 v[34:35], v57
  v_perm_b32 v48, v198, v194, s57
  v_perm_b32 v49, v206, v202, s57
  v_perm_b32 v50, v214, v210, s57
  v_perm_b32 v51, v222, v218, s57
  v_perm_b32 v52, v198, v194, s58
  v_perm_b32 v53, v206, v202, s58
  v_perm_b32 v54, v214, v210, s58
  v_perm_b32 v55, v222, v218, s58
  s_waitcnt lgkmcnt(0)
  v_mfma_f32_16x16x32_bf16 v[144:147], v[32:35], v[48:51], v[144:147]
  v_lshlrev_b32 v56, 16, v32
  v_and_b32 v57, 0xffff0000, v32
  v_lshlrev_b32 v58, 16, v33
  v_mfma_f32_16x16x32_bf16 v[148:151], v[32:35], v[52:55], v[148:151]
  v_and_b32 v59, 0xffff0000, v33
  v_lshlrev_b32 v60, 16, v34
  v_and_b32 v61, 0xffff0000, v34
  v_lshlrev_b32 v62, 16, v35
  v_and_b32 v63, 0xffff0000, v35
  v_mul_f32 v64, v64, v56
  v_mul_f32 v65, v65, v56
  v_mul_f32 v66, v66, v56
  v_mul_f32 v68, v68, v57
  v_mul_f32 v69, v69, v57
  v_mul_f32 v70, v70, v57
  v_mul_f32 v72, v72, v58
  v_mul_f32 v73, v73, v58
  v_mul_f32 v74, v74, v58
  v_mul_f32 v76, v76, v59
  v_mul_f32 v77, v77, v59
  v_mul_f32 v78, v78, v59
  v_cvt_pk_bf16_f32 v36, v64, v68
  v_cvt_pk_bf16_f32 v37, v72, v76
  v_cvt_pk_bf16_f32 v40, v65, v69
  v_cvt_pk_bf16_f32 v41, v73, v77
  v_cvt_pk_bf16_f32 v44, v66, v70
  v_cvt_pk_bf16_f32 v45, v74, v78
  ds_read_b128 v[64:67], v11 offset:1856
  ds_read_b128 v[68:71], v11 offset:1920
  ds_read_b128 v[72:75], v11 offset:1984
  ds_read_b128 v[76:79], v11 offset:2048
  v_add_u32 v11, s44, v2
  v_add_u32 v13, s78, v3
  ds_read_b32 v16, v11 offset:1612
  ds_read_b32 v18, v11 offset:1676
  ds_read_b32 v20, v11 offset:1740
  ds_read_b32 v22, v11 offset:1804
  ds_read_b32 v24, v11 offset:1868
  ds_read_b32 v26, v11 offset:1932
  ds_read_b32 v28, v11 offset:1996
  ds_read_b32 v30, v11 offset:2060
  v_perm_b32 v48, v199, v195, s57
  v_perm_b32 v49, v207, v203, s57
  v_perm_b32 v50, v215, v211, s57
  v_perm_b32 v51, v223, v219, s57
  v_perm_b32 v52, v199, v195, s58
  v_perm_b32 v53, v207, v203, s58
  v_perm_b32 v54, v215, v211, s58
  v_perm_b32 v55, v223, v219, s58
  s_waitcnt lgkmcnt(8)
  v_mfma_f32_16x16x32_bf16 v[152:155], v[32:35], v[48:51], v[152:155]
  v_mul_f32 v64, v64, v60
  v_mul_f32 v65, v65, v60
  v_mul_f32 v66, v66, v60
  v_mfma_f32_16x16x32_bf16 v[156:159], v[32:35], v[52:55], v[156:159]
  v_mul_f32 v68, v68, v61
  v_mul_f32 v69, v69, v61
  v_mul_f32 v70, v70, v61
  v_mul_f32 v72, v72, v62
  v_mul_f32 v73, v73, v62
  v_mul_f32 v74, v74, v62
  v_mul_f32 v76, v76, v63
  v_mul_f32 v77, v77, v63
  v_mul_f32 v78, v78, v63
  v_cvt_pk_bf16_f32 v38, v64, v68
  v_cvt_pk_bf16_f32 v39, v72, v76
  v_cvt_pk_bf16_f32 v42, v65, v69
  v_cvt_pk_bf16_f32 v43, v73, v77
  v_cvt_pk_bf16_f32 v46, v66, v70
  v_cvt_pk_bf16_f32 v47, v74, v78
  v_perm_b32 v48, v196, v192, s57
  v_perm_b32 v49, v204, v200, s57
  v_perm_b32 v50, v212, v208, s57
  v_perm_b32 v51, v220, v216, s57
  s_nop 1
  v_mfma_f32_16x16x32_bf16 v[80:83], v[48:51], v[32:35], v[80:83]
  v_perm_b32 v52, v196, v192, s58
  v_mfma_f32_16x16x32_bf16 v[96:99], v[48:51], v[36:39], v[96:99]
  v_perm_b32 v53, v204, v200, s58
  v_mfma_f32_16x16x32_bf16 v[112:115], v[48:51], v[40:43], v[112:115]
  v_perm_b32 v54, v212, v208, s58
  v_mfma_f32_16x16x32_bf16 v[128:131], v[48:51], v[44:47], v[128:131]
  v_perm_b32 v55, v220, v216, s58
  s_nop 1
  v_mfma_f32_16x16x32_bf16 v[84:87], v[52:55], v[32:35], v[84:87]
  v_perm_b32 v48, v197, v193, s57
  v_mfma_f32_16x16x32_bf16 v[100:103], v[52:55], v[36:39], v[100:103]
  v_perm_b32 v49, v205, v201, s57
  v_mfma_f32_16x16x32_bf16 v[116:119], v[52:55], v[40:43], v[116:119]
  v_perm_b32 v50, v213, v209, s57
  v_mfma_f32_16x16x32_bf16 v[132:135], v[52:55], v[44:47], v[132:135]
  v_perm_b32 v51, v221, v217, s57
  s_nop 1
  v_mfma_f32_16x16x32_bf16 v[88:91], v[48:51], v[32:35], v[88:91]
  v_perm_b32 v52, v197, v193, s58
  v_mfma_f32_16x16x32_bf16 v[104:107], v[48:51], v[36:39], v[104:107]
  v_perm_b32 v53, v205, v201, s58
  v_mfma_f32_16x16x32_bf16 v[120:123], v[48:51], v[40:43], v[120:123]
  v_perm_b32 v54, v213, v209, s58
  v_mfma_f32_16x16x32_bf16 v[136:139], v[48:51], v[44:47], v[136:139]
  v_perm_b32 v55, v221, v217, s58
  s_waitcnt lgkmcnt(0)
  s_bitcmp1_b32 s43, 11
  s_cbranch_scc1 LI_dead_Xrf1
  s_cmp_lt_u32 s45, 8
  s_cbranch_scc1 LI_tail_Xrf1
  buffer_load_dwordx4 v[192:195], v[16:17], s[12:15], 0 idxen offen sc1
  buffer_load_dwordx4 v[196:199], v[18:19], s[12:15], 0 idxen offen sc1
  buffer_load_dwordx4 v[200:203], v[20:21], s[12:15], 0 idxen offen sc1
  buffer_load_dwordx4 v[204:207], v[22:23], s[12:15], 0 idxen offen sc1
  buffer_load_dwordx4 v[208:211], v[24:25], s[12:15], 0 idxen offen sc1
  buffer_load_dwordx4 v[212:215], v[26:27], s[12:15], 0 idxen offen sc1
  buffer_load_dwordx4 v[216:219], v[28:29], s[12:15], 0 idxen offen sc1
  buffer_load_dwordx4 v[220:223], v[30:31], s[12:15], 0 idxen offen sc1
  s_mov_b32 s47, s43
  s_movk_i32 s50, 8
  s_add_u32 s53, s53, 8
  s_cmp_eq_u32 s45, 8
  s_cbranch_scc1 LI_last_Xrf1
  s_add_u32 s44, s44, 512
  s_add_u32 s78, s78, 64
  s_sub_u32 s45, s45, 8
  s_andn2_b32 s43, s43, 0x100
LI_end_Xrf1:
  v_mfma_f32_16x16x32_bf16 v[92:95], v[52:55], v[32:35], v[92:95]
  v_mfma_f32_16x16x32_bf16 v[108:111], v[52:55], v[36:39], v[108:111]
  v_mfma_f32_16x16x32_bf16 v[124:127], v[52:55], v[40:43], v[124:127]
  v_mfma_f32_16x16x32_bf16 v[140:143], v[52:55], v[44:47], v[140:143]
XJOIN_1:
  s_bitcmp1_b32 s52, 9
  s_cbranch_scc1 XEPI_1
XLOOP_2:
  s_mov_b32 s52, s48
  s_bitcmp1_b32 s52, 11
  s_cbranch_scc1 K2_fin
  ds_read_u16 v56, v9 offset:61888
  ds_read_u16 v57, v9 offset:61920
  ds_read_b128 v[64:67], v12 offset:1600
  ds_read_b128 v[68:71], v12 offset:1664
  ds_read_b128 v[72:75], v12 offset:1728
  ds_read_b128 v[76:79], v12 offset:1792
  s_add_u32 s80, s49, s50
  s_cmp_lt_u32 s80, 16
  s_cbranch_scc1 WS_X2
  s_waitcnt vmcnt(16)
WD_X2:
  s_and_b32 s81, s52, 0x1100
  s_cbranch_scc1 XDISP_2
  s_waitcnt lgkmcnt(4)
  v_lshl_add_u32 v56, v56, 5, v5
  v_lshl_add_u32 v57, v57, 5, v5
  ds_read_b64_tr_b16 v[32:33], v56
  ds_read_b64_tr_b16 v[34:35], v57
  v_perm_b32 v48, v230, v226, s57
  v_perm_b32 v49, v238, v234, s57
  v_perm_b32 v50, v246, v242, s57
  v_perm_b32 v51, v254, v250, s57
  v_perm_b32 v52, v230, v226, s58
  v_perm_b32 v53, v238, v234, s58
  v_perm_b32 v54, v246, v242, s58
  v_perm_b32 v55, v254, v250, s58
  s_waitcnt lgkmcnt(0)
  v_mfma_f32_16x16x32_bf16 v[144:147], v[32:35], v[48:51], v[144:147]
  v_lshlrev_b32 v56, 16, v32
  v_and_b32 v57, 0xffff0000, v32
  v_lshlrev_b32 v58, 16, v33
  v_mfma_f32_16x16x32_bf16 v[148:151], v[32:35], v[52:55], v[148:151]
  v_and_b32 v59, 0xffff0000, v33
  v_lshlrev_b32 v60, 16, v34
  v_and_b32 v61, 0xffff0000, v34
  v_lshlrev_b32 v62, 16, v35
  v_and_b32 v63, 0xffff0000, v35
  v_mul_f32 v64, v64, v56
  v_mul_f32 v65, v65, v56
  v_mul_f32 v66, v66, v56
  v_mul_f32 v68, v68, v57
  v_mul_f32 v69, v69, v57
  v_mul_f32 v70, v70, v57
  v_mul_f32 v72, v72, v58
  v_mul_f32 v73, v73, v58
  v_mul_f32 v74, v74, v58
  v_mul_f32 v76, v76, v59
  v_mul_f32 v77, v77, v59
  v_mul_f32 v78, v78, v59
  v_cvt_pk_bf16_f32 v36, v64, v68
  v_cvt_pk_bf16_f32 v37, v72, v76
  v_cvt_pk_bf16_f32 v40, v65, v69
  v_cvt_pk_bf16_f32 v41, v73, v77
  v_cvt_pk_bf16_f32 v44, v66, v70
  v_cvt_pk_bf16_f32 v45, v74, v78
  ds_read_b128 v[64:67], v12 offset:1856
  ds_read_b128 v[68:71], v12 offset:1920
  ds_read_b128 v[72:75], v12 offset:1984
  ds_read_b128 v[76:79], v12 offset:2048
  v_add_u32 v12, s44, v2
  v_add_u32 v9, s78, v3
  ds_read_b32 v16, v12 offset:1612
  ds_read_b32 v18, v12 offset:1676
  ds_read_b32 v20, v12 offset:1740
  ds_read_b32 v22, v12 offset:1804
  ds_read_b32 v24, v12 offset:1868
  ds_read_b32 v26, v12 offset:1932
  ds_read_b32 v28, v12 offset:1996
  ds_read_b32 v30, v12 offset:2060
  v_perm_b32 v48, v231, v227, s57
  v_perm_b32 v49, v239, v235, s57
  v_perm_b32 v50, v247, v243, s57
  v_perm_b32 v51, v255, v251, s57
  v_perm_b32 v52, v231, v227, s58
  v_perm_b32 v53, v239, v235, s58
  v_perm_b32 v54, v247, v243, s58
  v_perm_b32 v55, v255, v251, s58
  s_waitcnt lgkmcnt(8)
  v_mfma_f32_16x16x32_bf16 v[152:155], v[32:35], v[48:51], v[152:155]
  v_mul_f32 v64, v64, v60
  v_mul_f32 v65, v65, v60
  v_mul_f32 v66, v66, v60
  v_mfma_f32_16x16x32_bf16 v[156:159], v[32:35], v[52:55], v[156:159]
  v_mul_f32 v68, v68, v61
  v_mul_f32 v69, v69, v61
  v_mul_f32 v70, v70, v61
  v_mul_f32 v72, v72, v62
  v_mul_f32 v73, v73, v62
  v_mul_f32 v74, v74, v62
  v_mul_f32 v76, v76, v63
  v_mul_f32 v77, v77, v63
  v_mul_f32 v78, v78, v63
  v_cvt_pk_bf16_f32 v38, v64, v68
  v_cvt_pk_bf16_f32 v39, v72, v76
  v_cvt_pk_bf16_f32 v42, v65, v69
  v_cvt_pk_bf16_f32 v43, v73, v77
  v_cvt_pk_bf16_f32 v46, v66, v70
  v_cvt_pk_bf16_f32 v47, v74, v78
  v_perm_b32 v48, v228, v224, s57
  v_perm_b32 v49, v236, v232, s57
  v_perm_b32 v50, v244, v240, s57
  v_perm_b32 v51, v252, v248, s57
  s_nop 1
  v_mfma_f32_16x16x32_bf16 v[80:83], v[48:51], v[32:35], v[80:83]
  v_perm_b32 v52, v228, v224, s58
  v_mfma_f32_16x16x32_bf16 v[96:99], v[48:51], v[36:39], v[96:99]
  v_perm_b32 v53, v236, v232, s58
  v_mfma_f32_16x16x32_bf16 v[112:115], v[48:51], v[40:43], v[112:115]
  v_perm_b32 v54, v244, v240, s58
  v_mfma_f32_16x16x32_bf16 v[128:131], v[48:51], v[44:47], v[128:131]
  v_perm_b32 v55, v252, v248, s58
  s_nop 1
  v_mfma_f32_16x16x32_bf16 v[84:87], v[52:55], v[32:35], v[84:87]
  v_perm_b32 v48, v229, v225, s57
  v_mfma_f32_16x16x32_bf16 v[100:103], v[52:55], v[36:39], v[100:103]
  v_perm_b32 v49, v237, v233, s57
  v_mfma_f32_16x16x32_bf16 v[116:119], v[52:55], v[40:43], v[116:119]
  v_perm_b32 v50, v245, v241, s57
  v_mfma_f32_16x16x32_bf16 v[132:135], v[52:55], v[44:47], v[132:135]
  v_perm_b32 v51, v253, v249, s57
  s_nop 1
  v_mfma_f32_16x16x32_bf16 v[88:91], v[48:51], v[32:35], v[88:91]
  v_perm_b32 v52, v229, v225, s58
  v_mfma_f32_16x16x32_bf16 v[104:107], v[48:51], v[36:39], v[104:107]
  v_perm_b32 v53, v237, v233, s58
  v_mfma_f32_16x16x32_bf16 v[120:123], v[48:51], v[40:43], v[120:123]
  v_perm_b32 v54, v245, v241, s58
  v_mfma_f32_16x16x32_bf16 v[136:139], v[48:51], v[44:47], v[136:139]
  v_perm_b32 v55, v253, v249, s58
  s_waitcnt lgkmcnt(0)
  s_bitcmp1_b32 s43, 11
  s_cbranch_scc1 LI_dead_Xrf2
  s_cmp_lt_u32 s45, 8
  s_cbranch_scc1 LI_tail_Xrf2
  buffer_load_dwordx4 v[224:227], v[16:17], s[12:15], 0 idxen offen sc1
  buffer_load_dwordx4 v[228:231], v[18:19], s[12:15], 0 idxen offen sc1
  buffer_load_dwordx4 v[232:235], v[20:21], s[12:15], 0 idxen offen sc1
  buffer_load_dwordx4 v[236:239], v[22:23], s[12:15], 0 idxen offen sc1
  buffer_load_dwordx4 v[240:243], v[24:25], s[12:15], 0 idxen offen sc1
  buffer_load_dwordx4 v[244:247], v[26:27], s[12:15], 0 idxen offen sc1
  buffer_load_dwordx4 v[248:251], v[28:29], s[12:15], 0 idxen offen sc1
  buffer_load_dwordx4 v[252:255], v[30:31], s[12:15], 0 idxen offen sc1
  s_mov_b32 s48, s43
  s_movk_i32 s51, 8
  s_add_u32 s53, s53, 8
  s_cmp_eq_u32 s45, 8
  s_cbranch_scc1 LI_last_Xrf2
  s_add_u32 s44, s44, 512
  s_add_u32 s78, s78, 64
  s_sub_u32 s45, s45, 8
  s_andn2_b32 s43, s43, 0x100
LI_end_Xrf2:
  v_mfma_f32_16x16x32_bf16 v[92:95], v[52:55], v[32:35], v[92:95]
  v_mfma_f32_16x16x32_bf16 v[108:111], v[52:55], v[36:39], v[108:111]
  v_mfma_f32_16x16x32_bf16 v[124:127], v[52:55], v[40:43], v[124:127]
  v_mfma_f32_16x16x32_bf16 v[140:143], v[52:55], v[44:47], v[140:143]
XJOIN_2:
  s_bitcmp1_b32 s52, 9
  s_cbranch_scc1 XEPI_2
  s_branch XLOOP_0
K2_fin:
  s_bitcmp1_b32 s79, 1
  s_cbranch_scc1 K2_more
K2_exit:
  s_endpgm
K2_toosmall:
  s_movk_i32 s54, 48
  s_waitcnt vmcnt(0)
  s_barrier
  s_branch K2_redo
K2_more:
  s_waitcnt vmcnt(0) lgkmcnt(0)
  s_barrier
  s_add_u32 s62, s62, s54
K2_redo:
  v_and_b32 v11, 63, v0
  v_lshlrev_b32 v15, 4, v11
  s_lshl_b32 s81, s40, 10
  s_add_u32 s82, s81, 1600
  s_mov_b32 m0, s82
  s_add_u32 s82, s82, 8192
  buffer_load_dwordx4 v15, s[32:35], s81 offen lds
  s_add_u32 s81, s81, 8192
  s_mov_b32 m0, s82
  s_add_u32 s82, s82, 8192
  buffer_load_dwordx4 v15, s[32:35], s81 offen lds
  s_add_u32 s81, s81, 8192
  s_mov_b32 m0, s82
  s_add_u32 s82, s82, 8192
  buffer_load_dwordx4 v15, s[32:35], s81 offen lds
  s_add_u32 s81, s81, 8192
  s_mov_b32 m0, s82
  s_add_u32 s82, s82, 8192
  buffer_load_dwordx4 v15, s[32:35], s81 offen lds
  s_add_u32 s81, s81, 8192
  s_mov_b32 m0, s82
  s_add_u32 s82, s82, 8192
  buffer_load_dwordx4 v15, s[32:35], s81 offen lds
  s_add_u32 s81, s81, 8192
  s_mov_b32 m0, s82
  s_add_u32 s82, s82, 8192
  buffer_load_dwordx4 v15, s[32:35], s81 offen lds
  s_add_u32 s81, s81, 8192
  s_mov_b32 m0, s82
  s_add_u32 s82, s82, 8192
  buffer_load_dwordx4 v15, s[32:35], s81 offen lds
  s_add_u32 s81, s81, 8192
  s_mov_b32 m0, s82
  s_add_u32 s82, s82, 8192
  buffer_load_dwordx4 v15, s[32:35], s81 offen lds
  s_add_u32 s81, s81, 8192
  s_mov_b32 m0, s82
  s_add_u32 s82, s82, 8192
  buffer_load_dwordx4 v15, s[32:35], s81 offen lds
  s_add_u32 s81, s81, 8192
  s_cmp_ge_u32 s40, 2
  s_cbranch_scc1 K2_posdone2
  s_mov_b32 m0, s82
  s_add_u32 s82, s82, 8192
  buffer_load_dwordx4 v15, s[32:35], s81 offen lds
  s_add_u32 s81, s81, 8192
K2_posdone2:
  s_branch K2_batch
K2_small_0:
  s_mov_b64 exec, vcc
  v_mov_b32 v152, 14546
  v_cmp_eq_u32 vcc, v152, v146
  v_mov_b32 v152, 960
  s_nop 0
  v_cndmask_b32 v120, v120, v152, vcc
  s_andn2_b64 exec, exec, vcc
  s_cbranch_execz K2_smalldone_0
  v_mov_b32 v153, 0
  ds_add_rtn_u32 v152, v153, v138 offset:516
  v_subrev_u32 v153, 14464, v146
  v_lshlrev_b32 v153, 5, v153
  s_waitcnt lgkmcnt(0)
  v_cmp_gt_u32 vcc, 56, v152
  s_nop 1
  s_and_b64 exec, exec, vcc
  s_cbranch_execz K2_smalldone_0
  buffer_load_dwordx4 v[156:159], v153, s[16:19], 0 offen sc1
  v_add_u32 v120, 961, v152
  v_lshlrev_b32 v152, 5, v120
  v_add_u32 v152, 131232, v152
  s_waitcnt vmcnt(0)
  ds_write_b128 v152, v[156:159]
  s_waitcnt lgkmcnt(0)
  buffer_load_dwordx4 v[156:159], v153, s[16:19], 0 offen offset:16 sc1
  s_waitcnt vmcnt(0)
  ds_write_b128 v152, v[156:159] offset:16
K2_smalldone_0:
  s_mov_b64 exec, -1
  s_branch K2_smallret_0
K2_small_1:
  s_mov_b64 exec, vcc
  v_mov_b32 v152, 14546
  v_cmp_eq_u32 vcc, v152, v150
  v_mov_b32 v152, 960
  s_nop 0
  v_cndmask_b32 v121, v121, v152, vcc
  s_andn2_b64 exec, exec, vcc
  s_cbranch_execz K2_smalldone_1
  v_mov_b32 v153, 0
  ds_add_rtn_u32 v152, v153, v138 offset:516
  v_subrev_u32 v153, 14464, v150
  v_lshlrev_b32 v153, 5, v153
  s_waitcnt lgkmcnt(0)
  v_cmp_gt_u32 vcc, 56, v152
  s_nop 1
  s_and_b64 exec, exec, vcc
  s_cbranch_execz K2_smalldone_1
  buffer_load_dwordx4 v[156:159], v153, s[16:19], 0 offen sc1
  v_add_u32 v121, 961, v152
  v_lshlrev_b32 v152, 5, v121
  v_add_u32 v152, 131232, v152
  s_waitcnt vmcnt(0)
  ds_write_b128 v152, v[156:159]
  s_waitcnt lgkmcnt(0)
  buffer_load_dwordx4 v[156:159], v153, s[16:19], 0 offen offset:16 sc1
  s_waitcnt vmcnt(0)
  ds_write_b128 v152, v[156:159] offset:16
K2_smalldone_1:
  s_mov_b64 exec, -1
  s_branch K2_smallret_1
K2_small_2:
  s_mov_b64 exec, vcc
  v_mov_b32 v152, 14546
  v_cmp_eq_u32 vcc, v152, v146
  v_mov_b32 v152, 960
  s_nop 0
  v_cndmask_b32 v122, v122, v152, vcc
  s_andn2_b64 exec, exec, vcc
  s_cbranch_execz K2_smalldone_2
  v_mov_b32 v153, 0
  ds_add_rtn_u32 v152, v153, v138 offset:516
  v_subrev_u32 v153, 14464, v146
  v_lshlrev_b32 v153, 5, v153
  s_waitcnt lgkmcnt(0)
  v_cmp_gt_u32 vcc, 56, v152
  s_nop 1
  s_and_b64 exec, exec, vcc
  s_cbranch_execz K2_smalldone_2
  buffer_load_dwordx4 v[156:159], v153, s[16:19], 0 offen sc1
  v_add_u32 v122, 961, v152
  v_lshlrev_b32 v152, 5, v122
  v_add_u32 v152, 131232, v152
  s_waitcnt vmcnt(0)
  ds_write_b128 v152, v[156:159]
  s_waitcnt lgkmcnt(0)
  buffer_load_dwordx4 v[156:159], v153, s[16:19], 0 offen offset:16 sc1
  s_waitcnt vmcnt(0)
  ds_write_b128 v152, v[156:159] offset:16
K2_smalldone_2:
  s_mov_b64 exec, -1
  s_branch K2_smallret_2
K2_small_3:
  s_mov_b64 exec, vcc
  v_mov_b32 v152, 14546
  v_cmp_eq_u32 vcc, v152, v150
  v_mov_b32 v152, 960
  s_nop 0
  v_cndmask_b32 v123, v123, v152, vcc
  s_andn2_b64 exec, exec, vcc
  s_cbranch_execz K2_smalldone_3
  v_mov_b32 v153, 0
  ds_add_rtn_u32 v152, v153, v138 offset:516
  v_subrev_u32 v153, 14464, v150
  v_lshlrev_b32 v153, 5, v153
  s_waitcnt lgkmcnt(0)
  v_cmp_gt_u32 vcc, 56, v152
  s_nop 1
  s_and_b64 exec, exec, vcc
  s_cbranch_execz K2_smalldone_3
  buffer_load_dwordx4 v[156:159], v153, s[16:19], 0 offen sc1
  v_add_u32 v123, 961, v152
  v_lshlrev_b32 v152, 5, v123
  v_add_u32 v152, 131232, v152
  s_waitcnt vmcnt(0)
  ds_write_b128 v152, v[156:159]
  s_waitcnt lgkmcnt(0)
  buffer_load_dwordx4 v[156:159], v153, s[16:19], 0 offen offset:16 sc1
  s_waitcnt vmcnt(0)
  ds_write_b128 v152, v[156:159] offset:16
K2_smalldone_3:
  s_mov_b64 exec, -1
  s_branch K2_smallret_3
K2_small_4:
  s_mov_b64 exec, vcc
  v_mov_b32 v152, 14546
  v_cmp_eq_u32 vcc, v152, v146
  v_mov_b32 v152, 960
  s_nop 0
  v_cndmask_b32 v124, v124, v152, vcc
  s_andn2_b64 exec, exec, vcc
  s_cbranch_execz K2_smalldone_4
  v_mov_b32 v153, 0
  ds_add_rtn_u32 v152, v153, v138 offset:516
  v_subrev_u32 v153, 14464, v146
  v_lshlrev_b32 v153, 5, v153
  s_waitcnt lgkmcnt(0)
  v_cmp_gt_u32 vcc, 56, v152
  s_nop 1
  s_and_b64 exec, exec, vcc
  s_cbranch_execz K2_smalldone_4
  buffer_load_dwordx4 v[156:159], v153, s[16:19], 0 offen sc1
  v_add_u32 v124, 961, v152
  v_lshlrev_b32 v152, 5, v124
  v_add_u32 v152, 131232, v152
  s_waitcnt vmcnt(0)
  ds_write_b128 v152, v[156:159]
  s_waitcnt lgkmcnt(0)
  buffer_load_dwordx4 v[156:159], v153, s[16:19], 0 offen offset:16 sc1
  s_waitcnt vmcnt(0)
  ds_write_b128 v152, v[156:159] offset:16
K2_smalldone_4:
  s_mov_b64 exec, -1
  s_branch K2_smallret_4
K2_small_5:
  s_mov_b64 exec, vcc
  v_mov_b32 v152, 14546
  v_cmp_eq_u32 vcc, v152, v150
  v_mov_b32 v152, 960
  s_nop 0
  v_cndmask_b32 v125, v125, v152, vcc
  s_andn2_b64 exec, exec, vcc
  s_cbranch_execz K2_smalldone_5
  v_mov_b32 v153, 0
  ds_add_rtn_u32 v152, v153, v138 offset:516
  v_subrev_u32 v153, 14464, v150
  v_lshlrev_b32 v153, 5, v153
  s_waitcnt lgkmcnt(0)
  v_cmp_gt_u32 vcc, 56, v152
  s_nop 1
  s_and_b64 exec, exec, vcc
  s_cbranch_execz K2_smalldone_5
  buffer_load_dwordx4 v[156:159], v153, s[16:19], 0 offen sc1
  v_add_u32 v125, 961, v152
  v_lshlrev_b32 v152, 5, v125
  v_add_u32 v152, 131232, v152
  s_waitcnt vmcnt(0)
  ds_write_b128 v152, v[156:159]
  s_waitcnt lgkmcnt(0)
  buffer_load_dwordx4 v[156:159], v153, s[16:19], 0 offen offset:16 sc1
  s_waitcnt vmcnt(0)
  ds_write_b128 v152, v[156:159] offset:16
K2_smalldone_5:
  s_mov_b64 exec, -1
  s_branch K2_smallret_5
K2_small_6:
  s_mov_b64 exec, vcc
  v_mov_b32 v152, 14546
  v_cmp_eq_u32 vcc, v152, v146
  v_mov_b32 v152, 960
  s_nop 0
  v_cndmask_b32 v126, v126, v152, vcc
  s_andn2_b64 exec, exec, vcc
  s_cbranch_execz K2_smalldone_6
  v_mov_b32 v153, 0
  ds_add_rtn_u32 v152, v153, v138 offset:516
  v_subrev_u32 v153, 14464, v146
  v_lshlrev_b32 v153, 5, v153
  s_waitcnt lgkmcnt(0)
  v_cmp_gt_u32 vcc, 56, v152
  s_nop 1
  s_and_b64 exec, exec, vcc
  s_cbranch_execz K2_smalldone_6
  buffer_load_dwordx4 v[156:159], v153, s[16:19], 0 offen sc1
  v_add_u32 v126, 961, v152
  v_lshlrev_b32 v152, 5, v126
  v_add_u32 v152, 131232, v152
  s_waitcnt vmcnt(0)
  ds_write_b128 v152, v[156:159]
  s_waitcnt lgkmcnt(0)
  buffer_load_dwordx4 v[156:159], v153, s[16:19], 0 offen offset:16 sc1
  s_waitcnt vmcnt(0)
  ds_write_b128 v152, v[156:159] offset:16
K2_smalldone_6:
  s_mov_b64 exec, -1
  s_branch K2_smallret_6
NS_end_init:
  s_cmp_eq_u32 s56, 0x100
  s_cbranch_scc0 NS_dead_init
  s_movk_i32 s56, 0x500
  s_mov_b32 s55, 0
  s_mov_b32 s12, s36
  s_mov_b32 s13, s37
  s_branch NS_top_init
NS_dead_init:
  s_movk_i32 s56, 0x800
  s_movk_i32 s43, 0x800
  s_mov_b32 s45, 0
  s_mov_b32 s44, 0
  s_mov_b32 s78, 0
  s_branch NS_initdone
LI_dead_fill0:
  s_movk_i32 s46, 0x800
  s_mov_b32 s49, 0
  s_branch LI_end_fill0
LI_tail_fill0:
  s_mov_b32 s49, s45
  s_add_u32 s53, s53, s45
  s_cmp_le_u32 s45, 4
  s_cselect_b32 s81, 0x1000, 0
  s_or_b32 s46, s43, s81
  s_cmp_le_u32 s45, 0
  s_cbranch_scc1 LI_last_fill0
  buffer_load_dwordx4 v[160:163], v[16:17], s[12:15], 0 idxen offen sc1
  s_cmp_le_u32 s45, 1
  s_cbranch_scc1 LI_last_fill0
  buffer_load_dwordx4 v[164:167], v[18:19], s[12:15], 0 idxen offen sc1
  s_cmp_le_u32 s45, 2
  s_cbranch_scc1 LI_last_fill0
  buffer_load_dwordx4 v[168:171], v[20:21], s[12:15], 0 idxen offen sc1
  s_cmp_le_u32 s45, 3
  s_cbranch_scc1 LI_last_fill0
  buffer_load_dwordx4 v[172:175], v[22:23], s[12:15], 0 idxen offen sc1
  s_cmp_le_u32 s45, 4
  s_cbranch_scc1 LI_last_fill0
  buffer_load_dwordx4 v[176:179], v[24:25], s[12:15], 0 idxen offen sc1
  s_cmp_le_u32 s45, 5
  s_cbranch_scc1 LI_last_fill0
  buffer_load_dwordx4 v[180:183], v[26:27], s[12:15], 0 idxen offen sc1
  s_cmp_le_u32 s45, 6
  s_cbranch_scc1 LI_last_fill0
  buffer_load_dwordx4 v[184:187], v[28:29], s[12:15], 0 idxen offen sc1
LI_last_fill0:
  s_or_b32 s46, s46, 0x200
NS_top_fill0:
  s_bitcmp1_b32 s55, 0
  s_cselect_b32 s85, s73, s72
  s_mul_i32 s84, s55, s74
  s_add_u32 s84, s84, s85
  s_add_u32 s55, s55, 1
  s_cmp_ge_u32 s84, s75
  s_cbranch_scc1 NS_end_fill0
  v_readlane_b32 s85, v8, s84
  s_nop 1
  s_and_b32 s86, s85, 63
  s_or_b32 s43, s56, s86
  s_bfe_u32 s44, s85, 0xc0006
  s_lshl_b32 s44, s44, 4
  s_lshr_b32 s45, s85, 18
  v_readlane_b32 s78, v7, s84
  s_branch LI_end_fill0
NS_end_fill0:
  s_cmp_eq_u32 s56, 0x100
  s_cbranch_scc0 NS_dead_fill0
  s_movk_i32 s56, 0x500
  s_mov_b32 s55, 0
  s_mov_b32 s12, s36
  s_mov_b32 s13, s37
  s_branch NS_top_fill0
NS_dead_fill0:
  s_movk_i32 s56, 0x800
  s_movk_i32 s43, 0x800
  s_mov_b32 s45, 0
  s_mov_b32 s44, 0
  s_mov_b32 s78, 0
  s_branch LI_end_fill0
LI_dead_fill1:
  s_movk_i32 s47, 0x800
  s_mov_b32 s50, 0
  s_branch LI_end_fill1
LI_tail_fill1:
  s_mov_b32 s50, s45
  s_add_u32 s53, s53, s45
  s_cmp_le_u32 s45, 4
  s_cselect_b32 s81, 0x1000, 0
  s_or_b32 s47, s43, s81
  s_cmp_le_u32 s45, 0
  s_cbranch_scc1 LI_last_fill1
  buffer_load_dwordx4 v[192:195], v[16:17], s[12:15], 0 idxen offen sc1
  s_cmp_le_u32 s45, 1
  s_cbranch_scc1 LI_last_fill1
  buffer_load_dwordx4 v[196:199], v[18:19], s[12:15], 0 idxen offen sc1
  s_cmp_le_u32 s45, 2
  s_cbranch_scc1 LI_last_fill1
  buffer_load_dwordx4 v[200:203], v[20:21], s[12:15], 0 idxen offen sc1
  s_cmp_le_u32 s45, 3
  s_cbranch_scc1 LI_last_fill1
  buffer_load_dwordx4 v[204:207], v[22:23], s[12:15], 0 idxen offen sc1
  s_cmp_le_u32 s45, 4
  s_cbranch_scc1 LI_last_fill1
  buffer_load_dwordx4 v[208:211], v[24:25], s[12:15], 0 idxen offen sc1
  s_cmp_le_u32 s45, 5
  s_cbranch_scc1 LI_last_fill1
  buffer_load_dwordx4 v[212:215], v[26:27], s[12:15], 0 idxen offen sc1
  s_cmp_le_u32 s45, 6
  s_cbranch_scc1 LI_last_fill1
  buffer_load_dwordx4 v[216:219], v[28:29], s[12:15], 0 idxen offen sc1
LI_last_fill1:
  s_or_b32 s47, s47, 0x200
NS_top_fill1:
  s_bitcmp1_b32 s55, 0
  s_cselect_b32 s85, s73, s72
  s_mul_i32 s84, s55, s74
  s_add_u32 s84, s84, s85
  s_add_u32 s55, s55, 1
  s_cmp_ge_u32 s84, s75
  s_cbranch_scc1 NS_end_fill1
  v_readlane_b32 s85, v8, s84
  s_nop 1
  s_and_b32 s86, s85, 63
  s_or_b32 s43, s56, s86
  s_bfe_u32 s44, s85, 0xc0006
  s_lshl_b32 s44, s44, 4
  s_lshr_b32 s45, s85, 18
  v_readlane_b32 s78, v7, s84
  s_branch LI_end_fill1
NS_end_fill1:
  s_cmp_eq_u32 s56, 0x100
  s_cbranch_scc0 NS_dead_fill1
  s_movk_i32 s56, 0x500
  s_mov_b32 s55, 0
  s_mov_b32 s12, s36
  s_mov_b32 s13, s37
  s_branch NS_top_fill1
NS_dead_fill1:
  s_movk_i32 s56, 0x800
  s_movk_i32 s43, 0x800
  s_mov_b32 s45, 0
  s_mov_b32 s44, 0
  s_mov_b32 s78, 0
  s_branch LI_end_fill1
LI_dead_fill2:
  s_movk_i32 s48, 0x800
  s_mov_b32 s51, 0
  s_branch LI_end_fill2
LI_tail_fill2:
  s_mov_b32 s51, s45
  s_add_u32 s53, s53, s45
  s_cmp_le_u32 s45, 4
  s_cselect_b32 s81, 0x1000, 0
  s_or_b32 s48, s43, s81
  s_cmp_le_u32 s45, 0
  s_cbranch_scc1 LI_last_fill2
  buffer_load_dwordx4 v[224:227], v[16:17], s[12:15], 0 idxen offen sc1
  s_cmp_le_u32 s45, 1
  s_cbranch_scc1 LI_last_fill2
  buffer_load_dwordx4 v[228:231], v[18:19], s[12:15], 0 idxen offen sc1
  s_cmp_le_u32 s45, 2
  s_cbranch_scc1 LI_last_fill2
  buffer_load_dwordx4 v[232:235], v[20:21], s[12:15], 0 idxen offen sc1
  s_cmp_le_u32 s45, 3
  s_cbranch_scc1 LI_last_fill2
  buffer_load_dwordx4 v[236:239], v[22:23], s[12:15], 0 idxen offen sc1
  s_cmp_le_u32 s45, 4
  s_cbranch_scc1 LI_last_fill2
  buffer_load_dwordx4 v[240:243], v[24:25], s[12:15], 0 idxen offen sc1
  s_cmp_le_u32 s45, 5
  s_cbranch_scc1 LI_last_fill2
  buffer_load_dwordx4 v[244:247], v[26:27], s[12:15], 0 idxen offen sc1
  s_cmp_le_u32 s45, 6
  s_cbranch_scc1 LI_last_fill2
  buffer_load_dwordx4 v[248:251], v[28:29], s[12:15], 0 idxen offen sc1
LI_last_fill2:
  s_or_b32 s48, s48, 0x200
NS_top_fill2:
  s_bitcmp1_b32 s55, 0
  s_cselect_b32 s85, s73, s72
  s_mul_i32 s84, s55, s74
  s_add_u32 s84, s84, s85
  s_add_u32 s55, s55, 1
  s_cmp_ge_u32 s84, s75
  s_cbranch_scc1 NS_end_fill2
  v_readlane_b32 s85, v8, s84
  s_nop 1
  s_and_b32 s86, s85, 63
  s_or_b32 s43, s56, s86
  s_bfe_u32 s44, s85, 0xc0006
  s_lshl_b32 s44, s44, 4
  s_lshr_b32 s45, s85, 18
  v_readlane_b32 s78, v7, s84
  s_branch LI_end_fill2
NS_end_fill2:
  s_cmp_eq_u32 s56, 0x100
  s_cbranch_scc0 NS_dead_fill2
  s_movk_i32 s56, 0x500
  s_mov_b32 s55, 0
  s_mov_b32 s12, s36
  s_mov_b32 s13, s37
  s_branch NS_top_fill2
NS_dead_fill2:
  s_movk_i32 s56, 0x800
  s_movk_i32 s43, 0x800
  s_mov_b32 s45, 0
  s_mov_b32 s44, 0
  s_mov_b32 s78, 0
  s_branch LI_end_fill2
XENTER_0:
  s_cmp_lt_u32 s40, 4
  s_cbranch_scc1 XLOOP_0
  s_setprio 1
  s_branch XLOOP_0
WS_Y0:
  s_cmp_lt_u32 s80, 13
  s_cbranch_scc1 WS13_Y0
  s_waitcnt vmcnt(13)
  s_branch WD_Y0
WS13_Y0:
  s_cmp_lt_u32 s80, 10
  s_cbranch_scc1 WS10_Y0
  s_waitcnt vmcnt(10)
  s_branch WD_Y0
WS10_Y0:
  s_cmp_lt_u32 s80, 8
  s_cbranch_scc1 WS8_Y0
  s_waitcnt vmcnt(8)
  s_branch WD_Y0
WS8_Y0:
  s_cmp_lt_u32 s80, 5
  s_cbranch_scc1 WS5_Y0
  s_waitcnt vmcnt(5)
  s_branch WD_Y0
WS5_Y0:
  s_cmp_lt_u32 s80, 2
  s_cbranch_scc1 WS2_Y0
  s_waitcnt vmcnt(2)
  s_branch WD_Y0
WS2_Y0:
  s_waitcnt vmcnt(0)
  s_branch WD_Y0
LI_dead_Yrf0:
  s_movk_i32 s46, 0x800
  s_mov_b32 s49, 0
  s_branch LI_end_Yrf0
LI_tail_Yrf0:
  s_mov_b32 s49, s45
  s_add_u32 s53, s53, s45
  s_cmp_le_u32 s45, 4
  s_cselect_b32 s81, 0x1000, 0
  s_or_b32 s46, s43, s81
  s_cmp_le_u32 s45, 0
  s_cbranch_scc1 LI_last_Yrf0
  buffer_load_dwordx4 v[160:163], v[16:17], s[12:15], 0 idxen offen sc1
  s_cmp_le_u32 s45, 1
  s_cbranch_scc1 LI_last_Yrf0
  buffer_load_dwordx4 v[164:167], v[18:19], s[12:15], 0 idxen offen sc1
  s_cmp_le_u32 s45, 2
  s_cbranch_scc1 LI_last_Yrf0
  buffer_load_dwordx4 v[168:171], v[20:21], s[12:15], 0 idxen offen sc1
  s_cmp_le_u32 s45, 3
  s_cbranch_scc1 LI_last_Yrf0
  buffer_load_dwordx4 v[172:175], v[22:23], s[12:15], 0 idxen offen sc1
  s_cmp_le_u32 s45, 4
  s_cbranch_scc1 LI_last_Yrf0
  buffer_load_dwordx4 v[176:179], v[24:25], s[12:15], 0 idxen offen sc1
  s_cmp_le_u32 s45, 5
  s_cbranch_scc1 LI_last_Yrf0
  buffer_load_dwordx4 v[180:183], v[26:27], s[12:15], 0 idxen offen sc1
  s_cmp_le_u32 s45, 6
  s_cbranch_scc1 LI_last_Yrf0
  buffer_load_dwordx4 v[184:187], v[28:29], s[12:15], 0 idxen offen sc1
LI_last_Yrf0:
  s_or_b32 s46, s46, 0x200
NS_top_Yrf0:
  s_bitcmp1_b32 s55, 0
  s_cselect_b32 s85, s73, s72
  s_mul_i32 s84, s55, s74
  s_add_u32 s84, s84, s85
  s_add_u32 s55, s55, 1
  s_cmp_ge_u32 s84, s75
  s_cbranch_scc1 NS_end_Yrf0
  v_readlane_b32 s85, v8, s84
  s_nop 1
  s_and_b32 s86, s85, 63
  s_or_b32 s43, s56, s86
  s_bfe_u32 s44, s85, 0xc0006
  s_lshl_b32 s44, s44, 4
  s_lshr_b32 s45, s85, 18
  v_readlane_b32 s78, v7, s84
  s_branch LI_end_Yrf0
NS_end_Yrf0:
  s_cmp_eq_u32 s56, 0x100
  s_cbranch_scc0 NS_dead_Yrf0
  s_movk_i32 s56, 0x500
  s_mov_b32 s55, 0
  s_mov_b32 s12, s36
  s_mov_b32 s13, s37
  s_branch NS_top_Yrf0
NS_dead_Yrf0:
  s_movk_i32 s56, 0x800
  s_movk_i32 s43, 0x800
  s_mov_b32 s45, 0
  s_mov_b32 s44, 0
  s_mov_b32 s78, 0
  s_branch LI_end_Yrf0
YDISP_0:
  s_bitcmp1_b32 s52, 12
  s_cbranch_scc1 YH_0
  v_perm_b32 v48, v164, v160, s57
  v_perm_b32 v49, v172, v168, s57
  v_perm_b32 v50, v180, v176, s57
  v_perm_b32 v51, v188, v184, s57
  s_waitcnt lgkmcnt(0)
  v_lshl_add_u32 v56, v56, 5, v5
  v_lshl_add_u32 v57, v57, 5, v5
  ds_read_b64_tr_b16 v[32:33], v56
  ds_read_b64_tr_b16 v[34:35], v57
  v_add_u32 v10, s44, v2
  v_add_u32 v4, s78, v3
  ds_read_b32 v16, v10 offset:1612
  ds_read_b32 v18, v10 offset:1676
  ds_read_b32 v20, v10 offset:1740
  ds_read_b32 v22, v10 offset:1804
  ds_read_b32 v24, v10 offset:1868
  ds_read_b32 v26, v10 offset:1932
  ds_read_b32 v28, v10 offset:1996
  ds_read_b32 v30, v10 offset:2060
  v_perm_b32 v52, v164, v160, s58
  v_perm_b32 v53, v172, v168, s58
  v_perm_b32 v54, v180, v176, s58
  v_perm_b32 v55, v188, v184, s58
  v_perm_b32 v64, v165, v161, s57
  v_perm_b32 v65, v173, v169, s57
  v_perm_b32 v66, v181, v177, s57
  v_perm_b32 v67, v189, v185, s57
  v_perm_b32 v68, v165, v161, s58
  v_perm_b32 v69, v173, v169, s58
  v_perm_b32 v70, v181, v177, s58
  v_perm_b32 v71, v189, v185, s58
  s_waitcnt lgkmcnt(8)
  v_mfma_f32_16x16x32_bf16 v[80:83], v[32:35], v[48:51], 0
  v_perm_b32 v48, v166, v162, s57
  v_perm_b32 v49, v174, v170, s57
  v_perm_b32 v50, v182, v178, s57
  v_perm_b32 v51, v190, v186, s57
  v_mfma_f32_16x16x32_bf16 v[84:87], v[32:35], v[52:55], 0
  v_perm_b32 v52, v166, v162, s58
  v_perm_b32 v53, v174, v170, s58
  v_perm_b32 v54, v182, v178, s58
  v_perm_b32 v55, v190, v186, s58
  v_mfma_f32_16x16x32_bf16 v[88:91], v[32:35], v[64:67], 0
  v_perm_b32 v64, v167, v163, s57
  v_perm_b32 v65, v175, v171, s57
  v_perm_b32 v66, v183, v179, s57
  v_perm_b32 v67, v191, v187, s57
  v_mfma_f32_16x16x32_bf16 v[92:95], v[32:35], v[68:71], 0
  v_perm_b32 v68, v167, v163, s58
  v_perm_b32 v69, v175, v171, s58
  v_perm_b32 v70, v183, v179, s58
  v_perm_b32 v71, v191, v187, s58
  s_waitcnt lgkmcnt(0)
  s_bitcmp1_b32 s43, 11
  s_cbranch_scc1 LI_dead_Yff0
  s_cmp_lt_u32 s45, 8
  s_cbranch_scc1 LI_tail_Yff0
  buffer_load_dwordx4 v[160:163], v[16:17], s[12:15], 0 idxen offen sc1
  buffer_load_dwordx4 v[164:167], v[18:19], s[12:15], 0 idxen offen sc1
  buffer_load_dwordx4 v[168:171], v[20:21], s[12:15], 0 idxen offen sc1
  buffer_load_dwordx4 v[172:175], v[22:23], s[12:15], 0 idxen offen sc1
  buffer_load_dwordx4 v[176:179], v[24:25], s[12:15], 0 idxen offen sc1
  buffer_load_dwordx4 v[180:183], v[26:27], s[12:15], 0 idxen offen sc1
  buffer_load_dwordx4 v[184:187], v[28:29], s[12:15], 0 idxen offen sc1
  buffer_load_dwordx4 v[188:191], v[30:31], s[12:15], 0 idxen offen sc1
  s_mov_b32 s46, s43
  s_movk_i32 s49, 8
  s_add_u32 s53, s53, 8
  s_cmp_eq_u32 s45, 8
  s_cbranch_scc1 LI_last_Yff0
  s_add_u32 s44, s44, 512
  s_add_u32 s78, s78, 64
  s_sub_u32 s45, s45, 8
  s_andn2_b32 s43, s43, 0x100
LI_end_Yff0:
  v_mfma_f32_16x16x32_bf16 v[96:99], v[32:35], v[48:51], 0
  v_mfma_f32_16x16x32_bf16 v[100:103], v[32:35], v[52:55], 0
  v_mfma_f32_16x16x32_bf16 v[104:107], v[32:35], v[64:67], 0
  v_mfma_f32_16x16x32_bf16 v[108:111], v[32:35], v[68:71], 0
  s_branch YJOIN_0
YH_0:
  s_bitcmp1_b32 s52, 8
  s_cbranch_scc1 YHF_0
  v_perm_b32 v48, v164, v160, s57
  v_perm_b32 v49, v172, v168, s57
  s_waitcnt lgkmcnt(0)
  v_lshl_add_u32 v56, v56, 5, v5
  v_lshl_add_u32 v57, v57, 5, v5
  ds_read_b64_tr_b16 v[32:33], v56
  ds_read_b64_tr_b16 v[34:35], v57
  v_add_u32 v10, s44, v2
  v_add_u32 v4, s78, v3
  ds_read_b32 v16, v10 offset:1612
  ds_read_b32 v18, v10 offset:1676
  ds_read_b32 v20, v10 offset:1740
  ds_read_b32 v22, v10 offset:1804
  ds_read_b32 v24, v10 offset:1868
  ds_read_b32 v26, v10 offset:1932
  ds_read_b32 v28, v10 offset:1996
  ds_read_b32 v30, v10 offset:2060
  v_perm_b32 v52, v164, v160, s58
  v_perm_b32 v53, v172, v168, s58
  v_perm_b32 v64, v165, v161, s57
  v_perm_b32 v65, v173, v169, s57
  v_perm_b32 v68, v165, v161, s58
  v_perm_b32 v69, v173, v169, s58
  s_waitcnt lgkmcnt(8)
  v_mfma_f32_16x16x16_bf16 v[80:83], v[32:33], v[48:49], v[80:83]
  v_perm_b32 v48, v166, v162, s57
  v_perm_b32 v49, v174, v170, s57
  v_mfma_f32_16x16x16_bf16 v[84:87], v[32:33], v[52:53], v[84:87]
  v_perm_b32 v52, v166, v162, s58
  v_perm_b32 v53, v174, v170, s58
  v_mfma_f32_16x16x16_bf16 v[88:91], v[32:33], v[64:65], v[88:91]
  v_perm_b32 v64, v167, v163, s57
  v_perm_b32 v65, v175, v171, s57
  v_mfma_f32_16x16x16_bf16 v[92:95], v[32:33], v[68:69], v[92:95]
  v_perm_b32 v68, v167, v163, s58
  v_perm_b32 v69, v175, v171, s58
  s_waitcnt lgkmcnt(0)
  s_bitcmp1_b32 s43, 11
  s_cbranch_scc1 LI_dead_Yrh0
  s_cmp_lt_u32 s45, 8
  s_cbranch_scc1 LI_tail_Yrh0
  buffer_load_dwordx4 v[160:163], v[16:17], s[12:15], 0 idxen offen sc1
  buffer_load_dwordx4 v[164:167], v[18:19], s[12:15], 0 idxen offen sc1
  buffer_load_dwordx4 v[168:171], v[20:21], s[12:15], 0 idxen offen sc1
  buffer_load_dwordx4 v[172:175], v[22:23], s[12:15], 0 idxen offen sc1
  buffer_load_dwordx4 v[176:179], v[24:25], s[12:15], 0 idxen offen sc1
  buffer_load_dwordx4 v[180:183], v[26:27], s[12:15], 0 idxen offen sc1
  buffer_load_dwordx4 v[184:187], v[28:29], s[12:15], 0 idxen offen sc1
  buffer_load_dwordx4 v[188:191], v[30:31], s[12:15], 0 idxen offen sc1
  s_mov_b32 s46, s43
  s_movk_i32 s49, 8
  s_add_u32 s53, s53, 8
  s_cmp_eq_u32 s45, 8
  s_cbranch_scc1 LI_last_Yrh0
  s_add_u32 s44, s44, 512
  s_add_u32 s78, s78, 64
  s_sub_u32 s45, s45, 8
  s_andn2_b32 s43, s43, 0x100
LI_end_Yrh0:
  v_mfma_f32_16x16x16_bf16 v[96:99], v[32:33], v[48:49], v[96:99]
  v_mfma_f32_16x16x16_bf16 v[100:103], v[32:33], v[52:53], v[100:103]
  v_mfma_f32_16x16x16_bf16 v[104:107], v[32:33], v[64:65], v[104:107]
  v_mfma_f32_16x16x16_bf16 v[108:111], v[32:33], v[68:69], v[108:111]
  s_branch YEPI_0
YHF_0:
  v_perm_b32 v48, v164, v160, s57
  v_perm_b32 v49, v172, v168, s57
  s_waitcnt lgkmcnt(0)
  v_lshl_add_u32 v56, v56, 5, v5
  v_lshl_add_u32 v57, v57, 5, v5
  ds_read_b64_tr_b16 v[32:33], v56
  ds_read_b64_tr_b16 v[34:35], v57
  v_add_u32 v10, s44, v2
  v_add_u32 v4, s78, v3
  ds_read_b32 v16, v10 offset:1612
  ds_read_b32 v18, v10 offset:1676
  ds_read_b32 v20, v10 offset:1740
  ds_read_b32 v22, v10 offset:1804
  ds_read_b32 v24, v10 offset:1868
  ds_read_b32 v26, v10 offset:1932
  ds_read_b32 v28, v10 offset:1996
  ds_read_b32 v30, v10 offset:2060
  v_perm_b32 v52, v164, v160, s58
  v_perm_b32 v53, v172, v168, s58
  v_perm_b32 v64, v165, v161, s57
  v_perm_b32 v65, v173, v169, s57
  v_perm_b32 v68, v165, v161, s58
  v_perm_b32 v69, v173, v169, s58
  s_waitcnt lgkmcnt(8)
  v_mfma_f32_16x16x16_bf16 v[80:83], v[32:33], v[48:49], 0
  v_perm_b32 v48, v166, v162, s57
  v_perm_b32 v49, v174, v170, s57
  v_mfma_f32_16x16x16_bf16 v[84:87], v[32:33], v[52:53], 0
  v_perm_b32 v52, v166, v162, s58
  v_perm_b32 v53, v174, v170, s58
  v_mfma_f32_16x16x16_bf16 v[88:91], v[32:33], v[64:65], 0
  v_perm_b32 v64, v167, v163, s57
  v_perm_b32 v65, v175, v171, s57
  v_mfma_f32_16x16x16_bf16 v[92:95], v[32:33], v[68:69], 0
  v_perm_b32 v68, v167, v163, s58
  v_perm_b32 v69, v175, v171, s58
  s_waitcnt lgkmcnt(0)
  s_bitcmp1_b32 s43, 11
  s_cbranch_scc1 LI_dead_Yfh0
  s_cmp_lt_u32 s45, 8
  s_cbranch_scc1 LI_tail_Yfh0
  buffer_load_dwordx4 v[160:163], v[16:17], s[12:15], 0 idxen offen sc1
  buffer_load_dwordx4 v[164:167], v[18:19], s[12:15], 0 idxen offen sc1
  buffer_load_dwordx4 v[168:171], v[20:21], s[12:15], 0 idxen offen sc1
  buffer_load_dwordx4 v[172:175], v[22:23], s[12:15], 0 idxen offen sc1
  buffer_load_dwordx4 v[176:179], v[24:25], s[12:15], 0 idxen offen sc1
  buffer_load_dwordx4 v[180:183], v[26:27], s[12:15], 0 idxen offen sc1
  buffer_load_dwordx4 v[184:187], v[28:29], s[12:15], 0 idxen offen sc1
  buffer_load_dwordx4 v[188:191], v[30:31], s[12:15], 0 idxen offen sc1
  s_mov_b32 s46, s43
  s_movk_i32 s49, 8
  s_add_u32 s53, s53, 8
  s_cmp_eq_u32 s45, 8
  s_cbranch_scc1 LI_last_Yfh0
  s_add_u32 s44, s44, 512
  s_add_u32 s78, s78, 64
  s_sub_u32 s45, s45, 8
  s_andn2_b32 s43, s43, 0x100
LI_end_Yfh0:
  v_mfma_f32_16x16x16_bf16 v[96:99], v[32:33], v[48:49], 0
  v_mfma_f32_16x16x16_bf16 v[100:103], v[32:33], v[52:53], 0
  v_mfma_f32_16x16x16_bf16 v[104:107], v[32:33], v[64:65], 0
  v_mfma_f32_16x16x16_bf16 v[108:111], v[32:33], v[68:69], 0
YEPI_0:
  s_and_b32 s87, s52, 63
  s_lshl_b32 s80, s87, 9
  s_add_u32 s80, s80, 106144
  v_add_u32 v57, s80, v144
  v_mul_f32 v64, v128, v80
  v_mul_f32 v68, v128, v96
  v_mul_f32 v65, v132, v84
  v_mul_f32 v69, v132, v100
  v_mul_f32 v66, v136, v88
  v_mul_f32 v70, v136, v104
  v_mul_f32 v67, v140, v92
  v_mul_f32 v71, v140, v108
  v_fmac_f32 v64, v129, v81
  v_fmac_f32 v68, v129, v97
  v_fmac_f32 v65, v133, v85
  v_fmac_f32 v69, v133, v101
  v_fmac_f32 v66, v137, v89
  v_fmac_f32 v70, v137, v105
  v_fmac_f32 v67, v141, v93
  v_fmac_f32 v71, v141, v109
  v_fmac_f32 v64, v130, v82
  v_fmac_f32 v68, v130, v98
  v_fmac_f32 v65, v134, v86
  v_fmac_f32 v69, v134, v102
  v_fmac_f32 v66, v138, v90
  v_fmac_f32 v70, v138, v106
  v_fmac_f32 v67, v142, v94
  v_fmac_f32 v71, v142, v110
  v_fmac_f32 v64, v131, v83
  v_fmac_f32 v68, v131, v99
  v_fmac_f32 v65, v135, v87
  v_fmac_f32 v69, v135, v103
  v_fmac_f32 v66, v139, v91
  v_fmac_f32 v70, v139, v107
  v_fmac_f32 v67, v143, v95
  v_fmac_f32 v71, v143, v111
  v_permlane32_swap_b32 v64, v68
  v_permlane32_swap_b32 v65, v69
  v_permlane32_swap_b32 v66, v70
  v_permlane32_swap_b32 v67, v71
  v_add_f32 v64, v64, v68
  v_add_f32 v65, v65, v69
  v_add_f32 v66, v66, v70
  v_add_f32 v67, v67, v71
  s_nop 0
  v_permlane16_swap_b32 v64, v66
  v_permlane16_swap_b32 v65, v67
  v_add_f32 v64, v64, v66
  v_add_f32 v65, v65, v67
  ds_write_b64 v57, v[64:65]
  s_branch YLOOP_1
XENTER_1:
  s_cmp_lt_u32 s40, 4
  s_cbranch_scc1 XLOOP_1
  s_setprio 1
  s_branch XLOOP_1
WS_Y1:
  s_cmp_lt_u32 s80, 13
  s_cbranch_scc1 WS13_Y1
  s_waitcnt vmcnt(13)
  s_branch WD_Y1
WS13_Y1:
  s_cmp_lt_u32 s80, 10
  s_cbranch_scc1 WS10_Y1
  s_waitcnt vmcnt(10)
  s_branch WD_Y1
WS10_Y1:
  s_cmp_lt_u32 s80, 8
  s_cbranch_scc1 WS8_Y1
  s_waitcnt vmcnt(8)
  s_branch WD_Y1
WS8_Y1:
  s_cmp_lt_u32 s80, 5
  s_cbranch_scc1 WS5_Y1
  s_waitcnt vmcnt(5)
  s_branch WD_Y1
WS5_Y1:
  s_cmp_lt_u32 s80, 2
  s_cbranch_scc1 WS2_Y1
  s_waitcnt vmcnt(2)
  s_branch WD_Y1
WS2_Y1:
  s_waitcnt vmcnt(0)
  s_branch WD_Y1
LI_dead_Yrf1:
  s_movk_i32 s47, 0x800
  s_mov_b32 s50, 0
  s_branch LI_end_Yrf1
LI_tail_Yrf1:
  s_mov_b32 s50, s45
  s_add_u32 s53, s53, s45
  s_cmp_le_u32 s45, 4
  s_cselect_b32 s81, 0x1000, 0
  s_or_b32 s47, s43, s81
  s_cmp_le_u32 s45, 0
  s_cbranch_scc1 LI_last_Yrf1
  buffer_load_dwordx4 v[192:195], v[16:17], s[12:15], 0 idxen offen sc1
  s_cmp_le_u32 s45, 1
  s_cbranch_scc1 LI_last_Yrf1
  buffer_load_dwordx4 v[196:199], v[18:19], s[12:15], 0 idxen offen sc1
  s_cmp_le_u32 s45, 2
  s_cbranch_scc1 LI_last_Yrf1
  buffer_load_dwordx4 v[200:203], v[20:21], s[12:15], 0 idxen offen sc1
  s_cmp_le_u32 s45, 3
  s_cbranch_scc1 LI_last_Yrf1
  buffer_load_dwordx4 v[204:207], v[22:23], s[12:15], 0 idxen offen sc1
  s_cmp_le_u32 s45, 4
  s_cbranch_scc1 LI_last_Yrf1
  buffer_load_dwordx4 v[208:211], v[24:25], s[12:15], 0 idxen offen sc1
  s_cmp_le_u32 s45, 5
  s_cbranch_scc1 LI_last_Yrf1
  buffer_load_dwordx4 v[212:215], v[26:27], s[12:15], 0 idxen offen sc1
  s_cmp_le_u32 s45, 6
  s_cbranch_scc1 LI_last_Yrf1
  buffer_load_dwordx4 v[216:219], v[28:29], s[12:15], 0 idxen offen sc1
LI_last_Yrf1:
  s_or_b32 s47, s47, 0x200
NS_top_Yrf1:
  s_bitcmp1_b32 s55, 0
  s_cselect_b32 s85, s73, s72
  s_mul_i32 s84, s55, s74
  s_add_u32 s84, s84, s85
  s_add_u32 s55, s55, 1
  s_cmp_ge_u32 s84, s75
  s_cbranch_scc1 NS_end_Yrf1
  v_readlane_b32 s85, v8, s84
  s_nop 1
  s_and_b32 s86, s85, 63
  s_or_b32 s43, s56, s86
  s_bfe_u32 s44, s85, 0xc0006
  s_lshl_b32 s44, s44, 4
  s_lshr_b32 s45, s85, 18
  v_readlane_b32 s78, v7, s84
  s_branch LI_end_Yrf1
NS_end_Yrf1:
  s_cmp_eq_u32 s56, 0x100
  s_cbranch_scc0 NS_dead_Yrf1
  s_movk_i32 s56, 0x500
  s_mov_b32 s55, 0
  s_mov_b32 s12, s36
  s_mov_b32 s13, s37
  s_branch NS_top_Yrf1
NS_dead_Yrf1:
  s_movk_i32 s56, 0x800
  s_movk_i32 s43, 0x800
  s_mov_b32 s45, 0
  s_mov_b32 s44, 0
  s_mov_b32 s78, 0
  s_branch LI_end_Yrf1
YDISP_1:
  s_bitcmp1_b32 s52, 12
  s_cbranch_scc1 YH_1
  v_perm_b32 v48, v196, v192, s57
  v_perm_b32 v49, v204, v200, s57
  v_perm_b32 v50, v212, v208, s57
  v_perm_b32 v51, v220, v216, s57
  s_waitcnt lgkmcnt(0)
  v_lshl_add_u32 v56, v56, 5, v5
  v_lshl_add_u32 v57, v57, 5, v5
  ds_read_b64_tr_b16 v[32:33], v56
  ds_read_b64_tr_b16 v[34:35], v57
  v_add_u32 v11, s44, v2
  v_add_u32 v13, s78, v3
  ds_read_b32 v16, v11 offset:1612
  ds_read_b32 v18, v11 offset:1676
  ds_read_b32 v20, v11 offset:1740
  ds_read_b32 v22, v11 offset:1804
  ds_read_b32 v24, v11 offset:1868
  ds_read_b32 v26, v11 offset:1932
  ds_read_b32 v28, v11 offset:1996
  ds_read_b32 v30, v11 offset:2060
  v_perm_b32 v52, v196, v192, s58
  v_perm_b32 v53, v204, v200, s58
  v_perm_b32 v54, v212, v208, s58
  v_perm_b32 v55, v220, v216, s58
  v_perm_b32 v64, v197, v193, s57
  v_perm_b32 v65, v205, v201, s57
  v_perm_b32 v66, v213, v209, s57
  v_perm_b32 v67, v221, v217, s57
  v_perm_b32 v68, v197, v193, s58
  v_perm_b32 v69, v205, v201, s58
  v_perm_b32 v70, v213, v209, s58
  v_perm_b32 v71, v221, v217, s58
  s_waitcnt lgkmcnt(8)
  v_mfma_f32_16x16x32_bf16 v[80:83], v[32:35], v[48:51], 0
  v_perm_b32 v48, v198, v194, s57
  v_perm_b32 v49, v206, v202, s57
  v_perm_b32 v50, v214, v210, s57
  v_perm_b32 v51, v222, v218, s57
  v_mfma_f32_16x16x32_bf16 v[84:87], v[32:35], v[52:55], 0
  v_perm_b32 v52, v198, v194, s58
  v_perm_b32 v53, v206, v202, s58
  v_perm_b32 v54, v214, v210, s58
  v_perm_b32 v55, v222, v218, s58
  v_mfma_f32_16x16x32_bf16 v[88:91], v[32:35], v[64:67], 0
  v_perm_b32 v64, v199, v195, s57
  v_perm_b32 v65, v207, v203, s57
  v_perm_b32 v66, v215, v211, s57
  v_perm_b32 v67, v223, v219, s57
  v_mfma_f32_16x16x32_bf16 v[92:95], v[32:35], v[68:71], 0
  v_perm_b32 v68, v199, v195, s58
  v_perm_b32 v69, v207, v203, s58
  v_perm_b32 v70, v215, v211, s58
  v_perm_b32 v71, v223, v219, s58
  s_waitcnt lgkmcnt(0)
  s_bitcmp1_b32 s43, 11
  s_cbranch_scc1 LI_dead_Yff1
  s_cmp_lt_u32 s45, 8
  s_cbranch_scc1 LI_tail_Yff1
  buffer_load_dwordx4 v[192:195], v[16:17], s[12:15], 0 idxen offen sc1
  buffer_load_dwordx4 v[196:199], v[18:19], s[12:15], 0 idxen offen sc1
  buffer_load_dwordx4 v[200:203], v[20:21], s[12:15], 0 idxen offen sc1
  buffer_load_dwordx4 v[204:207], v[22:23], s[12:15], 0 idxen offen sc1
  buffer_load_dwordx4 v[208:211], v[24:25], s[12:15], 0 idxen offen sc1
  buffer_load_dwordx4 v[212:215], v[26:27], s[12:15], 0 idxen offen sc1
  buffer_load_dwordx4 v[216:219], v[28:29], s[12:15], 0 idxen offen sc1
  buffer_load_dwordx4 v[220:223], v[30:31], s[12:15], 0 idxen offen sc1
  s_mov_b32 s47, s43
  s_movk_i32 s50, 8
  s_add_u32 s53, s53, 8
  s_cmp_eq_u32 s45, 8
  s_cbranch_scc1 LI_last_Yff1
  s_add_u32 s44, s44, 512
  s_add_u32 s78, s78, 64
  s_sub_u32 s45, s45, 8
  s_andn2_b32 s43, s43, 0x100
LI_end_Yff1:
  v_mfma_f32_16x16x32_bf16 v[96:99], v[32:35], v[48:51], 0
  v_mfma_f32_16x16x32_bf16 v[100:103], v[32:35], v[52:55], 0
  v_mfma_f32_16x16x32_bf16 v[104:107], v[32:35], v[64:67], 0
  v_mfma_f32_16x16x32_bf16 v[108:111], v[32:35], v[68:71], 0
  s_branch YJOIN_1
YH_1:
  s_bitcmp1_b32 s52, 8
  s_cbranch_scc1 YHF_1
  v_perm_b32 v48, v196, v192, s57
  v_perm_b32 v49, v204, v200, s57
  s_waitcnt lgkmcnt(0)
  v_lshl_add_u32 v56, v56, 5, v5
  v_lshl_add_u32 v57, v57, 5, v5
  ds_read_b64_tr_b16 v[32:33], v56
  ds_read_b64_tr_b16 v[34:35], v57
  v_add_u32 v11, s44, v2
  v_add_u32 v13, s78, v3
  ds_read_b32 v16, v11 offset:1612
  ds_read_b32 v18, v11 offset:1676
  ds_read_b32 v20, v11 offset:1740
  ds_read_b32 v22, v11 offset:1804
  ds_read_b32 v24, v11 offset:1868
  ds_read_b32 v26, v11 offset:1932
  ds_read_b32 v28, v11 offset:1996
  ds_read_b32 v30, v11 offset:2060
  v_perm_b32 v52, v196, v192, s58
  v_perm_b32 v53, v204, v200, s58
  v_perm_b32 v64, v197, v193, s57
  v_perm_b32 v65, v205, v201, s57
  v_perm_b32 v68, v197, v193, s58
  v_perm_b32 v69, v205, v201, s58
  s_waitcnt lgkmcnt(8)
  v_mfma_f32_16x16x16_bf16 v[80:83], v[32:33], v[48:49], v[80:83]
  v_perm_b32 v48, v198, v194, s57
  v_perm_b32 v49, v206, v202, s57
  v_mfma_f32_16x16x16_bf16 v[84:87], v[32:33], v[52:53], v[84:87]
  v_perm_b32 v52, v198, v194, s58
  v_perm_b32 v53, v206, v202, s58
  v_mfma_f32_16x16x16_bf16 v[88:91], v[32:33], v[64:65], v[88:91]
  v_perm_b32 v64, v199, v195, s57
  v_perm_b32 v65, v207, v203, s57
  v_mfma_f32_16x16x16_bf16 v[92:95], v[32:33], v[68:69], v[92:95]
  v_perm_b32 v68, v199, v195, s58
  v_perm_b32 v69, v207, v203, s58
  s_waitcnt lgkmcnt(0)
  s_bitcmp1_b32 s43, 11
  s_cbranch_scc1 LI_dead_Yrh1
  s_cmp_lt_u32 s45, 8
  s_cbranch_scc1 LI_tail_Yrh1
  buffer_load_dwordx4 v[192:195], v[16:17], s[12:15], 0 idxen offen sc1
  buffer_load_dwordx4 v[196:199], v[18:19], s[12:15], 0 idxen offen sc1
  buffer_load_dwordx4 v[200:203], v[20:21], s[12:15], 0 idxen offen sc1
  buffer_load_dwordx4 v[204:207], v[22:23], s[12:15], 0 idxen offen sc1
  buffer_load_dwordx4 v[208:211], v[24:25], s[12:15], 0 idxen offen sc1
  buffer_load_dwordx4 v[212:215], v[26:27], s[12:15], 0 idxen offen sc1
  buffer_load_dwordx4 v[216:219], v[28:29], s[12:15], 0 idxen offen sc1
  buffer_load_dwordx4 v[220:223], v[30:31], s[12:15], 0 idxen offen sc1
  s_mov_b32 s47, s43
  s_movk_i32 s50, 8
  s_add_u32 s53, s53, 8
  s_cmp_eq_u32 s45, 8
  s_cbranch_scc1 LI_last_Yrh1
  s_add_u32 s44, s44, 512
  s_add_u32 s78, s78, 64
  s_sub_u32 s45, s45, 8
  s_andn2_b32 s43, s43, 0x100
LI_end_Yrh1:
  v_mfma_f32_16x16x16_bf16 v[96:99], v[32:33], v[48:49], v[96:99]
  v_mfma_f32_16x16x16_bf16 v[100:103], v[32:33], v[52:53], v[100:103]
  v_mfma_f32_16x16x16_bf16 v[104:107], v[32:33], v[64:65], v[104:107]
  v_mfma_f32_16x16x16_bf16 v[108:111], v[32:33], v[68:69], v[108:111]
  s_branch YEPI_1
YHF_1:
  v_perm_b32 v48, v196, v192, s57
  v_perm_b32 v49, v204, v200, s57
  s_waitcnt lgkmcnt(0)
  v_lshl_add_u32 v56, v56, 5, v5
  v_lshl_add_u32 v57, v57, 5, v5
  ds_read_b64_tr_b16 v[32:33], v56
  ds_read_b64_tr_b16 v[34:35], v57
  v_add_u32 v11, s44, v2
  v_add_u32 v13, s78, v3
  ds_read_b32 v16, v11 offset:1612
  ds_read_b32 v18, v11 offset:1676
  ds_read_b32 v20, v11 offset:1740
  ds_read_b32 v22, v11 offset:1804
  ds_read_b32 v24, v11 offset:1868
  ds_read_b32 v26, v11 offset:1932
  ds_read_b32 v28, v11 offset:1996
  ds_read_b32 v30, v11 offset:2060
  v_perm_b32 v52, v196, v192, s58
  v_perm_b32 v53, v204, v200, s58
  v_perm_b32 v64, v197, v193, s57
  v_perm_b32 v65, v205, v201, s57
  v_perm_b32 v68, v197, v193, s58
  v_perm_b32 v69, v205, v201, s58
  s_waitcnt lgkmcnt(8)
  v_mfma_f32_16x16x16_bf16 v[80:83], v[32:33], v[48:49], 0
  v_perm_b32 v48, v198, v194, s57
  v_perm_b32 v49, v206, v202, s57
  v_mfma_f32_16x16x16_bf16 v[84:87], v[32:33], v[52:53], 0
  v_perm_b32 v52, v198, v194, s58
  v_perm_b32 v53, v206, v202, s58
  v_mfma_f32_16x16x16_bf16 v[88:91], v[32:33], v[64:65], 0
  v_perm_b32 v64, v199, v195, s57
  v_perm_b32 v65, v207, v203, s57
  v_mfma_f32_16x16x16_bf16 v[92:95], v[32:33], v[68:69], 0
  v_perm_b32 v68, v199, v195, s58
  v_perm_b32 v69, v207, v203, s58
  s_waitcnt lgkmcnt(0)
  s_bitcmp1_b32 s43, 11
  s_cbranch_scc1 LI_dead_Yfh1
  s_cmp_lt_u32 s45, 8
  s_cbranch_scc1 LI_tail_Yfh1
  buffer_load_dwordx4 v[192:195], v[16:17], s[12:15], 0 idxen offen sc1
  buffer_load_dwordx4 v[196:199], v[18:19], s[12:15], 0 idxen offen sc1
  buffer_load_dwordx4 v[200:203], v[20:21], s[12:15], 0 idxen offen sc1
  buffer_load_dwordx4 v[204:207], v[22:23], s[12:15], 0 idxen offen sc1
  buffer_load_dwordx4 v[208:211], v[24:25], s[12:15], 0 idxen offen sc1
  buffer_load_dwordx4 v[212:215], v[26:27], s[12:15], 0 idxen offen sc1
  buffer_load_dwordx4 v[216:219], v[28:29], s[12:15], 0 idxen offen sc1
  buffer_load_dwordx4 v[220:223], v[30:31], s[12:15], 0 idxen offen sc1
  s_mov_b32 s47, s43
  s_movk_i32 s50, 8
  s_add_u32 s53, s53, 8
  s_cmp_eq_u32 s45, 8
  s_cbranch_scc1 LI_last_Yfh1
  s_add_u32 s44, s44, 512
  s_add_u32 s78, s78, 64
  s_sub_u32 s45, s45, 8
  s_andn2_b32 s43, s43, 0x100
LI_end_Yfh1:
  v_mfma_f32_16x16x16_bf16 v[96:99], v[32:33], v[48:49], 0
  v_mfma_f32_16x16x16_bf16 v[100:103], v[32:33], v[52:53], 0
  v_mfma_f32_16x16x16_bf16 v[104:107], v[32:33], v[64:65], 0
  v_mfma_f32_16x16x16_bf16 v[108:111], v[32:33], v[68:69], 0
YEPI_1:
  s_and_b32 s87, s52, 63
  s_lshl_b32 s80, s87, 9
  s_add_u32 s80, s80, 106144
  v_add_u32 v57, s80, v144
  v_mul_f32 v64, v128, v80
  v_mul_f32 v68, v128, v96
  v_mul_f32 v65, v132, v84
  v_mul_f32 v69, v132, v100
  v_mul_f32 v66, v136, v88
  v_mul_f32 v70, v136, v104
  v_mul_f32 v67, v140, v92
  v_mul_f32 v71, v140, v108
  v_fmac_f32 v64, v129, v81
  v_fmac_f32 v68, v129, v97
  v_fmac_f32 v65, v133, v85
  v_fmac_f32 v69, v133, v101
  v_fmac_f32 v66, v137, v89
  v_fmac_f32 v70, v137, v105
  v_fmac_f32 v67, v141, v93
  v_fmac_f32 v71, v141, v109
  v_fmac_f32 v64, v130, v82
  v_fmac_f32 v68, v130, v98
  v_fmac_f32 v65, v134, v86
  v_fmac_f32 v69, v134, v102
  v_fmac_f32 v66, v138, v90
  v_fmac_f32 v70, v138, v106
  v_fmac_f32 v67, v142, v94
  v_fmac_f32 v71, v142, v110
  v_fmac_f32 v64, v131, v83
  v_fmac_f32 v68, v131, v99
  v_fmac_f32 v65, v135, v87
  v_fmac_f32 v69, v135, v103
  v_fmac_f32 v66, v139, v91
  v_fmac_f32 v70, v139, v107
  v_fmac_f32 v67, v143, v95
  v_fmac_f32 v71, v143, v111
  v_permlane32_swap_b32 v64, v68
  v_permlane32_swap_b32 v65, v69
  v_permlane32_swap_b32 v66, v70
  v_permlane32_swap_b32 v67, v71
  v_add_f32 v64, v64, v68
  v_add_f32 v65, v65, v69
  v_add_f32 v66, v66, v70
  v_add_f32 v67, v67, v71
  s_nop 0
  v_permlane16_swap_b32 v64, v66
  v_permlane16_swap_b32 v65, v67
  v_add_f32 v64, v64, v66
  v_add_f32 v65, v65, v67
  ds_write_b64 v57, v[64:65]
  s_branch YLOOP_2
XENTER_2:
  s_cmp_lt_u32 s40, 4
  s_cbranch_scc1 XLOOP_2
  s_setprio 1
  s_branch XLOOP_2
WS_Y2:
  s_cmp_lt_u32 s80, 13
  s_cbranch_scc1 WS13_Y2
  s_waitcnt vmcnt(13)
  s_branch WD_Y2
WS13_Y2:
  s_cmp_lt_u32 s80, 10
  s_cbranch_scc1 WS10_Y2
  s_waitcnt vmcnt(10)
  s_branch WD_Y2
WS10_Y2:
  s_cmp_lt_u32 s80, 8
  s_cbranch_scc1 WS8_Y2
  s_waitcnt vmcnt(8)
  s_branch WD_Y2
WS8_Y2:
  s_cmp_lt_u32 s80, 5
  s_cbranch_scc1 WS5_Y2
  s_waitcnt vmcnt(5)
  s_branch WD_Y2
WS5_Y2:
  s_cmp_lt_u32 s80, 2
  s_cbranch_scc1 WS2_Y2
  s_waitcnt vmcnt(2)
  s_branch WD_Y2
WS2_Y2:
  s_waitcnt vmcnt(0)
  s_branch WD_Y2
LI_dead_Yrf2:
  s_movk_i32 s48, 0x800
  s_mov_b32 s51, 0
  s_branch LI_end_Yrf2
LI_tail_Yrf2:
  s_mov_b32 s51, s45
  s_add_u32 s53, s53, s45
  s_cmp_le_u32 s45, 4
  s_cselect_b32 s81, 0x1000, 0
  s_or_b32 s48, s43, s81
  s_cmp_le_u32 s45, 0
  s_cbranch_scc1 LI_last_Yrf2
  buffer_load_dwordx4 v[224:227], v[16:17], s[12:15], 0 idxen offen sc1
  s_cmp_le_u32 s45, 1
  s_cbranch_scc1 LI_last_Yrf2
  buffer_load_dwordx4 v[228:231], v[18:19], s[12:15], 0 idxen offen sc1
  s_cmp_le_u32 s45, 2
  s_cbranch_scc1 LI_last_Yrf2
  buffer_load_dwordx4 v[232:235], v[20:21], s[12:15], 0 idxen offen sc1
  s_cmp_le_u32 s45, 3
  s_cbranch_scc1 LI_last_Yrf2
  buffer_load_dwordx4 v[236:239], v[22:23], s[12:15], 0 idxen offen sc1
  s_cmp_le_u32 s45, 4
  s_cbranch_scc1 LI_last_Yrf2
  buffer_load_dwordx4 v[240:243], v[24:25], s[12:15], 0 idxen offen sc1
  s_cmp_le_u32 s45, 5
  s_cbranch_scc1 LI_last_Yrf2
  buffer_load_dwordx4 v[244:247], v[26:27], s[12:15], 0 idxen offen sc1
  s_cmp_le_u32 s45, 6
  s_cbranch_scc1 LI_last_Yrf2
  buffer_load_dwordx4 v[248:251], v[28:29], s[12:15], 0 idxen offen sc1
LI_last_Yrf2:
  s_or_b32 s48, s48, 0x200
NS_top_Yrf2:
  s_bitcmp1_b32 s55, 0
  s_cselect_b32 s85, s73, s72
  s_mul_i32 s84, s55, s74
  s_add_u32 s84, s84, s85
  s_add_u32 s55, s55, 1
  s_cmp_ge_u32 s84, s75
  s_cbranch_scc1 NS_end_Yrf2
  v_readlane_b32 s85, v8, s84
  s_nop 1
  s_and_b32 s86, s85, 63
  s_or_b32 s43, s56, s86
  s_bfe_u32 s44, s85, 0xc0006
  s_lshl_b32 s44, s44, 4
  s_lshr_b32 s45, s85, 18
  v_readlane_b32 s78, v7, s84
  s_branch LI_end_Yrf2
NS_end_Yrf2:
  s_cmp_eq_u32 s56, 0x100
  s_cbranch_scc0 NS_dead_Yrf2
  s_movk_i32 s56, 0x500
  s_mov_b32 s55, 0
  s_mov_b32 s12, s36
  s_mov_b32 s13, s37
  s_branch NS_top_Yrf2
NS_dead_Yrf2:
  s_movk_i32 s56, 0x800
  s_movk_i32 s43, 0x800
  s_mov_b32 s45, 0
  s_mov_b32 s44, 0
  s_mov_b32 s78, 0
  s_branch LI_end_Yrf2
YDISP_2:
  s_bitcmp1_b32 s52, 12
  s_cbranch_scc1 YH_2
  v_perm_b32 v48, v228, v224, s57
  v_perm_b32 v49, v236, v232, s57
  v_perm_b32 v50, v244, v240, s57
  v_perm_b32 v51, v252, v248, s57
  s_waitcnt lgkmcnt(0)
  v_lshl_add_u32 v56, v56, 5, v5
  v_lshl_add_u32 v57, v57, 5, v5
  ds_read_b64_tr_b16 v[32:33], v56
  ds_read_b64_tr_b16 v[34:35], v57
  v_add_u32 v12, s44, v2
  v_add_u32 v9, s78, v3
  ds_read_b32 v16, v12 offset:1612
  ds_read_b32 v18, v12 offset:1676
  ds_read_b32 v20, v12 offset:1740
  ds_read_b32 v22, v12 offset:1804
  ds_read_b32 v24, v12 offset:1868
  ds_read_b32 v26, v12 offset:1932
  ds_read_b32 v28, v12 offset:1996
  ds_read_b32 v30, v12 offset:2060
  v_perm_b32 v52, v228, v224, s58
  v_perm_b32 v53, v236, v232, s58
  v_perm_b32 v54, v244, v240, s58
  v_perm_b32 v55, v252, v248, s58
  v_perm_b32 v64, v229, v225, s57
  v_perm_b32 v65, v237, v233, s57
  v_perm_b32 v66, v245, v241, s57
  v_perm_b32 v67, v253, v249, s57
  v_perm_b32 v68, v229, v225, s58
  v_perm_b32 v69, v237, v233, s58
  v_perm_b32 v70, v245, v241, s58
  v_perm_b32 v71, v253, v249, s58
  s_waitcnt lgkmcnt(8)
  v_mfma_f32_16x16x32_bf16 v[80:83], v[32:35], v[48:51], 0
  v_perm_b32 v48, v230, v226, s57
  v_perm_b32 v49, v238, v234, s57
  v_perm_b32 v50, v246, v242, s57
  v_perm_b32 v51, v254, v250, s57
  v_mfma_f32_16x16x32_bf16 v[84:87], v[32:35], v[52:55], 0
  v_perm_b32 v52, v230, v226, s58
  v_perm_b32 v53, v238, v234, s58
  v_perm_b32 v54, v246, v242, s58
  v_perm_b32 v55, v254, v250, s58
  v_mfma_f32_16x16x32_bf16 v[88:91], v[32:35], v[64:67], 0
  v_perm_b32 v64, v231, v227, s57
  v_perm_b32 v65, v239, v235, s57
  v_perm_b32 v66, v247, v243, s57
  v_perm_b32 v67, v255, v251, s57
  v_mfma_f32_16x16x32_bf16 v[92:95], v[32:35], v[68:71], 0
  v_perm_b32 v68, v231, v227, s58
  v_perm_b32 v69, v239, v235, s58
  v_perm_b32 v70, v247, v243, s58
  v_perm_b32 v71, v255, v251, s58
  s_waitcnt lgkmcnt(0)
  s_bitcmp1_b32 s43, 11
  s_cbranch_scc1 LI_dead_Yff2
  s_cmp_lt_u32 s45, 8
  s_cbranch_scc1 LI_tail_Yff2
  buffer_load_dwordx4 v[224:227], v[16:17], s[12:15], 0 idxen offen sc1
  buffer_load_dwordx4 v[228:231], v[18:19], s[12:15], 0 idxen offen sc1
  buffer_load_dwordx4 v[232:235], v[20:21], s[12:15], 0 idxen offen sc1
  buffer_load_dwordx4 v[236:239], v[22:23], s[12:15], 0 idxen offen sc1
  buffer_load_dwordx4 v[240:243], v[24:25], s[12:15], 0 idxen offen sc1
  buffer_load_dwordx4 v[244:247], v[26:27], s[12:15], 0 idxen offen sc1
  buffer_load_dwordx4 v[248:251], v[28:29], s[12:15], 0 idxen offen sc1
  buffer_load_dwordx4 v[252:255], v[30:31], s[12:15], 0 idxen offen sc1
  s_mov_b32 s48, s43
  s_movk_i32 s51, 8
  s_add_u32 s53, s53, 8
  s_cmp_eq_u32 s45, 8
  s_cbranch_scc1 LI_last_Yff2
  s_add_u32 s44, s44, 512
  s_add_u32 s78, s78, 64
  s_sub_u32 s45, s45, 8
  s_andn2_b32 s43, s43, 0x100
LI_end_Yff2:
  v_mfma_f32_16x16x32_bf16 v[96:99], v[32:35], v[48:51], 0
  v_mfma_f32_16x16x32_bf16 v[100:103], v[32:35], v[52:55], 0
  v_mfma_f32_16x16x32_bf16 v[104:107], v[32:35], v[64:67], 0
  v_mfma_f32_16x16x32_bf16 v[108:111], v[32:35], v[68:71], 0
  s_branch YJOIN_2
YH_2:
  s_bitcmp1_b32 s52, 8
  s_cbranch_scc1 YHF_2
  v_perm_b32 v48, v228, v224, s57
  v_perm_b32 v49, v236, v232, s57
  s_waitcnt lgkmcnt(0)
  v_lshl_add_u32 v56, v56, 5, v5
  v_lshl_add_u32 v57, v57, 5, v5
  ds_read_b64_tr_b16 v[32:33], v56
  ds_read_b64_tr_b16 v[34:35], v57
  v_add_u32 v12, s44, v2
  v_add_u32 v9, s78, v3
  ds_read_b32 v16, v12 offset:1612
  ds_read_b32 v18, v12 offset:1676
  ds_read_b32 v20, v12 offset:1740
  ds_read_b32 v22, v12 offset:1804
  ds_read_b32 v24, v12 offset:1868
  ds_read_b32 v26, v12 offset:1932
  ds_read_b32 v28, v12 offset:1996
  ds_read_b32 v30, v12 offset:2060
  v_perm_b32 v52, v228, v224, s58
  v_perm_b32 v53, v236, v232, s58
  v_perm_b32 v64, v229, v225, s57
  v_perm_b32 v65, v237, v233, s57
  v_perm_b32 v68, v229, v225, s58
  v_perm_b32 v69, v237, v233, s58
  s_waitcnt lgkmcnt(8)
  v_mfma_f32_16x16x16_bf16 v[80:83], v[32:33], v[48:49], v[80:83]
  v_perm_b32 v48, v230, v226, s57
  v_perm_b32 v49, v238, v234, s57
  v_mfma_f32_16x16x16_bf16 v[84:87], v[32:33], v[52:53], v[84:87]
  v_perm_b32 v52, v230, v226, s58
  v_perm_b32 v53, v238, v234, s58
  v_mfma_f32_16x16x16_bf16 v[88:91], v[32:33], v[64:65], v[88:91]
  v_perm_b32 v64, v231, v227, s57
  v_perm_b32 v65, v239, v235, s57
  v_mfma_f32_16x16x16_bf16 v[92:95], v[32:33], v[68:69], v[92:95]
  v_perm_b32 v68, v231, v227, s58
  v_perm_b32 v69, v239, v235, s58
  s_waitcnt lgkmcnt(0)
  s_bitcmp1_b32 s43, 11
  s_cbranch_scc1 LI_dead_Yrh2
  s_cmp_lt_u32 s45, 8
  s_cbranch_scc1 LI_tail_Yrh2
  buffer_load_dwordx4 v[224:227], v[16:17], s[12:15], 0 idxen offen sc1
  buffer_load_dwordx4 v[228:231], v[18:19], s[12:15], 0 idxen offen sc1
  buffer_load_dwordx4 v[232:235], v[20:21], s[12:15], 0 idxen offen sc1
  buffer_load_dwordx4 v[236:239], v[22:23], s[12:15], 0 idxen offen sc1
  buffer_load_dwordx4 v[240:243], v[24:25], s[12:15], 0 idxen offen sc1
  buffer_load_dwordx4 v[244:247], v[26:27], s[12:15], 0 idxen offen sc1
  buffer_load_dwordx4 v[248:251], v[28:29], s[12:15], 0 idxen offen sc1
  buffer_load_dwordx4 v[252:255], v[30:31], s[12:15], 0 idxen offen sc1
  s_mov_b32 s48, s43
  s_movk_i32 s51, 8
  s_add_u32 s53, s53, 8
  s_cmp_eq_u32 s45, 8
  s_cbranch_scc1 LI_last_Yrh2
  s_add_u32 s44, s44, 512
  s_add_u32 s78, s78, 64
  s_sub_u32 s45, s45, 8
  s_andn2_b32 s43, s43, 0x100
LI_end_Yrh2:
  v_mfma_f32_16x16x16_bf16 v[96:99], v[32:33], v[48:49], v[96:99]
  v_mfma_f32_16x16x16_bf16 v[100:103], v[32:33], v[52:53], v[100:103]
  v_mfma_f32_16x16x16_bf16 v[104:107], v[32:33], v[64:65], v[104:107]
  v_mfma_f32_16x16x16_bf16 v[108:111], v[32:33], v[68:69], v[108:111]
  s_branch YEPI_2
YHF_2:
  v_perm_b32 v48, v228, v224, s57
  v_perm_b32 v49, v236, v232, s57
  s_waitcnt lgkmcnt(0)
  v_lshl_add_u32 v56, v56, 5, v5
  v_lshl_add_u32 v57, v57, 5, v5
  ds_read_b64_tr_b16 v[32:33], v56
  ds_read_b64_tr_b16 v[34:35], v57
  v_add_u32 v12, s44, v2
  v_add_u32 v9, s78, v3
  ds_read_b32 v16, v12 offset:1612
  ds_read_b32 v18, v12 offset:1676
  ds_read_b32 v20, v12 offset:1740
  ds_read_b32 v22, v12 offset:1804
  ds_read_b32 v24, v12 offset:1868
  ds_read_b32 v26, v12 offset:1932
  ds_read_b32 v28, v12 offset:1996
  ds_read_b32 v30, v12 offset:2060
  v_perm_b32 v52, v228, v224, s58
  v_perm_b32 v53, v236, v232, s58
  v_perm_b32 v64, v229, v225, s57
  v_perm_b32 v65, v237, v233, s57
  v_perm_b32 v68, v229, v225, s58
  v_perm_b32 v69, v237, v233, s58
  s_waitcnt lgkmcnt(8)
  v_mfma_f32_16x16x16_bf16 v[80:83], v[32:33], v[48:49], 0
  v_perm_b32 v48, v230, v226, s57
  v_perm_b32 v49, v238, v234, s57
  v_mfma_f32_16x16x16_bf16 v[84:87], v[32:33], v[52:53], 0
  v_perm_b32 v52, v230, v226, s58
  v_perm_b32 v53, v238, v234, s58
  v_mfma_f32_16x16x16_bf16 v[88:91], v[32:33], v[64:65], 0
  v_perm_b32 v64, v231, v227, s57
  v_perm_b32 v65, v239, v235, s57
  v_mfma_f32_16x16x16_bf16 v[92:95], v[32:33], v[68:69], 0
  v_perm_b32 v68, v231, v227, s58
  v_perm_b32 v69, v239, v235, s58
  s_waitcnt lgkmcnt(0)
  s_bitcmp1_b32 s43, 11
  s_cbranch_scc1 LI_dead_Yfh2
  s_cmp_lt_u32 s45, 8
  s_cbranch_scc1 LI_tail_Yfh2
  buffer_load_dwordx4 v[224:227], v[16:17], s[12:15], 0 idxen offen sc1
  buffer_load_dwordx4 v[228:231], v[18:19], s[12:15], 0 idxen offen sc1
  buffer_load_dwordx4 v[232:235], v[20:21], s[12:15], 0 idxen offen sc1
  buffer_load_dwordx4 v[236:239], v[22:23], s[12:15], 0 idxen offen sc1
  buffer_load_dwordx4 v[240:243], v[24:25], s[12:15], 0 idxen offen sc1
  buffer_load_dwordx4 v[244:247], v[26:27], s[12:15], 0 idxen offen sc1
  buffer_load_dwordx4 v[248:251], v[28:29], s[12:15], 0 idxen offen sc1
  buffer_load_dwordx4 v[252:255], v[30:31], s[12:15], 0 idxen offen sc1
  s_mov_b32 s48, s43
  s_movk_i32 s51, 8
  s_add_u32 s53, s53, 8
  s_cmp_eq_u32 s45, 8
  s_cbranch_scc1 LI_last_Yfh2
  s_add_u32 s44, s44, 512
  s_add_u32 s78, s78, 64
  s_sub_u32 s45, s45, 8
  s_andn2_b32 s43, s43, 0x100
LI_end_Yfh2:
  v_mfma_f32_16x16x16_bf16 v[96:99], v[32:33], v[48:49], 0
  v_mfma_f32_16x16x16_bf16 v[100:103], v[32:33], v[52:53], 0
  v_mfma_f32_16x16x16_bf16 v[104:107], v[32:33], v[64:65], 0
  v_mfma_f32_16x16x16_bf16 v[108:111], v[32:33], v[68:69], 0
YEPI_2:
  s_and_b32 s87, s52, 63
  s_lshl_b32 s80, s87, 9
  s_add_u32 s80, s80, 106144
  v_add_u32 v57, s80, v144
  v_mul_f32 v64, v128, v80
  v_mul_f32 v68, v128, v96
  v_mul_f32 v65, v132, v84
  v_mul_f32 v69, v132, v100
  v_mul_f32 v66, v136, v88
  v_mul_f32 v70, v136, v104
  v_mul_f32 v67, v140, v92
  v_mul_f32 v71, v140, v108
  v_fmac_f32 v64, v129, v81
  v_fmac_f32 v68, v129, v97
  v_fmac_f32 v65, v133, v85
  v_fmac_f32 v69, v133, v101
  v_fmac_f32 v66, v137, v89
  v_fmac_f32 v70, v137, v105
  v_fmac_f32 v67, v141, v93
  v_fmac_f32 v71, v141, v109
  v_fmac_f32 v64, v130, v82
  v_fmac_f32 v68, v130, v98
  v_fmac_f32 v65, v134, v86
  v_fmac_f32 v69, v134, v102
  v_fmac_f32 v66, v138, v90
  v_fmac_f32 v70, v138, v106
  v_fmac_f32 v67, v142, v94
  v_fmac_f32 v71, v142, v110
  v_fmac_f32 v64, v131, v83
  v_fmac_f32 v68, v131, v99
  v_fmac_f32 v65, v135, v87
  v_fmac_f32 v69, v135, v103
  v_fmac_f32 v66, v139, v91
  v_fmac_f32 v70, v139, v107
  v_fmac_f32 v67, v143, v95
  v_fmac_f32 v71, v143, v111
  v_permlane32_swap_b32 v64, v68
  v_permlane32_swap_b32 v65, v69
  v_permlane32_swap_b32 v66, v70
  v_permlane32_swap_b32 v67, v71
  v_add_f32 v64, v64, v68
  v_add_f32 v65, v65, v69
  v_add_f32 v66, v66, v70
  v_add_f32 v67, v67, v71
  s_nop 0
  v_permlane16_swap_b32 v64, v66
  v_permlane16_swap_b32 v65, v67
  v_add_f32 v64, v64, v66
  v_add_f32 v65, v65, v67
  ds_write_b64 v57, v[64:65]
  s_branch YLOOP_0
WS_X0:
  s_cmp_lt_u32 s80, 13
  s_cbranch_scc1 WS13_X0
  s_waitcnt vmcnt(13)
  s_branch WD_X0
WS13_X0:
  s_cmp_lt_u32 s80, 10
  s_cbranch_scc1 WS10_X0
  s_waitcnt vmcnt(10)
  s_branch WD_X0
WS10_X0:
  s_cmp_lt_u32 s80, 8
  s_cbranch_scc1 WS8_X0
  s_waitcnt vmcnt(8)
  s_branch WD_X0
WS8_X0:
  s_cmp_lt_u32 s80, 5
  s_cbranch_scc1 WS5_X0
  s_waitcnt vmcnt(5)
  s_branch WD_X0
WS5_X0:
  s_cmp_lt_u32 s80, 2
  s_cbranch_scc1 WS2_X0
  s_waitcnt vmcnt(2)
  s_branch WD_X0
WS2_X0:
  s_waitcnt vmcnt(0)
  s_branch WD_X0
LI_dead_Xrf0:
  s_movk_i32 s46, 0x800
  s_mov_b32 s49, 0
  s_branch LI_end_Xrf0
LI_tail_Xrf0:
  s_mov_b32 s49, s45
  s_add_u32 s53, s53, s45
  s_cmp_le_u32 s45, 4
  s_cselect_b32 s81, 0x1000, 0
  s_or_b32 s46, s43, s81
  s_cmp_le_u32 s45, 0
  s_cbranch_scc1 LI_last_Xrf0
  buffer_load_dwordx4 v[160:163], v[16:17], s[12:15], 0 idxen offen sc1
  s_cmp_le_u32 s45, 1
  s_cbranch_scc1 LI_last_Xrf0
  buffer_load_dwordx4 v[164:167], v[18:19], s[12:15], 0 idxen offen sc1
  s_cmp_le_u32 s45, 2
  s_cbranch_scc1 LI_last_Xrf0
  buffer_load_dwordx4 v[168:171], v[20:21], s[12:15], 0 idxen offen sc1
  s_cmp_le_u32 s45, 3
  s_cbranch_scc1 LI_last_Xrf0
  buffer_load_dwordx4 v[172:175], v[22:23], s[12:15], 0 idxen offen sc1
  s_cmp_le_u32 s45, 4
  s_cbranch_scc1 LI_last_Xrf0
  buffer_load_dwordx4 v[176:179], v[24:25], s[12:15], 0 idxen offen sc1
  s_cmp_le_u32 s45, 5
  s_cbranch_scc1 LI_last_Xrf0
  buffer_load_dwordx4 v[180:183], v[26:27], s[12:15], 0 idxen offen sc1
  s_cmp_le_u32 s45, 6
  s_cbranch_scc1 LI_last_Xrf0
  buffer_load_dwordx4 v[184:187], v[28:29], s[12:15], 0 idxen offen sc1
LI_last_Xrf0:
  s_or_b32 s46, s46, 0x200
NS_top_Xrf0:
  s_bitcmp1_b32 s55, 0
  s_cselect_b32 s85, s73, s72
  s_mul_i32 s84, s55, s74
  s_add_u32 s84, s84, s85
  s_add_u32 s55, s55, 1
  s_cmp_ge_u32 s84, s75
  s_cbranch_scc1 NS_end_Xrf0
  v_readlane_b32 s85, v8, s84
  s_nop 1
  s_and_b32 s86, s85, 63
  s_or_b32 s43, s56, s86
  s_bfe_u32 s44, s85, 0xc0006
  s_lshl_b32 s44, s44, 4
  s_lshr_b32 s45, s85, 18
  v_readlane_b32 s78, v7, s84
  s_branch LI_end_Xrf0
NS_end_Xrf0:
  s_cmp_eq_u32 s56, 0x100
  s_cbranch_scc0 NS_dead_Xrf0
  s_movk_i32 s56, 0x500
  s_mov_b32 s55, 0
  s_mov_b32 s12, s36
  s_mov_b32 s13, s37
  s_branch NS_top_Xrf0
NS_dead_Xrf0:
  s_movk_i32 s56, 0x800
  s_movk_i32 s43, 0x800
  s_mov_b32 s45, 0
  s_mov_b32 s44, 0
  s_mov_b32 s78, 0
  s_branch LI_end_Xrf0
XDISP_0:
  s_bitcmp1_b32 s52, 12
  s_cbranch_scc1 XH_0
  s_waitcnt lgkmcnt(4)
  v_lshl_add_u32 v56, v56, 5, v5
  v_lshl_add_u32 v57, v57, 5, v5
  ds_read_b64_tr_b16 v[32:33], v56
  ds_read_b64_tr_b16 v[34:35], v57
  s_and_b32 s82, s52, 63
  s_add_u32 s82, s82, s60
  s_lshl_b32 s82, s82, 9
  buffer_load_dwordx2 v[14:15], v6, s[20:23], s82 offen
  s_mov_b32 s53, 0
  v_perm_b32 v48, v166, v162, s57
  v_perm_b32 v49, v174, v170, s57
  v_perm_b32 v50, v182, v178, s57
  v_perm_b32 v51, v190, v186, s57
  v_perm_b32 v52, v166, v162, s58
  v_perm_b32 v53, v174, v170, s58
  v_perm_b32 v54, v182, v178, s58
  v_perm_b32 v55, v190, v186, s58
  s_waitcnt lgkmcnt(0)
  v_mfma_f32_16x16x32_bf16 v[144:147], v[32:35], v[48:51], 0
  v_lshlrev_b32 v56, 16, v32
  v_and_b32 v57, 0xffff0000, v32
  v_lshlrev_b32 v58, 16, v33
  v_mfma_f32_16x16x32_bf16 v[148:151], v[32:35], v[52:55], 0
  v_and_b32 v59, 0xffff0000, v33
  v_lshlrev_b32 v60, 16, v34
  v_and_b32 v61, 0xffff0000, v34
  v_lshlrev_b32 v62, 16, v35
  v_and_b32 v63, 0xffff0000, v35
  v_mul_f32 v64, v64, v56
  v_mul_f32 v65, v65, v56
  v_mul_f32 v66, v66, v56
  v_mul_f32 v68, v68, v57
  v_mul_f32 v69, v69, v57
  v_mul_f32 v70, v70, v57
  v_mul_f32 v72, v72, v58
  v_mul_f32 v73, v73, v58
  v_mul_f32 v74, v74, v58
  v_mul_f32 v76, v76, v59
  v_mul_f32 v77, v77, v59
  v_mul_f32 v78, v78, v59
  v_cvt_pk_bf16_f32 v36, v64, v68
  v_cvt_pk_bf16_f32 v37, v72, v76
  v_cvt_pk_bf16_f32 v40, v65, v69
  v_cvt_pk_bf16_f32 v41, v73, v77
  v_cvt_pk_bf16_f32 v44, v66, v70
  v_cvt_pk_bf16_f32 v45, v74, v78
  ds_read_b128 v[64:67], v10 offset:1856
  ds_read_b128 v[68:71], v10 offset:1920
  ds_read_b128 v[72:75], v10 offset:1984
  ds_read_b128 v[76:79], v10 offset:2048
  v_add_u32 v10, s44, v2
  v_add_u32 v4, s78, v3
  ds_read_b32 v16, v10 offset:1612
  ds_read_b32 v18, v10 offset:1676
  ds_read_b32 v20, v10 offset:1740
  ds_read_b32 v22, v10 offset:1804
  ds_read_b32 v24, v10 offset:1868
  ds_read_b32 v26, v10 offset:1932
  ds_read_b32 v28, v10 offset:1996
  ds_read_b32 v30, v10 offset:2060
  v_perm_b32 v48, v167, v163, s57
  v_perm_b32 v49, v175, v171, s57
  v_perm_b32 v50, v183, v179, s57
  v_perm_b32 v51, v191, v187, s57
  v_perm_b32 v52, v167, v163, s58
  v_perm_b32 v53, v175, v171, s58
  v_perm_b32 v54, v183, v179, s58
  v_perm_b32 v55, v191, v187, s58
  s_waitcnt lgkmcnt(8)
  v_mfma_f32_16x16x32_bf16 v[152:155], v[32:35], v[48:51], 0
  v_mul_f32 v64, v64, v60
  v_mul_f32 v65, v65, v60
  v_mul_f32 v66, v66, v60
  v_mfma_f32_16x16x32_bf16 v[156:159], v[32:35], v[52:55], 0
  v_mul_f32 v68, v68, v61
  v_mul_f32 v69, v69, v61
  v_mul_f32 v70, v70, v61
  v_mul_f32 v72, v72, v62
  v_mul_f32 v73, v73, v62
  v_mul_f32 v74, v74, v62
  v_mul_f32 v76, v76, v63
  v_mul_f32 v77, v77, v63
  v_mul_f32 v78, v78, v63
  v_cvt_pk_bf16_f32 v38, v64, v68
  v_cvt_pk_bf16_f32 v39, v72, v76
  v_cvt_pk_bf16_f32 v42, v65, v69
  v_cvt_pk_bf16_f32 v43, v73, v77
  v_cvt_pk_bf16_f32 v46, v66, v70
  v_cvt_pk_bf16_f32 v47, v74, v78
  v_perm_b32 v48, v164, v160, s57
  v_perm_b32 v49, v172, v168, s57
  v_perm_b32 v50, v180, v176, s57
  v_perm_b32 v51, v188, v184, s57
  s_nop 1
  v_mfma_f32_16x16x32_bf16 v[80:83], v[48:51], v[32:35], 0
  v_perm_b32 v52, v164, v160, s58
  v_mfma_f32_16x16x32_bf16 v[96:99], v[48:51], v[36:39], 0
  v_perm_b32 v53, v172, v168, s58
  v_mfma_f32_16x16x32_bf16 v[112:115], v[48:51], v[40:43], 0
  v_perm_b32 v54, v180, v176, s58
  v_mfma_f32_16x16x32_bf16 v[128:131], v[48:51], v[44:47], 0
  v_perm_b32 v55, v188, v184, s58
  s_nop 1
  v_mfma_f32_16x16x32_bf16 v[84:87], v[52:55], v[32:35], 0
  v_perm_b32 v48, v165, v161, s57
  v_mfma_f32_16x16x32_bf16 v[100:103], v[52:55], v[36:39], 0
  v_perm_b32 v49, v173, v169, s57
  v_mfma_f32_16x16x32_bf16 v[116:119], v[52:55], v[40:43], 0
  v_perm_b32 v50, v181, v177, s57
  v_mfma_f32_16x16x32_bf16 v[132:135], v[52:55], v[44:47], 0
  v_perm_b32 v51, v189, v185, s57
  s_nop 1
  v_mfma_f32_16x16x32_bf16 v[88:91], v[48:51], v[32:35], 0
  v_perm_b32 v52, v165, v161, s58
  v_mfma_f32_16x16x32_bf16 v[104:107], v[48:51], v[36:39], 0
  v_perm_b32 v53, v173, v169, s58
  v_mfma_f32_16x16x32_bf16 v[120:123], v[48:51], v[40:43], 0
  v_perm_b32 v54, v181, v177, s58
  v_mfma_f32_16x16x32_bf16 v[136:139], v[48:51], v[44:47], 0
  v_perm_b32 v55, v189, v185, s58
  s_waitcnt lgkmcnt(0)
  s_bitcmp1_b32 s43, 11
  s_cbranch_scc1 LI_dead_Xff0
  s_cmp_lt_u32 s45, 8
  s_cbranch_scc1 LI_tail_Xff0
  buffer_load_dwordx4 v[160:163], v[16:17], s[12:15], 0 idxen offen sc1
  buffer_load_dwordx4 v[164:167], v[18:19], s[12:15], 0 idxen offen sc1
  buffer_load_dwordx4 v[168:171], v[20:21], s[12:15], 0 idxen offen sc1
  buffer_load_dwordx4 v[172:175], v[22:23], s[12:15], 0 idxen offen sc1
  buffer_load_dwordx4 v[176:179], v[24:25], s[12:15], 0 idxen offen sc1
  buffer_load_dwordx4 v[180:183], v[26:27], s[12:15], 0 idxen offen sc1
  buffer_load_dwordx4 v[184:187], v[28:29], s[12:15], 0 idxen offen sc1
  buffer_load_dwordx4 v[188:191], v[30:31], s[12:15], 0 idxen offen sc1
  s_mov_b32 s46, s43
  s_movk_i32 s49, 8
  s_add_u32 s53, s53, 8
  s_cmp_eq_u32 s45, 8
  s_cbranch_scc1 LI_last_Xff0
  s_add_u32 s44, s44, 512
  s_add_u32 s78, s78, 64
  s_sub_u32 s45, s45, 8
  s_andn2_b32 s43, s43, 0x100
LI_end_Xff0:
  v_mfma_f32_16x16x32_bf16 v[92:95], v[52:55], v[32:35], 0
  v_mfma_f32_16x16x32_bf16 v[108:111], v[52:55], v[36:39], 0
  v_mfma_f32_16x16x32_bf16 v[124:127], v[52:55], v[40:43], 0
  v_mfma_f32_16x16x32_bf16 v[140:143], v[52:55], v[44:47], 0
  s_branch XJOIN_0
XH_0:
  s_bitcmp1_b32 s52, 8
  s_cbranch_scc1 XHF_0
  s_waitcnt lgkmcnt(4)
  v_lshl_add_u32 v56, v56, 5, v5
  v_lshl_add_u32 v57, v57, 5, v5
  ds_read_b64_tr_b16 v[32:33], v56
  ds_read_b64_tr_b16 v[34:35], v57
  v_perm_b32 v48, v166, v162, s57
  v_perm_b32 v49, v174, v170, s57
  v_perm_b32 v52, v166, v162, s58
  v_perm_b32 v53, v174, v170, s58
  s_waitcnt lgkmcnt(0)
  v_mfma_f32_16x16x16_bf16 v[144:147], v[32:33], v[48:49], v[144:147]
  v_lshlrev_b32 v56, 16, v32
  v_and_b32 v57, 0xffff0000, v32
  v_lshlrev_b32 v58, 16, v33
  v_mfma_f32_16x16x16_bf16 v[148:151], v[32:33], v[52:53], v[148:151]
  v_and_b32 v59, 0xffff0000, v33
  v_mul_f32 v64, v64, v56
  v_mul_f32 v65, v65, v56
  v_mul_f32 v66, v66, v56
  v_mul_f32 v68, v68, v57
  v_mul_f32 v69, v69, v57
  v_mul_f32 v70, v70, v57
  v_mul_f32 v72, v72, v58
  v_mul_f32 v73, v73, v58
  v_mul_f32 v74, v74, v58
  v_mul_f32 v76, v76, v59
  v_mul_f32 v77, v77, v59
  v_mul_f32 v78, v78, v59
  v_cvt_pk_bf16_f32 v36, v64, v68
  v_cvt_pk_bf16_f32 v37, v72, v76
  v_cvt_pk_bf16_f32 v40, v65, v69
  v_cvt_pk_bf16_f32 v41, v73, v77
  v_cvt_pk_bf16_f32 v44, v66, v70
  v_cvt_pk_bf16_f32 v45, v74, v78
  v_add_u32 v10, s44, v2
  v_add_u32 v4, s78, v3
  ds_read_b32 v16, v10 offset:1612
  ds_read_b32 v18, v10 offset:1676
  ds_read_b32 v20, v10 offset:1740
  ds_read_b32 v22, v10 offset:1804
  ds_read_b32 v24, v10 offset:1868
  ds_read_b32 v26, v10 offset:1932
  ds_read_b32 v28, v10 offset:1996
  ds_read_b32 v30, v10 offset:2060
  v_perm_b32 v48, v167, v163, s57
  v_perm_b32 v49, v175, v171, s57
  v_perm_b32 v52, v167, v163, s58
  v_perm_b32 v53, v175, v171, s58
  v_mfma_f32_16x16x16_bf16 v[152:155], v[32:33], v[48:49], v[152:155]
  s_nop 0
  v_mfma_f32_16x16x16_bf16 v[156:159], v[32:33], v[52:53], v[156:159]
  v_perm_b32 v48, v164, v160, s57
  v_perm_b32 v49, v172, v168, s57
  s_nop 1
  v_mfma_f32_16x16x16_bf16 v[80:83], v[48:49], v[32:33], v[80:83]
  v_perm_b32 v52, v164, v160, s58
  v_mfma_f32_16x16x16_bf16 v[96:99], v[48:49], v[36:37], v[96:99]
  v_perm_b32 v53, v172, v168, s58
  v_mfma_f32_16x16x16_bf16 v[112:115], v[48:49], v[40:41], v[112:115]
  v_mfma_f32_16x16x16_bf16 v[128:131], v[48:49], v[44:45], v[128:131]
  v_mfma_f32_16x16x16_bf16 v[84:87], v[52:53], v[32:33], v[84:87]
  v_perm_b32 v48, v165, v161, s57
  v_mfma_f32_16x16x16_bf16 v[100:103], v[52:53], v[36:37], v[100:103]
  v_perm_b32 v49, v173, v169, s57
  v_mfma_f32_16x16x16_bf16 v[116:119], v[52:53], v[40:41], v[116:119]
  v_mfma_f32_16x16x16_bf16 v[132:135], v[52:53], v[44:45], v[132:135]
  v_mfma_f32_16x16x16_bf16 v[88:91], v[48:49], v[32:33], v[88:91]
  v_perm_b32 v52, v165, v161, s58
  v_mfma_f32_16x16x16_bf16 v[104:107], v[48:49], v[36:37], v[104:107]
  v_perm_b32 v53, v173, v169, s58
  v_mfma_f32_16x16x16_bf16 v[120:123], v[48:49], v[40:41], v[120:123]
  v_mfma_f32_16x16x16_bf16 v[136:139], v[48:49], v[44:45], v[136:139]
  s_waitcnt lgkmcnt(0)
  s_bitcmp1_b32 s43, 11
  s_cbranch_scc1 LI_dead_Xrh0
  s_cmp_lt_u32 s45, 8
  s_cbranch_scc1 LI_tail_Xrh0
  buffer_load_dwordx4 v[160:163], v[16:17], s[12:15], 0 idxen offen sc1
  buffer_load_dwordx4 v[164:167], v[18:19], s[12:15], 0 idxen offen sc1
  buffer_load_dwordx4 v[168:171], v[20:21], s[12:15], 0 idxen offen sc1
  buffer_load_dwordx4 v[172:175], v[22:23], s[12:15], 0 idxen offen sc1
  buffer_load_dwordx4 v[176:179], v[24:25], s[12:15], 0 idxen offen sc1
  buffer_load_dwordx4 v[180:183], v[26:27], s[12:15], 0 idxen offen sc1
  buffer_load_dwordx4 v[184:187], v[28:29], s[12:15], 0 idxen offen sc1
  buffer_load_dwordx4 v[188:191], v[30:31], s[12:15], 0 idxen offen sc1
  s_mov_b32 s46, s43
  s_movk_i32 s49, 8
  s_add_u32 s53, s53, 8
  s_cmp_eq_u32 s45, 8
  s_cbranch_scc1 LI_last_Xrh0
  s_add_u32 s44, s44, 512
  s_add_u32 s78, s78, 64
  s_sub_u32 s45, s45, 8
  s_andn2_b32 s43, s43, 0x100
LI_end_Xrh0:
  v_mfma_f32_16x16x16_bf16 v[92:95], v[52:53], v[32:33], v[92:95]
  v_mfma_f32_16x16x16_bf16 v[108:111], v[52:53], v[36:37], v[108:111]
  v_mfma_f32_16x16x16_bf16 v[124:127], v[52:53], v[40:41], v[124:127]
  v_mfma_f32_16x16x16_bf16 v[140:143], v[52:53], v[44:45], v[140:143]
  s_branch XEPI_0
XHF_0:
  s_waitcnt lgkmcnt(4)
  v_lshl_add_u32 v56, v56, 5, v5
  v_lshl_add_u32 v57, v57, 5, v5
  ds_read_b64_tr_b16 v[32:33], v56
  ds_read_b64_tr_b16 v[34:35], v57
  s_and_b32 s82, s52, 63
  s_add_u32 s82, s82, s60
  s_lshl_b32 s82, s82, 9
  buffer_load_dwordx2 v[14:15], v6, s[20:23], s82 offen
  s_mov_b32 s53, 0
  v_perm_b32 v48, v166, v162, s57
  v_perm_b32 v49, v174, v170, s57
  v_perm_b32 v52, v166, v162, s58
  v_perm_b32 v53, v174, v170, s58
  s_waitcnt lgkmcnt(0)
  v_mfma_f32_16x16x16_bf16 v[144:147], v[32:33], v[48:49], 0
  v_lshlrev_b32 v56, 16, v32
  v_and_b32 v57, 0xffff0000, v32
  v_lshlrev_b32 v58, 16, v33
  v_mfma_f32_16x16x16_bf16 v[148:151], v[32:33], v[52:53], 0
  v_and_b32 v59, 0xffff0000, v33
  v_mul_f32 v64, v64, v56
  v_mul_f32 v65, v65, v56
  v_mul_f32 v66, v66, v56
  v_mul_f32 v68, v68, v57
  v_mul_f32 v69, v69, v57
  v_mul_f32 v70, v70, v57
  v_mul_f32 v72, v72, v58
  v_mul_f32 v73, v73, v58
  v_mul_f32 v74, v74, v58
  v_mul_f32 v76, v76, v59
  v_mul_f32 v77, v77, v59
  v_mul_f32 v78, v78, v59
  v_cvt_pk_bf16_f32 v36, v64, v68
  v_cvt_pk_bf16_f32 v37, v72, v76
  v_cvt_pk_bf16_f32 v40, v65, v69
  v_cvt_pk_bf16_f32 v41, v73, v77
  v_cvt_pk_bf16_f32 v44, v66, v70
  v_cvt_pk_bf16_f32 v45, v74, v78
  v_add_u32 v10, s44, v2
  v_add_u32 v4, s78, v3
  ds_read_b32 v16, v10 offset:1612
  ds_read_b32 v18, v10 offset:1676
  ds_read_b32 v20, v10 offset:1740
  ds_read_b32 v22, v10 offset:1804
  ds_read_b32 v24, v10 offset:1868
  ds_read_b32 v26, v10 offset:1932
  ds_read_b32 v28, v10 offset:1996
  ds_read_b32 v30, v10 offset:2060
  v_perm_b32 v48, v167, v163, s57
  v_perm_b32 v49, v175, v171, s57
  v_perm_b32 v52, v167, v163, s58
  v_perm_b32 v53, v175, v171, s58
  v_mfma_f32_16x16x16_bf16 v[152:155], v[32:33], v[48:49], 0
  s_nop 0
  v_mfma_f32_16x16x16_bf16 v[156:159], v[32:33], v[52:53], 0
  v_perm_b32 v48, v164, v160, s57
  v_perm_b32 v49, v172, v168, s57
  s_nop 1
  v_mfma_f32_16x16x16_bf16 v[80:83], v[48:49], v[32:33], 0
  v_perm_b32 v52, v164, v160, s58
  v_mfma_f32_16x16x16_bf16 v[96:99], v[48:49], v[36:37], 0
  v_perm_b32 v53, v172, v168, s58
  v_mfma_f32_16x16x16_bf16 v[112:115], v[48:49], v[40:41], 0
  v_mfma_f32_16x16x16_bf16 v[128:131], v[48:49], v[44:45], 0
  v_mfma_f32_16x16x16_bf16 v[84:87], v[52:53], v[32:33], 0
  v_perm_b32 v48, v165, v161, s57
  v_mfma_f32_16x16x16_bf16 v[100:103], v[52:53], v[36:37], 0
  v_perm_b32 v49, v173, v169, s57
  v_mfma_f32_16x16x16_bf16 v[116:119], v[52:53], v[40:41], 0
  v_mfma_f32_16x16x16_bf16 v[132:135], v[52:53], v[44:45], 0
  v_mfma_f32_16x16x16_bf16 v[88:91], v[48:49], v[32:33], 0
  v_perm_b32 v52, v165, v161, s58
  v_mfma_f32_16x16x16_bf16 v[104:107], v[48:49], v[36:37], 0
  v_perm_b32 v53, v173, v169, s58
  v_mfma_f32_16x16x16_bf16 v[120:123], v[48:49], v[40:41], 0
  v_mfma_f32_16x16x16_bf16 v[136:139], v[48:49], v[44:45], 0
  s_waitcnt lgkmcnt(0)
  s_bitcmp1_b32 s43, 11
  s_cbranch_scc1 LI_dead_Xfh0
  s_cmp_lt_u32 s45, 8
  s_cbranch_scc1 LI_tail_Xfh0
  buffer_load_dwordx4 v[160:163], v[16:17], s[12:15], 0 idxen offen sc1
  buffer_load_dwordx4 v[164:167], v[18:19], s[12:15], 0 idxen offen sc1
  buffer_load_dwordx4 v[168:171], v[20:21], s[12:15], 0 idxen offen sc1
  buffer_load_dwordx4 v[172:175], v[22:23], s[12:15], 0 idxen offen sc1
  buffer_load_dwordx4 v[176:179], v[24:25], s[12:15], 0 idxen offen sc1
  buffer_load_dwordx4 v[180:183], v[26:27], s[12:15], 0 idxen offen sc1
  buffer_load_dwordx4 v[184:187], v[28:29], s[12:15], 0 idxen offen sc1
  buffer_load_dwordx4 v[188:191], v[30:31], s[12:15], 0 idxen offen sc1
  s_mov_b32 s46, s43
  s_movk_i32 s49, 8
  s_add_u32 s53, s53, 8
  s_cmp_eq_u32 s45, 8
  s_cbranch_scc1 LI_last_Xfh0
  s_add_u32 s44, s44, 512
  s_add_u32 s78, s78, 64
  s_sub_u32 s45, s45, 8
  s_andn2_b32 s43, s43, 0x100
LI_end_Xfh0:
  v_mfma_f32_16x16x16_bf16 v[92:95], v[52:53], v[32:33], 0
  v_mfma_f32_16x16x16_bf16 v[108:111], v[52:53], v[36:37], 0
  v_mfma_f32_16x16x16_bf16 v[124:127], v[52:53], v[40:41], 0
  v_mfma_f32_16x16x16_bf16 v[140:143], v[52:53], v[44:45], 0
XEPI_0:
  s_mov_b32 s80, 77472
  v_lshl_add_u32 v16, v6, 1, s80
  ds_read_b128 v[32:35], v16 offset:20480
  ds_read_b128 v[36:39], v16 offset:21504
  ds_read_b128 v[40:43], v16 offset:22528
  ds_read_b128 v[44:47], v16 offset:23552
  ds_read_b128 v[56:59], v16 offset:1024
  ds_read_b128 v[64:67], v16 offset:9216
  ds_read_b128 v[60:63], v16 offset:5120
  ds_read_b128 v[68:71], v16 offset:13312
  ds_read_b128 v[72:75], v16 offset:17408
  ds_read_b128 v[76:79], v16 offset:25600
  v_cvt_pk_bf16_f32 v80, v80, v81
  v_cvt_pk_bf16_f32 v81, v82, v83
  v_cvt_pk_bf16_f32 v82, v84, v85
  v_cvt_pk_bf16_f32 v83, v86, v87
  v_cvt_pk_bf16_f32 v96, v96, v97
  v_cvt_pk_bf16_f32 v97, v98, v99
  v_cvt_pk_bf16_f32 v98, v100, v101
  v_cvt_pk_bf16_f32 v99, v102, v103
  v_cvt_pk_bf16_f32 v112, v112, v113
  v_cvt_pk_bf16_f32 v113, v114, v115
  v_cvt_pk_bf16_f32 v114, v116, v117
  v_cvt_pk_bf16_f32 v115, v118, v119
  v_cvt_pk_bf16_f32 v128, v128, v129
  v_cvt_pk_bf16_f32 v129, v130, v131
  v_cvt_pk_bf16_f32 v130, v132, v133
  v_cvt_pk_bf16_f32 v131, v134, v135
  v_cvt_pk_bf16_f32 v88, v88, v89
  v_cvt_pk_bf16_f32 v89, v90, v91
  v_cvt_pk_bf16_f32 v90, v92, v93
  v_cvt_pk_bf16_f32 v91, v94, v95
  v_cvt_pk_bf16_f32 v104, v104, v105
  v_cvt_pk_bf16_f32 v105, v106, v107
  v_cvt_pk_bf16_f32 v106, v108, v109
  v_cvt_pk_bf16_f32 v107, v110, v111
  v_cvt_pk_bf16_f32 v120, v120, v121
  v_cvt_pk_bf16_f32 v121, v122, v123
  v_cvt_pk_bf16_f32 v122, v124, v125
  v_cvt_pk_bf16_f32 v123, v126, v127
  v_cvt_pk_bf16_f32 v136, v136, v137
  v_cvt_pk_bf16_f32 v137, v138, v139
  v_cvt_pk_bf16_f32 v138, v140, v141
  v_cvt_pk_bf16_f32 v139, v142, v143
  s_waitcnt lgkmcnt(0)
  v_mfma_f32_16x16x32_bf16 v[92:95], v[80:83], v[56:59], 0
  v_mul_f32 v144, v32, v144
  v_mul_f32 v148, v36, v148
  v_mfma_f32_16x16x32_bf16 v[108:111], v[96:99], v[64:67], 0
  v_mul_f32 v152, v40, v152
  v_mul_f32 v156, v44, v156
  v_mfma_f32_16x16x32_bf16 v[124:127], v[112:115], v[64:67], 0
  v_fmac_f32 v144, v33, v145
  v_fmac_f32 v148, v37, v149
  v_mfma_f32_16x16x32_bf16 v[140:143], v[128:131], v[64:67], 0
  v_fmac_f32 v152, v41, v153
  v_fmac_f32 v156, v45, v157
  v_mfma_f32_16x16x32_bf16 v[92:95], v[88:91], v[60:63], v[92:95]
  v_fmac_f32 v144, v34, v146
  v_fmac_f32 v148, v38, v150
  v_mfma_f32_16x16x32_bf16 v[108:111], v[104:107], v[68:71], v[108:111]
  v_fmac_f32 v152, v42, v154
  v_fmac_f32 v156, v46, v158
  v_mfma_f32_16x16x32_bf16 v[124:127], v[120:123], v[68:71], v[124:127]
  v_fmac_f32 v144, v35, v147
  v_fmac_f32 v148, v39, v151
  v_mfma_f32_16x16x32_bf16 v[140:143], v[136:139], v[68:71], v[140:143]
  v_fmac_f32 v152, v43, v155
  v_fmac_f32 v156, v47, v159
  ds_read_b128 v[32:35], v16 offset:0
  ds_read_b128 v[40:43], v16 offset:8192
  ds_read_b128 v[36:39], v16 offset:4096
  ds_read_b128 v[44:47], v16 offset:12288
  ds_read_b128 v[48:51], v16 offset:16384
  ds_read_b128 v[52:55], v16 offset:24576
  s_and_b32 s80, s52, 63
  s_lshl_b32 s81, s80, 9
  s_add_u32 s81, s81, 105632
  v_lshl_add_u32 v18, v2, 4, v1
  v_add_u32 v18, s81, v18
  v_mul_f32 v149, v72, v92
  v_fmac_f32 v148, v76, v108
  v_mul_f32 v150, v76, v124
  v_mul_f32 v151, v76, v140
  v_fmac_f32 v149, v73, v93
  v_fmac_f32 v148, v77, v109
  v_fmac_f32 v150, v77, v125
  v_fmac_f32 v151, v77, v141
  s_waitcnt lgkmcnt(0)
  v_mfma_f32_16x16x32_bf16 v[84:87], v[80:83], v[32:35], 0
  v_fmac_f32 v149, v74, v94
  v_mfma_f32_16x16x32_bf16 v[100:103], v[96:99], v[40:43], 0
  v_fmac_f32 v148, v78, v110
  v_mfma_f32_16x16x32_bf16 v[116:119], v[112:115], v[40:43], 0
  v_fmac_f32 v150, v78, v126
  v_mfma_f32_16x16x32_bf16 v[132:135], v[128:131], v[40:43], 0
  v_fmac_f32 v151, v78, v142
  v_mfma_f32_16x16x32_bf16 v[84:87], v[88:91], v[36:39], v[84:87]
  v_fmac_f32 v149, v75, v95
  v_mfma_f32_16x16x32_bf16 v[100:103], v[104:107], v[44:47], v[100:103]
  v_fmac_f32 v148, v79, v111
  v_mfma_f32_16x16x32_bf16 v[116:119], v[120:123], v[44:47], v[116:119]
  v_fmac_f32 v150, v79, v127
  v_mfma_f32_16x16x32_bf16 v[132:135], v[136:139], v[44:47], v[132:135]
  v_fmac_f32 v151, v79, v143
  ds_read_b128 v[56:59], v16 offset:3072
  ds_read_b128 v[64:67], v16 offset:11264
  ds_read_b128 v[60:63], v16 offset:7168
  ds_read_b128 v[68:71], v16 offset:15360
  ds_read_b128 v[72:75], v16 offset:19456
  ds_read_b128 v[76:79], v16 offset:27648
  s_nop 3
  v_mul_f32 v145, v48, v84
  v_fmac_f32 v144, v52, v100
  v_mul_f32 v146, v52, v116
  v_mul_f32 v147, v52, v132
  v_fmac_f32 v145, v49, v85
  v_fmac_f32 v144, v53, v101
  v_fmac_f32 v146, v53, v117
  v_fmac_f32 v147, v53, v133
  s_waitcnt lgkmcnt(0)
  v_mfma_f32_16x16x32_bf16 v[92:95], v[80:83], v[56:59], 0
  v_fmac_f32 v145, v50, v86
  v_mfma_f32_16x16x32_bf16 v[108:111], v[96:99], v[64:67], 0
  v_fmac_f32 v144, v54, v102
  v_mfma_f32_16x16x32_bf16 v[124:127], v[112:115], v[64:67], 0
  v_fmac_f32 v146, v54, v118
  v_mfma_f32_16x16x32_bf16 v[140:143], v[128:131], v[64:67], 0
  v_fmac_f32 v147, v54, v134
  v_mfma_f32_16x16x32_bf16 v[92:95], v[88:91], v[60:63], v[92:95]
  v_fmac_f32 v145, v51, v87
  v_mfma_f32_16x16x32_bf16 v[108:111], v[104:107], v[68:71], v[108:111]
  v_fmac_f32 v144, v55, v103
  v_mfma_f32_16x16x32_bf16 v[124:127], v[120:123], v[68:71], v[124:127]
  v_fmac_f32 v146, v55, v119
  v_mfma_f32_16x16x32_bf16 v[140:143], v[136:139], v[68:71], v[140:143]
  v_fmac_f32 v147, v55, v135
  ds_read_b128 v[32:35], v16 offset:2048
  ds_read_b128 v[40:43], v16 offset:10240
  ds_read_b128 v[36:39], v16 offset:6144
  ds_read_b128 v[44:47], v16 offset:14336
  ds_read_b128 v[48:51], v16 offset:18432
  ds_read_b128 v[52:55], v16 offset:26624
  s_nop 3
  v_mul_f32 v157, v72, v92
  v_fmac_f32 v156, v76, v108
  v_mul_f32 v158, v76, v124
  v_mul_f32 v159, v76, v140
  v_fmac_f32 v157, v73, v93
  v_fmac_f32 v156, v77, v109
  v_fmac_f32 v158, v77, v125
  v_fmac_f32 v159, v77, v141
  s_waitcnt lgkmcnt(0)
  v_mfma_f32_16x16x32_bf16 v[84:87], v[80:83], v[32:35], 0
  v_fmac_f32 v157, v74, v94
  v_mfma_f32_16x16x32_bf16 v[100:103], v[96:99], v[40:43], 0
  v_fmac_f32 v156, v78, v110
  v_mfma_f32_16x16x32_bf16 v[116:119], v[112:115], v[40:43], 0
  v_fmac_f32 v158, v78, v126
  v_mfma_f32_16x16x32_bf16 v[132:135], v[128:131], v[40:43], 0
  v_fmac_f32 v159, v78, v142
  v_mfma_f32_16x16x32_bf16 v[84:87], v[88:91], v[36:39], v[84:87]
  v_fmac_f32 v157, v75, v95
  v_mfma_f32_16x16x32_bf16 v[100:103], v[104:107], v[44:47], v[100:103]
  v_fmac_f32 v156, v79, v111
  v_mfma_f32_16x16x32_bf16 v[116:119], v[120:123], v[44:47], v[116:119]
  v_fmac_f32 v158, v79, v127
  v_mfma_f32_16x16x32_bf16 v[132:135], v[136:139], v[44:47], v[132:135]
  v_fmac_f32 v159, v79, v143
  ds_read_b128 v[60:63], v18
  v_mul_f32 v153, v48, v84
  s_nop 0
  v_fmac_f32 v152, v52, v100
  s_nop 0
  v_mul_f32 v154, v52, v116
  s_nop 0
  v_mul_f32 v155, v52, v132
  v_fmac_f32 v153, v49, v85
  v_fmac_f32 v152, v53, v101
  v_fmac_f32 v154, v53, v117
  v_fmac_f32 v155, v53, v133
  v_fmac_f32 v153, v50, v86
  v_fmac_f32 v152, v54, v102
  v_fmac_f32 v154, v54, v118
  v_fmac_f32 v155, v54, v134
  v_fmac_f32 v153, v51, v87
  v_fmac_f32 v152, v55, v103
  v_fmac_f32 v154, v55, v119
  v_fmac_f32 v155, v55, v135
  v_permlane32_swap_b32 v145, v146
  v_permlane32_swap_b32 v144, v147
  v_permlane32_swap_b32 v149, v150
  v_permlane32_swap_b32 v148, v151
  v_permlane32_swap_b32 v153, v154
  v_permlane32_swap_b32 v152, v155
  v_permlane32_swap_b32 v157, v158
  v_permlane32_swap_b32 v156, v159
  v_add_f32 v145, v145, v146
  v_add_f32 v144, v144, v147
  v_add_f32 v149, v149, v150
  v_add_f32 v148, v148, v151
  v_add_f32 v153, v153, v154
  v_add_f32 v152, v152, v155
  v_add_f32 v157, v157, v158
  v_add_f32 v156, v156, v159
  v_permlane16_swap_b32 v145, v144
  v_permlane16_swap_b32 v149, v148
  v_permlane16_swap_b32 v153, v152
  v_permlane16_swap_b32 v157, v156
  v_add_f32 v145, v145, v144
  v_add_f32 v149, v149, v148
  v_add_f32 v153, v153, v152
  v_add_f32 v157, v157, v156
  s_waitcnt lgkmcnt(0)
  s_cmp_lg_u32 s79, 0
  s_cbranch_scc1 EX_fb_X0
  s_cmp_lt_u32 s53, 12
  s_cbranch_scc1 EX_rw_X0
  s_waitcnt vmcnt(12)
EX_rwd_X0:
  s_mov_b32 exec_lo, 0
  v_add_f32 v145, v145, v60
  v_add_f32 v149, v149, v61
  v_add_f32 v153, v153, v62
  v_add_f32 v157, v157, v63
  s_mov_b64 exec, -1
  v_lshlrev_b32 v32, 16, v14
  v_and_b32 v33, 0xffff0000, v14
  v_lshlrev_b32 v34, 16, v15
  v_and_b32 v35, 0xffff0000, v15
  v_add_f32 v32, v32, v145
  v_add_f32 v33, v33, v149
  v_add_f32 v34, v34, v153
  v_add_f32 v35, v35, v157
  v_cvt_pk_bf16_f32 v36, v32, v33
  v_cvt_pk_bf16_f32 v37, v34, v35
  s_add_u32 s80, s80, s60
  s_lshl_b32 s80, s80, 9
  buffer_store_dwordx2 v[36:37], v6, s[24:27], s80 offen
EX_end_X0:
  s_branch XLOOP_1
WS_X1:
  s_cmp_lt_u32 s80, 13
  s_cbranch_scc1 WS13_X1
  s_waitcnt vmcnt(13)
  s_branch WD_X1
WS13_X1:
  s_cmp_lt_u32 s80, 10
  s_cbranch_scc1 WS10_X1
  s_waitcnt vmcnt(10)
  s_branch WD_X1
WS10_X1:
  s_cmp_lt_u32 s80, 8
  s_cbranch_scc1 WS8_X1
  s_waitcnt vmcnt(8)
  s_branch WD_X1
WS8_X1:
  s_cmp_lt_u32 s80, 5
  s_cbranch_scc1 WS5_X1
  s_waitcnt vmcnt(5)
  s_branch WD_X1
WS5_X1:
  s_cmp_lt_u32 s80, 2
  s_cbranch_scc1 WS2_X1
  s_waitcnt vmcnt(2)
  s_branch WD_X1
WS2_X1:
  s_waitcnt vmcnt(0)
  s_branch WD_X1
LI_dead_Xrf1:
  s_movk_i32 s47, 0x800
  s_mov_b32 s50, 0
  s_branch LI_end_Xrf1
LI_tail_Xrf1:
  s_mov_b32 s50, s45
  s_add_u32 s53, s53, s45
  s_cmp_le_u32 s45, 4
  s_cselect_b32 s81, 0x1000, 0
  s_or_b32 s47, s43, s81
  s_cmp_le_u32 s45, 0
  s_cbranch_scc1 LI_last_Xrf1
  buffer_load_dwordx4 v[192:195], v[16:17], s[12:15], 0 idxen offen sc1
  s_cmp_le_u32 s45, 1
  s_cbranch_scc1 LI_last_Xrf1
  buffer_load_dwordx4 v[196:199], v[18:19], s[12:15], 0 idxen offen sc1
  s_cmp_le_u32 s45, 2
  s_cbranch_scc1 LI_last_Xrf1
  buffer_load_dwordx4 v[200:203], v[20:21], s[12:15], 0 idxen offen sc1
  s_cmp_le_u32 s45, 3
  s_cbranch_scc1 LI_last_Xrf1
  buffer_load_dwordx4 v[204:207], v[22:23], s[12:15], 0 idxen offen sc1
  s_cmp_le_u32 s45, 4
  s_cbranch_scc1 LI_last_Xrf1
  buffer_load_dwordx4 v[208:211], v[24:25], s[12:15], 0 idxen offen sc1
  s_cmp_le_u32 s45, 5
  s_cbranch_scc1 LI_last_Xrf1
  buffer_load_dwordx4 v[212:215], v[26:27], s[12:15], 0 idxen offen sc1
  s_cmp_le_u32 s45, 6
  s_cbranch_scc1 LI_last_Xrf1
  buffer_load_dwordx4 v[216:219], v[28:29], s[12:15], 0 idxen offen sc1
LI_last_Xrf1:
  s_or_b32 s47, s47, 0x200
NS_top_Xrf1:
  s_bitcmp1_b32 s55, 0
  s_cselect_b32 s85, s73, s72
  s_mul_i32 s84, s55, s74
  s_add_u32 s84, s84, s85
  s_add_u32 s55, s55, 1
  s_cmp_ge_u32 s84, s75
  s_cbranch_scc1 NS_end_Xrf1
  v_readlane_b32 s85, v8, s84
  s_nop 1
  s_and_b32 s86, s85, 63
  s_or_b32 s43, s56, s86
  s_bfe_u32 s44, s85, 0xc0006
  s_lshl_b32 s44, s44, 4
  s_lshr_b32 s45, s85, 18
  v_readlane_b32 s78, v7, s84
  s_branch LI_end_Xrf1
NS_end_Xrf1:
  s_cmp_eq_u32 s56, 0x100
  s_cbranch_scc0 NS_dead_Xrf1
  s_movk_i32 s56, 0x500
  s_mov_b32 s55, 0
  s_mov_b32 s12, s36
  s_mov_b32 s13, s37
  s_branch NS_top_Xrf1
NS_dead_Xrf1:
  s_movk_i32 s56, 0x800
  s_movk_i32 s43, 0x800
  s_mov_b32 s45, 0
  s_mov_b32 s44, 0
  s_mov_b32 s78, 0
  s_branch LI_end_Xrf1
XDISP_1:
  s_bitcmp1_b32 s52, 12
  s_cbranch_scc1 XH_1
  s_waitcnt lgkmcnt(4)
  v_lshl_add_u32 v56, v56, 5, v5
  v_lshl_add_u32 v57, v57, 5, v5
  ds_read_b64_tr_b16 v[32:33], v56
  ds_read_b64_tr_b16 v[34:35], v57
  s_and_b32 s82, s52, 63
  s_add_u32 s82, s82, s60
  s_lshl_b32 s82, s82, 9
  buffer_load_dwordx2 v[14:15], v6, s[20:23], s82 offen
  s_mov_b32 s53, 0
  v_perm_b32 v48, v198, v194, s57
  v_perm_b32 v49, v206, v202, s57
  v_perm_b32 v50, v214, v210, s57
  v_perm_b32 v51, v222, v218, s57
  v_perm_b32 v52, v198, v194, s58
  v_perm_b32 v53, v206, v202, s58
  v_perm_b32 v54, v214, v210, s58
  v_perm_b32 v55, v222, v218, s58
  s_waitcnt lgkmcnt(0)
  v_mfma_f32_16x16x32_bf16 v[144:147], v[32:35], v[48:51], 0
  v_lshlrev_b32 v56, 16, v32
  v_and_b32 v57, 0xffff0000, v32
  v_lshlrev_b32 v58, 16, v33
  v_mfma_f32_16x16x32_bf16 v[148:151], v[32:35], v[52:55], 0
  v_and_b32 v59, 0xffff0000, v33
  v_lshlrev_b32 v60, 16, v34
  v_and_b32 v61, 0xffff0000, v34
  v_lshlrev_b32 v62, 16, v35
  v_and_b32 v63, 0xffff0000, v35
  v_mul_f32 v64, v64, v56
  v_mul_f32 v65, v65, v56
  v_mul_f32 v66, v66, v56
  v_mul_f32 v68, v68, v57
  v_mul_f32 v69, v69, v57
  v_mul_f32 v70, v70, v57
  v_mul_f32 v72, v72, v58
  v_mul_f32 v73, v73, v58
  v_mul_f32 v74, v74, v58
  v_mul_f32 v76, v76, v59
  v_mul_f32 v77, v77, v59
  v_mul_f32 v78, v78, v59
  v_cvt_pk_bf16_f32 v36, v64, v68
  v_cvt_pk_bf16_f32 v37, v72, v76
  v_cvt_pk_bf16_f32 v40, v65, v69
  v_cvt_pk_bf16_f32 v41, v73, v77
  v_cvt_pk_bf16_f32 v44, v66, v70
  v_cvt_pk_bf16_f32 v45, v74, v78
  ds_read_b128 v[64:67], v11 offset:1856
  ds_read_b128 v[68:71], v11 offset:1920
  ds_read_b128 v[72:75], v11 offset:1984
  ds_read_b128 v[76:79], v11 offset:2048
  v_add_u32 v11, s44, v2
  v_add_u32 v13, s78, v3
  ds_read_b32 v16, v11 offset:1612
  ds_read_b32 v18, v11 offset:1676
  ds_read_b32 v20, v11 offset:1740
  ds_read_b32 v22, v11 offset:1804
  ds_read_b32 v24, v11 offset:1868
  ds_read_b32 v26, v11 offset:1932
  ds_read_b32 v28, v11 offset:1996
  ds_read_b32 v30, v11 offset:2060
  v_perm_b32 v48, v199, v195, s57
  v_perm_b32 v49, v207, v203, s57
  v_perm_b32 v50, v215, v211, s57
  v_perm_b32 v51, v223, v219, s57
  v_perm_b32 v52, v199, v195, s58
  v_perm_b32 v53, v207, v203, s58
  v_perm_b32 v54, v215, v211, s58
  v_perm_b32 v55, v223, v219, s58
  s_waitcnt lgkmcnt(8)
  v_mfma_f32_16x16x32_bf16 v[152:155], v[32:35], v[48:51], 0
  v_mul_f32 v64, v64, v60
  v_mul_f32 v65, v65, v60
  v_mul_f32 v66, v66, v60
  v_mfma_f32_16x16x32_bf16 v[156:159], v[32:35], v[52:55], 0
  v_mul_f32 v68, v68, v61
  v_mul_f32 v69, v69, v61
  v_mul_f32 v70, v70, v61
  v_mul_f32 v72, v72, v62
  v_mul_f32 v73, v73, v62
  v_mul_f32 v74, v74, v62
  v_mul_f32 v76, v76, v63
  v_mul_f32 v77, v77, v63
  v_mul_f32 v78, v78, v63
  v_cvt_pk_bf16_f32 v38, v64, v68
  v_cvt_pk_bf16_f32 v39, v72, v76
  v_cvt_pk_bf16_f32 v42, v65, v69
  v_cvt_pk_bf16_f32 v43, v73, v77
  v_cvt_pk_bf16_f32 v46, v66, v70
  v_cvt_pk_bf16_f32 v47, v74, v78
  v_perm_b32 v48, v196, v192, s57
  v_perm_b32 v49, v204, v200, s57
  v_perm_b32 v50, v212, v208, s57
  v_perm_b32 v51, v220, v216, s57
  s_nop 1
  v_mfma_f32_16x16x32_bf16 v[80:83], v[48:51], v[32:35], 0
  v_perm_b32 v52, v196, v192, s58
  v_mfma_f32_16x16x32_bf16 v[96:99], v[48:51], v[36:39], 0
  v_perm_b32 v53, v204, v200, s58
  v_mfma_f32_16x16x32_bf16 v[112:115], v[48:51], v[40:43], 0
  v_perm_b32 v54, v212, v208, s58
  v_mfma_f32_16x16x32_bf16 v[128:131], v[48:51], v[44:47], 0
  v_perm_b32 v55, v220, v216, s58
  s_nop 1
  v_mfma_f32_16x16x32_bf16 v[84:87], v[52:55], v[32:35], 0
  v_perm_b32 v48, v197, v193, s57
  v_mfma_f32_16x16x32_bf16 v[100:103], v[52:55], v[36:39], 0
  v_perm_b32 v49, v205, v201, s57
  v_mfma_f32_16x16x32_bf16 v[116:119], v[52:55], v[40:43], 0
  v_perm_b32 v50, v213, v209, s57
  v_mfma_f32_16x16x32_bf16 v[132:135], v[52:55], v[44:47], 0
  v_perm_b32 v51, v221, v217, s57
  s_nop 1
  v_mfma_f32_16x16x32_bf16 v[88:91], v[48:51], v[32:35], 0
  v_perm_b32 v52, v197, v193, s58
  v_mfma_f32_16x16x32_bf16 v[104:107], v[48:51], v[36:39], 0
  v_perm_b32 v53, v205, v201, s58
  v_mfma_f32_16x16x32_bf16 v[120:123], v[48:51], v[40:43], 0
  v_perm_b32 v54, v213, v209, s58
  v_mfma_f32_16x16x32_bf16 v[136:139], v[48:51], v[44:47], 0
  v_perm_b32 v55, v221, v217, s58
  s_waitcnt lgkmcnt(0)
  s_bitcmp1_b32 s43, 11
  s_cbranch_scc1 LI_dead_Xff1
  s_cmp_lt_u32 s45, 8
  s_cbranch_scc1 LI_tail_Xff1
  buffer_load_dwordx4 v[192:195], v[16:17], s[12:15], 0 idxen offen sc1
  buffer_load_dwordx4 v[196:199], v[18:19], s[12:15], 0 idxen offen sc1
  buffer_load_dwordx4 v[200:203], v[20:21], s[12:15], 0 idxen offen sc1
  buffer_load_dwordx4 v[204:207], v[22:23], s[12:15], 0 idxen offen sc1
  buffer_load_dwordx4 v[208:211], v[24:25], s[12:15], 0 idxen offen sc1
  buffer_load_dwordx4 v[212:215], v[26:27], s[12:15], 0 idxen offen sc1
  buffer_load_dwordx4 v[216:219], v[28:29], s[12:15], 0 idxen offen sc1
  buffer_load_dwordx4 v[220:223], v[30:31], s[12:15], 0 idxen offen sc1
  s_mov_b32 s47, s43
  s_movk_i32 s50, 8
  s_add_u32 s53, s53, 8
  s_cmp_eq_u32 s45, 8
  s_cbranch_scc1 LI_last_Xff1
  s_add_u32 s44, s44, 512
  s_add_u32 s78, s78, 64
  s_sub_u32 s45, s45, 8
  s_andn2_b32 s43, s43, 0x100
LI_end_Xff1:
  v_mfma_f32_16x16x32_bf16 v[92:95], v[52:55], v[32:35], 0
  v_mfma_f32_16x16x32_bf16 v[108:111], v[52:55], v[36:39], 0
  v_mfma_f32_16x16x32_bf16 v[124:127], v[52:55], v[40:43], 0
  v_mfma_f32_16x16x32_bf16 v[140:143], v[52:55], v[44:47], 0
  s_branch XJOIN_1
XH_1:
  s_bitcmp1_b32 s52, 8
  s_cbranch_scc1 XHF_1
  s_waitcnt lgkmcnt(4)
  v_lshl_add_u32 v56, v56, 5, v5
  v_lshl_add_u32 v57, v57, 5, v5
  ds_read_b64_tr_b16 v[32:33], v56
  ds_read_b64_tr_b16 v[34:35], v57
  v_perm_b32 v48, v198, v194, s57
  v_perm_b32 v49, v206, v202, s57
  v_perm_b32 v52, v198, v194, s58
  v_perm_b32 v53, v206, v202, s58
  s_waitcnt lgkmcnt(0)
  v_mfma_f32_16x16x16_bf16 v[144:147], v[32:33], v[48:49], v[144:147]
  v_lshlrev_b32 v56, 16, v32
  v_and_b32 v57, 0xffff0000, v32
  v_lshlrev_b32 v58, 16, v33
  v_mfma_f32_16x16x16_bf16 v[148:151], v[32:33], v[52:53], v[148:151]
  v_and_b32 v59, 0xffff0000, v33
  v_mul_f32 v64, v64, v56
  v_mul_f32 v65, v65, v56
  v_mul_f32 v66, v66, v56
  v_mul_f32 v68, v68, v57
  v_mul_f32 v69, v69, v57
  v_mul_f32 v70, v70, v57
  v_mul_f32 v72, v72, v58
  v_mul_f32 v73, v73, v58
  v_mul_f32 v74, v74, v58
  v_mul_f32 v76, v76, v59
  v_mul_f32 v77, v77, v59
  v_mul_f32 v78, v78, v59
  v_cvt_pk_bf16_f32 v36, v64, v68
  v_cvt_pk_bf16_f32 v37, v72, v76
  v_cvt_pk_bf16_f32 v40, v65, v69
  v_cvt_pk_bf16_f32 v41, v73, v77
  v_cvt_pk_bf16_f32 v44, v66, v70
  v_cvt_pk_bf16_f32 v45, v74, v78
  v_add_u32 v11, s44, v2
  v_add_u32 v13, s78, v3
  ds_read_b32 v16, v11 offset:1612
  ds_read_b32 v18, v11 offset:1676
  ds_read_b32 v20, v11 offset:1740
  ds_read_b32 v22, v11 offset:1804
  ds_read_b32 v24, v11 offset:1868
  ds_read_b32 v26, v11 offset:1932
  ds_read_b32 v28, v11 offset:1996
  ds_read_b32 v30, v11 offset:2060
  v_perm_b32 v48, v199, v195, s57
  v_perm_b32 v49, v207, v203, s57
  v_perm_b32 v52, v199, v195, s58
  v_perm_b32 v53, v207, v203, s58
  v_mfma_f32_16x16x16_bf16 v[152:155], v[32:33], v[48:49], v[152:155]
  s_nop 0
  v_mfma_f32_16x16x16_bf16 v[156:159], v[32:33], v[52:53], v[156:159]
  v_perm_b32 v48, v196, v192, s57
  v_perm_b32 v49, v204, v200, s57
  s_nop 1
  v_mfma_f32_16x16x16_bf16 v[80:83], v[48:49], v[32:33], v[80:83]
  v_perm_b32 v52, v196, v192, s58
  v_mfma_f32_16x16x16_bf16 v[96:99], v[48:49], v[36:37], v[96:99]
  v_perm_b32 v53, v204, v200, s58
  v_mfma_f32_16x16x16_bf16 v[112:115], v[48:49], v[40:41], v[112:115]
  v_mfma_f32_16x16x16_bf16 v[128:131], v[48:49], v[44:45], v[128:131]
  v_mfma_f32_16x16x16_bf16 v[84:87], v[52:53], v[32:33], v[84:87]
  v_perm_b32 v48, v197, v193, s57
  v_mfma_f32_16x16x16_bf16 v[100:103], v[52:53], v[36:37], v[100:103]
  v_perm_b32 v49, v205, v201, s57
  v_mfma_f32_16x16x16_bf16 v[116:119], v[52:53], v[40:41], v[116:119]
  v_mfma_f32_16x16x16_bf16 v[132:135], v[52:53], v[44:45], v[132:135]
  v_mfma_f32_16x16x16_bf16 v[88:91], v[48:49], v[32:33], v[88:91]
  v_perm_b32 v52, v197, v193, s58
  v_mfma_f32_16x16x16_bf16 v[104:107], v[48:49], v[36:37], v[104:107]
  v_perm_b32 v53, v205, v201, s58
  v_mfma_f32_16x16x16_bf16 v[120:123], v[48:49], v[40:41], v[120:123]
  v_mfma_f32_16x16x16_bf16 v[136:139], v[48:49], v[44:45], v[136:139]
  s_waitcnt lgkmcnt(0)
  s_bitcmp1_b32 s43, 11
  s_cbranch_scc1 LI_dead_Xrh1
  s_cmp_lt_u32 s45, 8
  s_cbranch_scc1 LI_tail_Xrh1
  buffer_load_dwordx4 v[192:195], v[16:17], s[12:15], 0 idxen offen sc1
  buffer_load_dwordx4 v[196:199], v[18:19], s[12:15], 0 idxen offen sc1
  buffer_load_dwordx4 v[200:203], v[20:21], s[12:15], 0 idxen offen sc1
  buffer_load_dwordx4 v[204:207], v[22:23], s[12:15], 0 idxen offen sc1
  buffer_load_dwordx4 v[208:211], v[24:25], s[12:15], 0 idxen offen sc1
  buffer_load_dwordx4 v[212:215], v[26:27], s[12:15], 0 idxen offen sc1
  buffer_load_dwordx4 v[216:219], v[28:29], s[12:15], 0 idxen offen sc1
  buffer_load_dwordx4 v[220:223], v[30:31], s[12:15], 0 idxen offen sc1
  s_mov_b32 s47, s43
  s_movk_i32 s50, 8
  s_add_u32 s53, s53, 8
  s_cmp_eq_u32 s45, 8
  s_cbranch_scc1 LI_last_Xrh1
  s_add_u32 s44, s44, 512
  s_add_u32 s78, s78, 64
  s_sub_u32 s45, s45, 8
  s_andn2_b32 s43, s43, 0x100
LI_end_Xrh1:
  v_mfma_f32_16x16x16_bf16 v[92:95], v[52:53], v[32:33], v[92:95]
  v_mfma_f32_16x16x16_bf16 v[108:111], v[52:53], v[36:37], v[108:111]
  v_mfma_f32_16x16x16_bf16 v[124:127], v[52:53], v[40:41], v[124:127]
  v_mfma_f32_16x16x16_bf16 v[140:143], v[52:53], v[44:45], v[140:143]
  s_branch XEPI_1
XHF_1:
  s_waitcnt lgkmcnt(4)
  v_lshl_add_u32 v56, v56, 5, v5
  v_lshl_add_u32 v57, v57, 5, v5
  ds_read_b64_tr_b16 v[32:33], v56
  ds_read_b64_tr_b16 v[34:35], v57
  s_and_b32 s82, s52, 63
  s_add_u32 s82, s82, s60
  s_lshl_b32 s82, s82, 9
  buffer_load_dwordx2 v[14:15], v6, s[20:23], s82 offen
  s_mov_b32 s53, 0
  v_perm_b32 v48, v198, v194, s57
  v_perm_b32 v49, v206, v202, s57
  v_perm_b32 v52, v198, v194, s58
  v_perm_b32 v53, v206, v202, s58
  s_waitcnt lgkmcnt(0)
  v_mfma_f32_16x16x16_bf16 v[144:147], v[32:33], v[48:49], 0
  v_lshlrev_b32 v56, 16, v32
  v_and_b32 v57, 0xffff0000, v32
  v_lshlrev_b32 v58, 16, v33
  v_mfma_f32_16x16x16_bf16 v[148:151], v[32:33], v[52:53], 0
  v_and_b32 v59, 0xffff0000, v33
  v_mul_f32 v64, v64, v56
  v_mul_f32 v65, v65, v56
  v_mul_f32 v66, v66, v56
  v_mul_f32 v68, v68, v57
  v_mul_f32 v69, v69, v57
  v_mul_f32 v70, v70, v57
  v_mul_f32 v72, v72, v58
  v_mul_f32 v73, v73, v58
  v_mul_f32 v74, v74, v58
  v_mul_f32 v76, v76, v59
  v_mul_f32 v77, v77, v59
  v_mul_f32 v78, v78, v59
  v_cvt_pk_bf16_f32 v36, v64, v68
  v_cvt_pk_bf16_f32 v37, v72, v76
  v_cvt_pk_bf16_f32 v40, v65, v69
  v_cvt_pk_bf16_f32 v41, v73, v77
  v_cvt_pk_bf16_f32 v44, v66, v70
  v_cvt_pk_bf16_f32 v45, v74, v78
  v_add_u32 v11, s44, v2
  v_add_u32 v13, s78, v3
  ds_read_b32 v16, v11 offset:1612
  ds_read_b32 v18, v11 offset:1676
  ds_read_b32 v20, v11 offset:1740
  ds_read_b32 v22, v11 offset:1804
  ds_read_b32 v24, v11 offset:1868
  ds_read_b32 v26, v11 offset:1932
  ds_read_b32 v28, v11 offset:1996
  ds_read_b32 v30, v11 offset:2060
  v_perm_b32 v48, v199, v195, s57
  v_perm_b32 v49, v207, v203, s57
  v_perm_b32 v52, v199, v195, s58
  v_perm_b32 v53, v207, v203, s58
  v_mfma_f32_16x16x16_bf16 v[152:155], v[32:33], v[48:49], 0
  s_nop 0
  v_mfma_f32_16x16x16_bf16 v[156:159], v[32:33], v[52:53], 0
  v_perm_b32 v48, v196, v192, s57
  v_perm_b32 v49, v204, v200, s57
  s_nop 1
  v_mfma_f32_16x16x16_bf16 v[80:83], v[48:49], v[32:33], 0
  v_perm_b32 v52, v196, v192, s58
  v_mfma_f32_16x16x16_bf16 v[96:99], v[48:49], v[36:37], 0
  v_perm_b32 v53, v204, v200, s58
  v_mfma_f32_16x16x16_bf16 v[112:115], v[48:49], v[40:41], 0
  v_mfma_f32_16x16x16_bf16 v[128:131], v[48:49], v[44:45], 0
  v_mfma_f32_16x16x16_bf16 v[84:87], v[52:53], v[32:33], 0
  v_perm_b32 v48, v197, v193, s57
  v_mfma_f32_16x16x16_bf16 v[100:103], v[52:53], v[36:37], 0
  v_perm_b32 v49, v205, v201, s57
  v_mfma_f32_16x16x16_bf16 v[116:119], v[52:53], v[40:41], 0
  v_mfma_f32_16x16x16_bf16 v[132:135], v[52:53], v[44:45], 0
  v_mfma_f32_16x16x16_bf16 v[88:91], v[48:49], v[32:33], 0
  v_perm_b32 v52, v197, v193, s58
  v_mfma_f32_16x16x16_bf16 v[104:107], v[48:49], v[36:37], 0
  v_perm_b32 v53, v205, v201, s58
  v_mfma_f32_16x16x16_bf16 v[120:123], v[48:49], v[40:41], 0
  v_mfma_f32_16x16x16_bf16 v[136:139], v[48:49], v[44:45], 0
  s_waitcnt lgkmcnt(0)
  s_bitcmp1_b32 s43, 11
  s_cbranch_scc1 LI_dead_Xfh1
  s_cmp_lt_u32 s45, 8
  s_cbranch_scc1 LI_tail_Xfh1
  buffer_load_dwordx4 v[192:195], v[16:17], s[12:15], 0 idxen offen sc1
  buffer_load_dwordx4 v[196:199], v[18:19], s[12:15], 0 idxen offen sc1
  buffer_load_dwordx4 v[200:203], v[20:21], s[12:15], 0 idxen offen sc1
  buffer_load_dwordx4 v[204:207], v[22:23], s[12:15], 0 idxen offen sc1
  buffer_load_dwordx4 v[208:211], v[24:25], s[12:15], 0 idxen offen sc1
  buffer_load_dwordx4 v[212:215], v[26:27], s[12:15], 0 idxen offen sc1
  buffer_load_dwordx4 v[216:219], v[28:29], s[12:15], 0 idxen offen sc1
  buffer_load_dwordx4 v[220:223], v[30:31], s[12:15], 0 idxen offen sc1
  s_mov_b32 s47, s43
  s_movk_i32 s50, 8
  s_add_u32 s53, s53, 8
  s_cmp_eq_u32 s45, 8
  s_cbranch_scc1 LI_last_Xfh1
  s_add_u32 s44, s44, 512
  s_add_u32 s78, s78, 64
  s_sub_u32 s45, s45, 8
  s_andn2_b32 s43, s43, 0x100
LI_end_Xfh1:
  v_mfma_f32_16x16x16_bf16 v[92:95], v[52:53], v[32:33], 0
  v_mfma_f32_16x16x16_bf16 v[108:111], v[52:53], v[36:37], 0
  v_mfma_f32_16x16x16_bf16 v[124:127], v[52:53], v[40:41], 0
  v_mfma_f32_16x16x16_bf16 v[140:143], v[52:53], v[44:45], 0
XEPI_1:
  s_mov_b32 s80, 77472
  v_lshl_add_u32 v16, v6, 1, s80
  ds_read_b128 v[32:35], v16 offset:20480
  ds_read_b128 v[36:39], v16 offset:21504
  ds_read_b128 v[40:43], v16 offset:22528
  ds_read_b128 v[44:47], v16 offset:23552
  ds_read_b128 v[56:59], v16 offset:1024
  ds_read_b128 v[64:67], v16 offset:9216
  ds_read_b128 v[60:63], v16 offset:5120
  ds_read_b128 v[68:71], v16 offset:13312
  ds_read_b128 v[72:75], v16 offset:17408
  ds_read_b128 v[76:79], v16 offset:25600
  v_cvt_pk_bf16_f32 v80, v80, v81
  v_cvt_pk_bf16_f32 v81, v82, v83
  v_cvt_pk_bf16_f32 v82, v84, v85
  v_cvt_pk_bf16_f32 v83, v86, v87
  v_cvt_pk_bf16_f32 v96, v96, v97
  v_cvt_pk_bf16_f32 v97, v98, v99
  v_cvt_pk_bf16_f32 v98, v100, v101
  v_cvt_pk_bf16_f32 v99, v102, v103
  v_cvt_pk_bf16_f32 v112, v112, v113
  v_cvt_pk_bf16_f32 v113, v114, v115
  v_cvt_pk_bf16_f32 v114, v116, v117
  v_cvt_pk_bf16_f32 v115, v118, v119
  v_cvt_pk_bf16_f32 v128, v128, v129
  v_cvt_pk_bf16_f32 v129, v130, v131
  v_cvt_pk_bf16_f32 v130, v132, v133
  v_cvt_pk_bf16_f32 v131, v134, v135
  v_cvt_pk_bf16_f32 v88, v88, v89
  v_cvt_pk_bf16_f32 v89, v90, v91
  v_cvt_pk_bf16_f32 v90, v92, v93
  v_cvt_pk_bf16_f32 v91, v94, v95
  v_cvt_pk_bf16_f32 v104, v104, v105
  v_cvt_pk_bf16_f32 v105, v106, v107
  v_cvt_pk_bf16_f32 v106, v108, v109
  v_cvt_pk_bf16_f32 v107, v110, v111
  v_cvt_pk_bf16_f32 v120, v120, v121
  v_cvt_pk_bf16_f32 v121, v122, v123
  v_cvt_pk_bf16_f32 v122, v124, v125
  v_cvt_pk_bf16_f32 v123, v126, v127
  v_cvt_pk_bf16_f32 v136, v136, v137
  v_cvt_pk_bf16_f32 v137, v138, v139
  v_cvt_pk_bf16_f32 v138, v140, v141
  v_cvt_pk_bf16_f32 v139, v142, v143
  s_waitcnt lgkmcnt(0)
  v_mfma_f32_16x16x32_bf16 v[92:95], v[80:83], v[56:59], 0
  v_mul_f32 v144, v32, v144
  v_mul_f32 v148, v36, v148
  v_mfma_f32_16x16x32_bf16 v[108:111], v[96:99], v[64:67], 0
  v_mul_f32 v152, v40, v152
  v_mul_f32 v156, v44, v156
  v_mfma_f32_16x16x32_bf16 v[124:127], v[112:115], v[64:67], 0
  v_fmac_f32 v144, v33, v145
  v_fmac_f32 v148, v37, v149
  v_mfma_f32_16x16x32_bf16 v[140:143], v[128:131], v[64:67], 0
  v_fmac_f32 v152, v41, v153
  v_fmac_f32 v156, v45, v157
  v_mfma_f32_16x16x32_bf16 v[92:95], v[88:91], v[60:63], v[92:95]
  v_fmac_f32 v144, v34, v146
  v_fmac_f32 v148, v38, v150
  v_mfma_f32_16x16x32_bf16 v[108:111], v[104:107], v[68:71], v[108:111]
  v_fmac_f32 v152, v42, v154
  v_fmac_f32 v156, v46, v158
  v_mfma_f32_16x16x32_bf16 v[124:127], v[120:123], v[68:71], v[124:127]
  v_fmac_f32 v144, v35, v147
  v_fmac_f32 v148, v39, v151
  v_mfma_f32_16x16x32_bf16 v[140:143], v[136:139], v[68:71], v[140:143]
  v_fmac_f32 v152, v43, v155
  v_fmac_f32 v156, v47, v159
  ds_read_b128 v[32:35], v16 offset:0
  ds_read_b128 v[40:43], v16 offset:8192
  ds_read_b128 v[36:39], v16 offset:4096
  ds_read_b128 v[44:47], v16 offset:12288
  ds_read_b128 v[48:51], v16 offset:16384
  ds_read_b128 v[52:55], v16 offset:24576
  s_and_b32 s80, s52, 63
  s_lshl_b32 s81, s80, 9
  s_add_u32 s81, s81, 105632
  v_lshl_add_u32 v18, v2, 4, v1
  v_add_u32 v18, s81, v18
  v_mul_f32 v149, v72, v92
  v_fmac_f32 v148, v76, v108
  v_mul_f32 v150, v76, v124
  v_mul_f32 v151, v76, v140
  v_fmac_f32 v149, v73, v93
  v_fmac_f32 v148, v77, v109
  v_fmac_f32 v150, v77, v125
  v_fmac_f32 v151, v77, v141
  s_waitcnt lgkmcnt(0)
  v_mfma_f32_16x16x32_bf16 v[84:87], v[80:83], v[32:35], 0
  v_fmac_f32 v149, v74, v94
  v_mfma_f32_16x16x32_bf16 v[100:103], v[96:99], v[40:43], 0
  v_fmac_f32 v148, v78, v110
  v_mfma_f32_16x16x32_bf16 v[116:119], v[112:115], v[40:43], 0
  v_fmac_f32 v150, v78, v126
  v_mfma_f32_16x16x32_bf16 v[132:135], v[128:131], v[40:43], 0
  v_fmac_f32 v151, v78, v142
  v_mfma_f32_16x16x32_bf16 v[84:87], v[88:91], v[36:39], v[84:87]
  v_fmac_f32 v149, v75, v95
  v_mfma_f32_16x16x32_bf16 v[100:103], v[104:107], v[44:47], v[100:103]
  v_fmac_f32 v148, v79, v111
  v_mfma_f32_16x16x32_bf16 v[116:119], v[120:123], v[44:47], v[116:119]
  v_fmac_f32 v150, v79, v127
  v_mfma_f32_16x16x32_bf16 v[132:135], v[136:139], v[44:47], v[132:135]
  v_fmac_f32 v151, v79, v143
  ds_read_b128 v[56:59], v16 offset:3072
  ds_read_b128 v[64:67], v16 offset:11264
  ds_read_b128 v[60:63], v16 offset:7168
  ds_read_b128 v[68:71], v16 offset:15360
  ds_read_b128 v[72:75], v16 offset:19456
  ds_read_b128 v[76:79], v16 offset:27648
  s_nop 3
  v_mul_f32 v145, v48, v84
  v_fmac_f32 v144, v52, v100
  v_mul_f32 v146, v52, v116
  v_mul_f32 v147, v52, v132
  v_fmac_f32 v145, v49, v85
  v_fmac_f32 v144, v53, v101
  v_fmac_f32 v146, v53, v117
  v_fmac_f32 v147, v53, v133
  s_waitcnt lgkmcnt(0)
  v_mfma_f32_16x16x32_bf16 v[92:95], v[80:83], v[56:59], 0
  v_fmac_f32 v145, v50, v86
  v_mfma_f32_16x16x32_bf16 v[108:111], v[96:99], v[64:67], 0
  v_fmac_f32 v144, v54, v102
  v_mfma_f32_16x16x32_bf16 v[124:127], v[112:115], v[64:67], 0
  v_fmac_f32 v146, v54, v118
  v_mfma_f32_16x16x32_bf16 v[140:143], v[128:131], v[64:67], 0
  v_fmac_f32 v147, v54, v134
  v_mfma_f32_16x16x32_bf16 v[92:95], v[88:91], v[60:63], v[92:95]
  v_fmac_f32 v145, v51, v87
  v_mfma_f32_16x16x32_bf16 v[108:111], v[104:107], v[68:71], v[108:111]
  v_fmac_f32 v144, v55, v103
  v_mfma_f32_16x16x32_bf16 v[124:127], v[120:123], v[68:71], v[124:127]
  v_fmac_f32 v146, v55, v119
  v_mfma_f32_16x16x32_bf16 v[140:143], v[136:139], v[68:71], v[140:143]
  v_fmac_f32 v147, v55, v135
  ds_read_b128 v[32:35], v16 offset:2048
  ds_read_b128 v[40:43], v16 offset:10240
  ds_read_b128 v[36:39], v16 offset:6144
  ds_read_b128 v[44:47], v16 offset:14336
  ds_read_b128 v[48:51], v16 offset:18432
  ds_read_b128 v[52:55], v16 offset:26624
  s_nop 3
  v_mul_f32 v157, v72, v92
  v_fmac_f32 v156, v76, v108
  v_mul_f32 v158, v76, v124
  v_mul_f32 v159, v76, v140
  v_fmac_f32 v157, v73, v93
  v_fmac_f32 v156, v77, v109
  v_fmac_f32 v158, v77, v125
  v_fmac_f32 v159, v77, v141
  s_waitcnt lgkmcnt(0)
  v_mfma_f32_16x16x32_bf16 v[84:87], v[80:83], v[32:35], 0
  v_fmac_f32 v157, v74, v94
  v_mfma_f32_16x16x32_bf16 v[100:103], v[96:99], v[40:43], 0
  v_fmac_f32 v156, v78, v110
  v_mfma_f32_16x16x32_bf16 v[116:119], v[112:115], v[40:43], 0
  v_fmac_f32 v158, v78, v126
  v_mfma_f32_16x16x32_bf16 v[132:135], v[128:131], v[40:43], 0
  v_fmac_f32 v159, v78, v142
  v_mfma_f32_16x16x32_bf16 v[84:87], v[88:91], v[36:39], v[84:87]
  v_fmac_f32 v157, v75, v95
  v_mfma_f32_16x16x32_bf16 v[100:103], v[104:107], v[44:47], v[100:103]
  v_fmac_f32 v156, v79, v111
  v_mfma_f32_16x16x32_bf16 v[116:119], v[120:123], v[44:47], v[116:119]
  v_fmac_f32 v158, v79, v127
  v_mfma_f32_16x16x32_bf16 v[132:135], v[136:139], v[44:47], v[132:135]
  v_fmac_f32 v159, v79, v143
  ds_read_b128 v[60:63], v18
  v_mul_f32 v153, v48, v84
  s_nop 0
  v_fmac_f32 v152, v52, v100
  s_nop 0
  v_mul_f32 v154, v52, v116
  s_nop 0
  v_mul_f32 v155, v52, v132
  v_fmac_f32 v153, v49, v85
  v_fmac_f32 v152, v53, v101
  v_fmac_f32 v154, v53, v117
  v_fmac_f32 v155, v53, v133
  v_fmac_f32 v153, v50, v86
  v_fmac_f32 v152, v54, v102
  v_fmac_f32 v154, v54, v118
  v_fmac_f32 v155, v54, v134
  v_fmac_f32 v153, v51, v87
  v_fmac_f32 v152, v55, v103
  v_fmac_f32 v154, v55, v119
  v_fmac_f32 v155, v55, v135
  v_permlane32_swap_b32 v145, v146
  v_permlane32_swap_b32 v144, v147
  v_permlane32_swap_b32 v149, v150
  v_permlane32_swap_b32 v148, v151
  v_permlane32_swap_b32 v153, v154
  v_permlane32_swap_b32 v152, v155
  v_permlane32_swap_b32 v157, v158
  v_permlane32_swap_b32 v156, v159
  v_add_f32 v145, v145, v146
  v_add_f32 v144, v144, v147
  v_add_f32 v149, v149, v150
  v_add_f32 v148, v148, v151
  v_add_f32 v153, v153, v154
  v_add_f32 v152, v152, v155
  v_add_f32 v157, v157, v158
  v_add_f32 v156, v156, v159
  v_permlane16_swap_b32 v145, v144
  v_permlane16_swap_b32 v149, v148
  v_permlane16_swap_b32 v153, v152
  v_permlane16_swap_b32 v157, v156
  v_add_f32 v145, v145, v144
  v_add_f32 v149, v149, v148
  v_add_f32 v153, v153, v152
  v_add_f32 v157, v157, v156
  s_waitcnt lgkmcnt(0)
  s_cmp_lg_u32 s79, 0
  s_cbranch_scc1 EX_fb_X1
  s_cmp_lt_u32 s53, 12
  s_cbranch_scc1 EX_rw_X1
  s_waitcnt vmcnt(12)
EX_rwd_X1:
  s_mov_b32 exec_lo, 0
  v_add_f32 v145, v145, v60
  v_add_f32 v149, v149, v61
  v_add_f32 v153, v153, v62
  v_add_f32 v157, v157, v63
  s_mov_b64 exec, -1
  v_lshlrev_b32 v32, 16, v14
  v_and_b32 v33, 0xffff0000, v14
  v_lshlrev_b32 v34, 16, v15
  v_and_b32 v35, 0xffff0000, v15
  v_add_f32 v32, v32, v145
  v_add_f32 v33, v33, v149
  v_add_f32 v34, v34, v153
  v_add_f32 v35, v35, v157
  v_cvt_pk_bf16_f32 v36, v32, v33
  v_cvt_pk_bf16_f32 v37, v34, v35
  s_add_u32 s80, s80, s60
  s_lshl_b32 s80, s80, 9
  buffer_store_dwordx2 v[36:37], v6, s[24:27], s80 offen
EX_end_X1:
  s_branch XLOOP_2
WS_X2:
  s_cmp_lt_u32 s80, 13
  s_cbranch_scc1 WS13_X2
  s_waitcnt vmcnt(13)
  s_branch WD_X2
WS13_X2:
  s_cmp_lt_u32 s80, 10
  s_cbranch_scc1 WS10_X2
  s_waitcnt vmcnt(10)
  s_branch WD_X2
WS10_X2:
  s_cmp_lt_u32 s80, 8
  s_cbranch_scc1 WS8_X2
  s_waitcnt vmcnt(8)
  s_branch WD_X2
WS8_X2:
  s_cmp_lt_u32 s80, 5
  s_cbranch_scc1 WS5_X2
  s_waitcnt vmcnt(5)
  s_branch WD_X2
WS5_X2:
  s_cmp_lt_u32 s80, 2
  s_cbranch_scc1 WS2_X2
  s_waitcnt vmcnt(2)
  s_branch WD_X2
WS2_X2:
  s_waitcnt vmcnt(0)
  s_branch WD_X2
LI_dead_Xrf2:
  s_movk_i32 s48, 0x800
  s_mov_b32 s51, 0
  s_branch LI_end_Xrf2
LI_tail_Xrf2:
  s_mov_b32 s51, s45
  s_add_u32 s53, s53, s45
  s_cmp_le_u32 s45, 4
  s_cselect_b32 s81, 0x1000, 0
  s_or_b32 s48, s43, s81
  s_cmp_le_u32 s45, 0
  s_cbranch_scc1 LI_last_Xrf2
  buffer_load_dwordx4 v[224:227], v[16:17], s[12:15], 0 idxen offen sc1
  s_cmp_le_u32 s45, 1
  s_cbranch_scc1 LI_last_Xrf2
  buffer_load_dwordx4 v[228:231], v[18:19], s[12:15], 0 idxen offen sc1
  s_cmp_le_u32 s45, 2
  s_cbranch_scc1 LI_last_Xrf2
  buffer_load_dwordx4 v[232:235], v[20:21], s[12:15], 0 idxen offen sc1
  s_cmp_le_u32 s45, 3
  s_cbranch_scc1 LI_last_Xrf2
  buffer_load_dwordx4 v[236:239], v[22:23], s[12:15], 0 idxen offen sc1
  s_cmp_le_u32 s45, 4
  s_cbranch_scc1 LI_last_Xrf2
  buffer_load_dwordx4 v[240:243], v[24:25], s[12:15], 0 idxen offen sc1
  s_cmp_le_u32 s45, 5
  s_cbranch_scc1 LI_last_Xrf2
  buffer_load_dwordx4 v[244:247], v[26:27], s[12:15], 0 idxen offen sc1
  s_cmp_le_u32 s45, 6
  s_cbranch_scc1 LI_last_Xrf2
  buffer_load_dwordx4 v[248:251], v[28:29], s[12:15], 0 idxen offen sc1
LI_last_Xrf2:
  s_or_b32 s48, s48, 0x200
NS_top_Xrf2:
  s_bitcmp1_b32 s55, 0
  s_cselect_b32 s85, s73, s72
  s_mul_i32 s84, s55, s74
  s_add_u32 s84, s84, s85
  s_add_u32 s55, s55, 1
  s_cmp_ge_u32 s84, s75
  s_cbranch_scc1 NS_end_Xrf2
  v_readlane_b32 s85, v8, s84
  s_nop 1
  s_and_b32 s86, s85, 63
  s_or_b32 s43, s56, s86
  s_bfe_u32 s44, s85, 0xc0006
  s_lshl_b32 s44, s44, 4
  s_lshr_b32 s45, s85, 18
  v_readlane_b32 s78, v7, s84
  s_branch LI_end_Xrf2
NS_end_Xrf2:
  s_cmp_eq_u32 s56, 0x100
  s_cbranch_scc0 NS_dead_Xrf2
  s_movk_i32 s56, 0x500
  s_mov_b32 s55, 0
  s_mov_b32 s12, s36
  s_mov_b32 s13, s37
  s_branch NS_top_Xrf2
NS_dead_Xrf2:
  s_movk_i32 s56, 0x800
  s_movk_i32 s43, 0x800
  s_mov_b32 s45, 0
  s_mov_b32 s44, 0
  s_mov_b32 s78, 0
  s_branch LI_end_Xrf2
XDISP_2:
  s_bitcmp1_b32 s52, 12
  s_cbranch_scc1 XH_2
  s_waitcnt lgkmcnt(4)
  v_lshl_add_u32 v56, v56, 5, v5
  v_lshl_add_u32 v57, v57, 5, v5
  ds_read_b64_tr_b16 v[32:33], v56
  ds_read_b64_tr_b16 v[34:35], v57
  s_and_b32 s82, s52, 63
  s_add_u32 s82, s82, s60
  s_lshl_b32 s82, s82, 9
  buffer_load_dwordx2 v[14:15], v6, s[20:23], s82 offen
  s_mov_b32 s53, 0
  v_perm_b32 v48, v230, v226, s57
  v_perm_b32 v49, v238, v234, s57
  v_perm_b32 v50, v246, v242, s57
  v_perm_b32 v51, v254, v250, s57
  v_perm_b32 v52, v230, v226, s58
  v_perm_b32 v53, v238, v234, s58
  v_perm_b32 v54, v246, v242, s58
  v_perm_b32 v55, v254, v250, s58
  s_waitcnt lgkmcnt(0)
  v_mfma_f32_16x16x32_bf16 v[144:147], v[32:35], v[48:51], 0
  v_lshlrev_b32 v56, 16, v32
  v_and_b32 v57, 0xffff0000, v32
  v_lshlrev_b32 v58, 16, v33
  v_mfma_f32_16x16x32_bf16 v[148:151], v[32:35], v[52:55], 0
  v_and_b32 v59, 0xffff0000, v33
  v_lshlrev_b32 v60, 16, v34
  v_and_b32 v61, 0xffff0000, v34
  v_lshlrev_b32 v62, 16, v35
  v_and_b32 v63, 0xffff0000, v35
  v_mul_f32 v64, v64, v56
  v_mul_f32 v65, v65, v56
  v_mul_f32 v66, v66, v56
  v_mul_f32 v68, v68, v57
  v_mul_f32 v69, v69, v57
  v_mul_f32 v70, v70, v57
  v_mul_f32 v72, v72, v58
  v_mul_f32 v73, v73, v58
  v_mul_f32 v74, v74, v58
  v_mul_f32 v76, v76, v59
  v_mul_f32 v77, v77, v59
  v_mul_f32 v78, v78, v59
  v_cvt_pk_bf16_f32 v36, v64, v68
  v_cvt_pk_bf16_f32 v37, v72, v76
  v_cvt_pk_bf16_f32 v40, v65, v69
  v_cvt_pk_bf16_f32 v41, v73, v77
  v_cvt_pk_bf16_f32 v44, v66, v70
  v_cvt_pk_bf16_f32 v45, v74, v78
  ds_read_b128 v[64:67], v12 offset:1856
  ds_read_b128 v[68:71], v12 offset:1920
  ds_read_b128 v[72:75], v12 offset:1984
  ds_read_b128 v[76:79], v12 offset:2048
  v_add_u32 v12, s44, v2
  v_add_u32 v9, s78, v3
  ds_read_b32 v16, v12 offset:1612
  ds_read_b32 v18, v12 offset:1676
  ds_read_b32 v20, v12 offset:1740
  ds_read_b32 v22, v12 offset:1804
  ds_read_b32 v24, v12 offset:1868
  ds_read_b32 v26, v12 offset:1932
  ds_read_b32 v28, v12 offset:1996
  ds_read_b32 v30, v12 offset:2060
  v_perm_b32 v48, v231, v227, s57
  v_perm_b32 v49, v239, v235, s57
  v_perm_b32 v50, v247, v243, s57
  v_perm_b32 v51, v255, v251, s57
  v_perm_b32 v52, v231, v227, s58
  v_perm_b32 v53, v239, v235, s58
  v_perm_b32 v54, v247, v243, s58
  v_perm_b32 v55, v255, v251, s58
  s_waitcnt lgkmcnt(8)
  v_mfma_f32_16x16x32_bf16 v[152:155], v[32:35], v[48:51], 0
  v_mul_f32 v64, v64, v60
  v_mul_f32 v65, v65, v60
  v_mul_f32 v66, v66, v60
  v_mfma_f32_16x16x32_bf16 v[156:159], v[32:35], v[52:55], 0
  v_mul_f32 v68, v68, v61
  v_mul_f32 v69, v69, v61
  v_mul_f32 v70, v70, v61
  v_mul_f32 v72, v72, v62
  v_mul_f32 v73, v73, v62
  v_mul_f32 v74, v74, v62
  v_mul_f32 v76, v76, v63
  v_mul_f32 v77, v77, v63
  v_mul_f32 v78, v78, v63
  v_cvt_pk_bf16_f32 v38, v64, v68
  v_cvt_pk_bf16_f32 v39, v72, v76
  v_cvt_pk_bf16_f32 v42, v65, v69
  v_cvt_pk_bf16_f32 v43, v73, v77
  v_cvt_pk_bf16_f32 v46, v66, v70
  v_cvt_pk_bf16_f32 v47, v74, v78
  v_perm_b32 v48, v228, v224, s57
  v_perm_b32 v49, v236, v232, s57
  v_perm_b32 v50, v244, v240, s57
  v_perm_b32 v51, v252, v248, s57
  s_nop 1
  v_mfma_f32_16x16x32_bf16 v[80:83], v[48:51], v[32:35], 0
  v_perm_b32 v52, v228, v224, s58
  v_mfma_f32_16x16x32_bf16 v[96:99], v[48:51], v[36:39], 0
  v_perm_b32 v53, v236, v232, s58
  v_mfma_f32_16x16x32_bf16 v[112:115], v[48:51], v[40:43], 0
  v_perm_b32 v54, v244, v240, s58
  v_mfma_f32_16x16x32_bf16 v[128:131], v[48:51], v[44:47], 0
  v_perm_b32 v55, v252, v248, s58
  s_nop 1
  v_mfma_f32_16x16x32_bf16 v[84:87], v[52:55], v[32:35], 0
  v_perm_b32 v48, v229, v225, s57
  v_mfma_f32_16x16x32_bf16 v[100:103], v[52:55], v[36:39], 0
  v_perm_b32 v49, v237, v233, s57
  v_mfma_f32_16x16x32_bf16 v[116:119], v[52:55], v[40:43], 0
  v_perm_b32 v50, v245, v241, s57
  v_mfma_f32_16x16x32_bf16 v[132:135], v[52:55], v[44:47], 0
  v_perm_b32 v51, v253, v249, s57
  s_nop 1
  v_mfma_f32_16x16x32_bf16 v[88:91], v[48:51], v[32:35], 0
  v_perm_b32 v52, v229, v225, s58
  v_mfma_f32_16x16x32_bf16 v[104:107], v[48:51], v[36:39], 0
  v_perm_b32 v53, v237, v233, s58
  v_mfma_f32_16x16x32_bf16 v[120:123], v[48:51], v[40:43], 0
  v_perm_b32 v54, v245, v241, s58
  v_mfma_f32_16x16x32_bf16 v[136:139], v[48:51], v[44:47], 0
  v_perm_b32 v55, v253, v249, s58
  s_waitcnt lgkmcnt(0)
  s_bitcmp1_b32 s43, 11
  s_cbranch_scc1 LI_dead_Xff2
  s_cmp_lt_u32 s45, 8
  s_cbranch_scc1 LI_tail_Xff2
  buffer_load_dwordx4 v[224:227], v[16:17], s[12:15], 0 idxen offen sc1
  buffer_load_dwordx4 v[228:231], v[18:19], s[12:15], 0 idxen offen sc1
  buffer_load_dwordx4 v[232:235], v[20:21], s[12:15], 0 idxen offen sc1
  buffer_load_dwordx4 v[236:239], v[22:23], s[12:15], 0 idxen offen sc1
  buffer_load_dwordx4 v[240:243], v[24:25], s[12:15], 0 idxen offen sc1
  buffer_load_dwordx4 v[244:247], v[26:27], s[12:15], 0 idxen offen sc1
  buffer_load_dwordx4 v[248:251], v[28:29], s[12:15], 0 idxen offen sc1
  buffer_load_dwordx4 v[252:255], v[30:31], s[12:15], 0 idxen offen sc1
  s_mov_b32 s48, s43
  s_movk_i32 s51, 8
  s_add_u32 s53, s53, 8
  s_cmp_eq_u32 s45, 8
  s_cbranch_scc1 LI_last_Xff2
  s_add_u32 s44, s44, 512
  s_add_u32 s78, s78, 64
  s_sub_u32 s45, s45, 8
  s_andn2_b32 s43, s43, 0x100
LI_end_Xff2:
  v_mfma_f32_16x16x32_bf16 v[92:95], v[52:55], v[32:35], 0
  v_mfma_f32_16x16x32_bf16 v[108:111], v[52:55], v[36:39], 0
  v_mfma_f32_16x16x32_bf16 v[124:127], v[52:55], v[40:43], 0
  v_mfma_f32_16x16x32_bf16 v[140:143], v[52:55], v[44:47], 0
  s_branch XJOIN_2
XH_2:
  s_bitcmp1_b32 s52, 8
  s_cbranch_scc1 XHF_2
  s_waitcnt lgkmcnt(4)
  v_lshl_add_u32 v56, v56, 5, v5
  v_lshl_add_u32 v57, v57, 5, v5
  ds_read_b64_tr_b16 v[32:33], v56
  ds_read_b64_tr_b16 v[34:35], v57
  v_perm_b32 v48, v230, v226, s57
  v_perm_b32 v49, v238, v234, s57
  v_perm_b32 v52, v230, v226, s58
  v_perm_b32 v53, v238, v234, s58
  s_waitcnt lgkmcnt(0)
  v_mfma_f32_16x16x16_bf16 v[144:147], v[32:33], v[48:49], v[144:147]
  v_lshlrev_b32 v56, 16, v32
  v_and_b32 v57, 0xffff0000, v32
  v_lshlrev_b32 v58, 16, v33
  v_mfma_f32_16x16x16_bf16 v[148:151], v[32:33], v[52:53], v[148:151]
  v_and_b32 v59, 0xffff0000, v33
  v_mul_f32 v64, v64, v56
  v_mul_f32 v65, v65, v56
  v_mul_f32 v66, v66, v56
  v_mul_f32 v68, v68, v57
  v_mul_f32 v69, v69, v57
  v_mul_f32 v70, v70, v57
  v_mul_f32 v72, v72, v58
  v_mul_f32 v73, v73, v58
  v_mul_f32 v74, v74, v58
  v_mul_f32 v76, v76, v59
  v_mul_f32 v77, v77, v59
  v_mul_f32 v78, v78, v59
  v_cvt_pk_bf16_f32 v36, v64, v68
  v_cvt_pk_bf16_f32 v37, v72, v76
  v_cvt_pk_bf16_f32 v40, v65, v69
  v_cvt_pk_bf16_f32 v41, v73, v77
  v_cvt_pk_bf16_f32 v44, v66, v70
  v_cvt_pk_bf16_f32 v45, v74, v78
  v_add_u32 v12, s44, v2
  v_add_u32 v9, s78, v3
  ds_read_b32 v16, v12 offset:1612
  ds_read_b32 v18, v12 offset:1676
  ds_read_b32 v20, v12 offset:1740
  ds_read_b32 v22, v12 offset:1804
  ds_read_b32 v24, v12 offset:1868
  ds_read_b32 v26, v12 offset:1932
  ds_read_b32 v28, v12 offset:1996
  ds_read_b32 v30, v12 offset:2060
  v_perm_b32 v48, v231, v227, s57
  v_perm_b32 v49, v239, v235, s57
  v_perm_b32 v52, v231, v227, s58
  v_perm_b32 v53, v239, v235, s58
  v_mfma_f32_16x16x16_bf16 v[152:155], v[32:33], v[48:49], v[152:155]
  s_nop 0
  v_mfma_f32_16x16x16_bf16 v[156:159], v[32:33], v[52:53], v[156:159]
  v_perm_b32 v48, v228, v224, s57
  v_perm_b32 v49, v236, v232, s57
  s_nop 1
  v_mfma_f32_16x16x16_bf16 v[80:83], v[48:49], v[32:33], v[80:83]
  v_perm_b32 v52, v228, v224, s58
  v_mfma_f32_16x16x16_bf16 v[96:99], v[48:49], v[36:37], v[96:99]
  v_perm_b32 v53, v236, v232, s58
  v_mfma_f32_16x16x16_bf16 v[112:115], v[48:49], v[40:41], v[112:115]
  v_mfma_f32_16x16x16_bf16 v[128:131], v[48:49], v[44:45], v[128:131]
  v_mfma_f32_16x16x16_bf16 v[84:87], v[52:53], v[32:33], v[84:87]
  v_perm_b32 v48, v229, v225, s57
  v_mfma_f32_16x16x16_bf16 v[100:103], v[52:53], v[36:37], v[100:103]
  v_perm_b32 v49, v237, v233, s57
  v_mfma_f32_16x16x16_bf16 v[116:119], v[52:53], v[40:41], v[116:119]
  v_mfma_f32_16x16x16_bf16 v[132:135], v[52:53], v[44:45], v[132:135]
  v_mfma_f32_16x16x16_bf16 v[88:91], v[48:49], v[32:33], v[88:91]
  v_perm_b32 v52, v229, v225, s58
  v_mfma_f32_16x16x16_bf16 v[104:107], v[48:49], v[36:37], v[104:107]
  v_perm_b32 v53, v237, v233, s58
  v_mfma_f32_16x16x16_bf16 v[120:123], v[48:49], v[40:41], v[120:123]
  v_mfma_f32_16x16x16_bf16 v[136:139], v[48:49], v[44:45], v[136:139]
  s_waitcnt lgkmcnt(0)
  s_bitcmp1_b32 s43, 11
  s_cbranch_scc1 LI_dead_Xrh2
  s_cmp_lt_u32 s45, 8
  s_cbranch_scc1 LI_tail_Xrh2
  buffer_load_dwordx4 v[224:227], v[16:17], s[12:15], 0 idxen offen sc1
  buffer_load_dwordx4 v[228:231], v[18:19], s[12:15], 0 idxen offen sc1
  buffer_load_dwordx4 v[232:235], v[20:21], s[12:15], 0 idxen offen sc1
  buffer_load_dwordx4 v[236:239], v[22:23], s[12:15], 0 idxen offen sc1
  buffer_load_dwordx4 v[240:243], v[24:25], s[12:15], 0 idxen offen sc1
  buffer_load_dwordx4 v[244:247], v[26:27], s[12:15], 0 idxen offen sc1
  buffer_load_dwordx4 v[248:251], v[28:29], s[12:15], 0 idxen offen sc1
  buffer_load_dwordx4 v[252:255], v[30:31], s[12:15], 0 idxen offen sc1
  s_mov_b32 s48, s43
  s_movk_i32 s51, 8
  s_add_u32 s53, s53, 8
  s_cmp_eq_u32 s45, 8
  s_cbranch_scc1 LI_last_Xrh2
  s_add_u32 s44, s44, 512
  s_add_u32 s78, s78, 64
  s_sub_u32 s45, s45, 8
  s_andn2_b32 s43, s43, 0x100
LI_end_Xrh2:
  v_mfma_f32_16x16x16_bf16 v[92:95], v[52:53], v[32:33], v[92:95]
  v_mfma_f32_16x16x16_bf16 v[108:111], v[52:53], v[36:37], v[108:111]
  v_mfma_f32_16x16x16_bf16 v[124:127], v[52:53], v[40:41], v[124:127]
  v_mfma_f32_16x16x16_bf16 v[140:143], v[52:53], v[44:45], v[140:143]
  s_branch XEPI_2
XHF_2:
  s_waitcnt lgkmcnt(4)
  v_lshl_add_u32 v56, v56, 5, v5
  v_lshl_add_u32 v57, v57, 5, v5
  ds_read_b64_tr_b16 v[32:33], v56
  ds_read_b64_tr_b16 v[34:35], v57
  s_and_b32 s82, s52, 63
  s_add_u32 s82, s82, s60
  s_lshl_b32 s82, s82, 9
  buffer_load_dwordx2 v[14:15], v6, s[20:23], s82 offen
  s_mov_b32 s53, 0
  v_perm_b32 v48, v230, v226, s57
  v_perm_b32 v49, v238, v234, s57
  v_perm_b32 v52, v230, v226, s58
  v_perm_b32 v53, v238, v234, s58
  s_waitcnt lgkmcnt(0)
  v_mfma_f32_16x16x16_bf16 v[144:147], v[32:33], v[48:49], 0
  v_lshlrev_b32 v56, 16, v32
  v_and_b32 v57, 0xffff0000, v32
  v_lshlrev_b32 v58, 16, v33
  v_mfma_f32_16x16x16_bf16 v[148:151], v[32:33], v[52:53], 0
  v_and_b32 v59, 0xffff0000, v33
  v_mul_f32 v64, v64, v56
  v_mul_f32 v65, v65, v56
  v_mul_f32 v66, v66, v56
  v_mul_f32 v68, v68, v57
  v_mul_f32 v69, v69, v57
  v_mul_f32 v70, v70, v57
  v_mul_f32 v72, v72, v58
  v_mul_f32 v73, v73, v58
  v_mul_f32 v74, v74, v58
  v_mul_f32 v76, v76, v59
  v_mul_f32 v77, v77, v59
  v_mul_f32 v78, v78, v59
  v_cvt_pk_bf16_f32 v36, v64, v68
  v_cvt_pk_bf16_f32 v37, v72, v76
  v_cvt_pk_bf16_f32 v40, v65, v69
  v_cvt_pk_bf16_f32 v41, v73, v77
  v_cvt_pk_bf16_f32 v44, v66, v70
  v_cvt_pk_bf16_f32 v45, v74, v78
  v_add_u32 v12, s44, v2
  v_add_u32 v9, s78, v3
  ds_read_b32 v16, v12 offset:1612
  ds_read_b32 v18, v12 offset:1676
  ds_read_b32 v20, v12 offset:1740
  ds_read_b32 v22, v12 offset:1804
  ds_read_b32 v24, v12 offset:1868
  ds_read_b32 v26, v12 offset:1932
  ds_read_b32 v28, v12 offset:1996
  ds_read_b32 v30, v12 offset:2060
  v_perm_b32 v48, v231, v227, s57
  v_perm_b32 v49, v239, v235, s57
  v_perm_b32 v52, v231, v227, s58
  v_perm_b32 v53, v239, v235, s58
  v_mfma_f32_16x16x16_bf16 v[152:155], v[32:33], v[48:49], 0
  s_nop 0
  v_mfma_f32_16x16x16_bf16 v[156:159], v[32:33], v[52:53], 0
  v_perm_b32 v48, v228, v224, s57
  v_perm_b32 v49, v236, v232, s57
  s_nop 1
  v_mfma_f32_16x16x16_bf16 v[80:83], v[48:49], v[32:33], 0
  v_perm_b32 v52, v228, v224, s58
  v_mfma_f32_16x16x16_bf16 v[96:99], v[48:49], v[36:37], 0
  v_perm_b32 v53, v236, v232, s58
  v_mfma_f32_16x16x16_bf16 v[112:115], v[48:49], v[40:41], 0
  v_mfma_f32_16x16x16_bf16 v[128:131], v[48:49], v[44:45], 0
  v_mfma_f32_16x16x16_bf16 v[84:87], v[52:53], v[32:33], 0
  v_perm_b32 v48, v229, v225, s57
  v_mfma_f32_16x16x16_bf16 v[100:103], v[52:53], v[36:37], 0
  v_perm_b32 v49, v237, v233, s57
  v_mfma_f32_16x16x16_bf16 v[116:119], v[52:53], v[40:41], 0
  v_mfma_f32_16x16x16_bf16 v[132:135], v[52:53], v[44:45], 0
  v_mfma_f32_16x16x16_bf16 v[88:91], v[48:49], v[32:33], 0
  v_perm_b32 v52, v229, v225, s58
  v_mfma_f32_16x16x16_bf16 v[104:107], v[48:49], v[36:37], 0
  v_perm_b32 v53, v237, v233, s58
  v_mfma_f32_16x16x16_bf16 v[120:123], v[48:49], v[40:41], 0
  v_mfma_f32_16x16x16_bf16 v[136:139], v[48:49], v[44:45], 0
  s_waitcnt lgkmcnt(0)
  s_bitcmp1_b32 s43, 11
  s_cbranch_scc1 LI_dead_Xfh2
  s_cmp_lt_u32 s45, 8
  s_cbranch_scc1 LI_tail_Xfh2
  buffer_load_dwordx4 v[224:227], v[16:17], s[12:15], 0 idxen offen sc1
  buffer_load_dwordx4 v[228:231], v[18:19], s[12:15], 0 idxen offen sc1
  buffer_load_dwordx4 v[232:235], v[20:21], s[12:15], 0 idxen offen sc1
  buffer_load_dwordx4 v[236:239], v[22:23], s[12:15], 0 idxen offen sc1
  buffer_load_dwordx4 v[240:243], v[24:25], s[12:15], 0 idxen offen sc1
  buffer_load_dwordx4 v[244:247], v[26:27], s[12:15], 0 idxen offen sc1
  buffer_load_dwordx4 v[248:251], v[28:29], s[12:15], 0 idxen offen sc1
  buffer_load_dwordx4 v[252:255], v[30:31], s[12:15], 0 idxen offen sc1
  s_mov_b32 s48, s43
  s_movk_i32 s51, 8
  s_add_u32 s53, s53, 8
  s_cmp_eq_u32 s45, 8
  s_cbranch_scc1 LI_last_Xfh2
  s_add_u32 s44, s44, 512
  s_add_u32 s78, s78, 64
  s_sub_u32 s45, s45, 8
  s_andn2_b32 s43, s43, 0x100
LI_end_Xfh2:
  v_mfma_f32_16x16x16_bf16 v[92:95], v[52:53], v[32:33], 0
  v_mfma_f32_16x16x16_bf16 v[108:111], v[52:53], v[36:37], 0
  v_mfma_f32_16x16x16_bf16 v[124:127], v[52:53], v[40:41], 0
  v_mfma_f32_16x16x16_bf16 v[140:143], v[52:53], v[44:45], 0
XEPI_2:
  s_mov_b32 s80, 77472
  v_lshl_add_u32 v16, v6, 1, s80
  ds_read_b128 v[32:35], v16 offset:20480
  ds_read_b128 v[36:39], v16 offset:21504
  ds_read_b128 v[40:43], v16 offset:22528
  ds_read_b128 v[44:47], v16 offset:23552
  ds_read_b128 v[56:59], v16 offset:1024
  ds_read_b128 v[64:67], v16 offset:9216
  ds_read_b128 v[60:63], v16 offset:5120
  ds_read_b128 v[68:71], v16 offset:13312
  ds_read_b128 v[72:75], v16 offset:17408
  ds_read_b128 v[76:79], v16 offset:25600
  v_cvt_pk_bf16_f32 v80, v80, v81
  v_cvt_pk_bf16_f32 v81, v82, v83
  v_cvt_pk_bf16_f32 v82, v84, v85
  v_cvt_pk_bf16_f32 v83, v86, v87
  v_cvt_pk_bf16_f32 v96, v96, v97
  v_cvt_pk_bf16_f32 v97, v98, v99
  v_cvt_pk_bf16_f32 v98, v100, v101
  v_cvt_pk_bf16_f32 v99, v102, v103
  v_cvt_pk_bf16_f32 v112, v112, v113
  v_cvt_pk_bf16_f32 v113, v114, v115
  v_cvt_pk_bf16_f32 v114, v116, v117
  v_cvt_pk_bf16_f32 v115, v118, v119
  v_cvt_pk_bf16_f32 v128, v128, v129
  v_cvt_pk_bf16_f32 v129, v130, v131
  v_cvt_pk_bf16_f32 v130, v132, v133
  v_cvt_pk_bf16_f32 v131, v134, v135
  v_cvt_pk_bf16_f32 v88, v88, v89
  v_cvt_pk_bf16_f32 v89, v90, v91
  v_cvt_pk_bf16_f32 v90, v92, v93
  v_cvt_pk_bf16_f32 v91, v94, v95
  v_cvt_pk_bf16_f32 v104, v104, v105
  v_cvt_pk_bf16_f32 v105, v106, v107
  v_cvt_pk_bf16_f32 v106, v108, v109
  v_cvt_pk_bf16_f32 v107, v110, v111
  v_cvt_pk_bf16_f32 v120, v120, v121
  v_cvt_pk_bf16_f32 v121, v122, v123
  v_cvt_pk_bf16_f32 v122, v124, v125
  v_cvt_pk_bf16_f32 v123, v126, v127
  v_cvt_pk_bf16_f32 v136, v136, v137
  v_cvt_pk_bf16_f32 v137, v138, v139
  v_cvt_pk_bf16_f32 v138, v140, v141
  v_cvt_pk_bf16_f32 v139, v142, v143
  s_waitcnt lgkmcnt(0)
  v_mfma_f32_16x16x32_bf16 v[92:95], v[80:83], v[56:59], 0
  v_mul_f32 v144, v32, v144
  v_mul_f32 v148, v36, v148
  v_mfma_f32_16x16x32_bf16 v[108:111], v[96:99], v[64:67], 0
  v_mul_f32 v152, v40, v152
  v_mul_f32 v156, v44, v156
  v_mfma_f32_16x16x32_bf16 v[124:127], v[112:115], v[64:67], 0
  v_fmac_f32 v144, v33, v145
  v_fmac_f32 v148, v37, v149
  v_mfma_f32_16x16x32_bf16 v[140:143], v[128:131], v[64:67], 0
  v_fmac_f32 v152, v41, v153
  v_fmac_f32 v156, v45, v157
  v_mfma_f32_16x16x32_bf16 v[92:95], v[88:91], v[60:63], v[92:95]
  v_fmac_f32 v144, v34, v146
  v_fmac_f32 v148, v38, v150
  v_mfma_f32_16x16x32_bf16 v[108:111], v[104:107], v[68:71], v[108:111]
  v_fmac_f32 v152, v42, v154
  v_fmac_f32 v156, v46, v158
  v_mfma_f32_16x16x32_bf16 v[124:127], v[120:123], v[68:71], v[124:127]
  v_fmac_f32 v144, v35, v147
  v_fmac_f32 v148, v39, v151
  v_mfma_f32_16x16x32_bf16 v[140:143], v[136:139], v[68:71], v[140:143]
  v_fmac_f32 v152, v43, v155
  v_fmac_f32 v156, v47, v159
  ds_read_b128 v[32:35], v16 offset:0
  ds_read_b128 v[40:43], v16 offset:8192
  ds_read_b128 v[36:39], v16 offset:4096
  ds_read_b128 v[44:47], v16 offset:12288
  ds_read_b128 v[48:51], v16 offset:16384
  ds_read_b128 v[52:55], v16 offset:24576
  s_and_b32 s80, s52, 63
  s_lshl_b32 s81, s80, 9
  s_add_u32 s81, s81, 105632
  v_lshl_add_u32 v18, v2, 4, v1
  v_add_u32 v18, s81, v18
  v_mul_f32 v149, v72, v92
  v_fmac_f32 v148, v76, v108
  v_mul_f32 v150, v76, v124
  v_mul_f32 v151, v76, v140
  v_fmac_f32 v149, v73, v93
  v_fmac_f32 v148, v77, v109
  v_fmac_f32 v150, v77, v125
  v_fmac_f32 v151, v77, v141
  s_waitcnt lgkmcnt(0)
  v_mfma_f32_16x16x32_bf16 v[84:87], v[80:83], v[32:35], 0
  v_fmac_f32 v149, v74, v94
  v_mfma_f32_16x16x32_bf16 v[100:103], v[96:99], v[40:43], 0
  v_fmac_f32 v148, v78, v110
  v_mfma_f32_16x16x32_bf16 v[116:119], v[112:115], v[40:43], 0
  v_fmac_f32 v150, v78, v126
  v_mfma_f32_16x16x32_bf16 v[132:135], v[128:131], v[40:43], 0
  v_fmac_f32 v151, v78, v142
  v_mfma_f32_16x16x32_bf16 v[84:87], v[88:91], v[36:39], v[84:87]
  v_fmac_f32 v149, v75, v95
  v_mfma_f32_16x16x32_bf16 v[100:103], v[104:107], v[44:47], v[100:103]
  v_fmac_f32 v148, v79, v111
  v_mfma_f32_16x16x32_bf16 v[116:119], v[120:123], v[44:47], v[116:119]
  v_fmac_f32 v150, v79, v127
  v_mfma_f32_16x16x32_bf16 v[132:135], v[136:139], v[44:47], v[132:135]
  v_fmac_f32 v151, v79, v143
  ds_read_b128 v[56:59], v16 offset:3072
  ds_read_b128 v[64:67], v16 offset:11264
  ds_read_b128 v[60:63], v16 offset:7168
  ds_read_b128 v[68:71], v16 offset:15360
  ds_read_b128 v[72:75], v16 offset:19456
  ds_read_b128 v[76:79], v16 offset:27648
  s_nop 3
  v_mul_f32 v145, v48, v84
  v_fmac_f32 v144, v52, v100
  v_mul_f32 v146, v52, v116
  v_mul_f32 v147, v52, v132
  v_fmac_f32 v145, v49, v85
  v_fmac_f32 v144, v53, v101
  v_fmac_f32 v146, v53, v117
  v_fmac_f32 v147, v53, v133
  s_waitcnt lgkmcnt(0)
  v_mfma_f32_16x16x32_bf16 v[92:95], v[80:83], v[56:59], 0
  v_fmac_f32 v145, v50, v86
  v_mfma_f32_16x16x32_bf16 v[108:111], v[96:99], v[64:67], 0
  v_fmac_f32 v144, v54, v102
  v_mfma_f32_16x16x32_bf16 v[124:127], v[112:115], v[64:67], 0
  v_fmac_f32 v146, v54, v118
  v_mfma_f32_16x16x32_bf16 v[140:143], v[128:131], v[64:67], 0
  v_fmac_f32 v147, v54, v134
  v_mfma_f32_16x16x32_bf16 v[92:95], v[88:91], v[60:63], v[92:95]
  v_fmac_f32 v145, v51, v87
  v_mfma_f32_16x16x32_bf16 v[108:111], v[104:107], v[68:71], v[108:111]
  v_fmac_f32 v144, v55, v103
  v_mfma_f32_16x16x32_bf16 v[124:127], v[120:123], v[68:71], v[124:127]
  v_fmac_f32 v146, v55, v119
  v_mfma_f32_16x16x32_bf16 v[140:143], v[136:139], v[68:71], v[140:143]
  v_fmac_f32 v147, v55, v135
  ds_read_b128 v[32:35], v16 offset:2048
  ds_read_b128 v[40:43], v16 offset:10240
  ds_read_b128 v[36:39], v16 offset:6144
  ds_read_b128 v[44:47], v16 offset:14336
  ds_read_b128 v[48:51], v16 offset:18432
  ds_read_b128 v[52:55], v16 offset:26624
  s_nop 3
  v_mul_f32 v157, v72, v92
  v_fmac_f32 v156, v76, v108
  v_mul_f32 v158, v76, v124
  v_mul_f32 v159, v76, v140
  v_fmac_f32 v157, v73, v93
  v_fmac_f32 v156, v77, v109
  v_fmac_f32 v158, v77, v125
  v_fmac_f32 v159, v77, v141
  s_waitcnt lgkmcnt(0)
  v_mfma_f32_16x16x32_bf16 v[84:87], v[80:83], v[32:35], 0
  v_fmac_f32 v157, v74, v94
  v_mfma_f32_16x16x32_bf16 v[100:103], v[96:99], v[40:43], 0
  v_fmac_f32 v156, v78, v110
  v_mfma_f32_16x16x32_bf16 v[116:119], v[112:115], v[40:43], 0
  v_fmac_f32 v158, v78, v126
  v_mfma_f32_16x16x32_bf16 v[132:135], v[128:131], v[40:43], 0
  v_fmac_f32 v159, v78, v142
  v_mfma_f32_16x16x32_bf16 v[84:87], v[88:91], v[36:39], v[84:87]
  v_fmac_f32 v157, v75, v95
  v_mfma_f32_16x16x32_bf16 v[100:103], v[104:107], v[44:47], v[100:103]
  v_fmac_f32 v156, v79, v111
  v_mfma_f32_16x16x32_bf16 v[116:119], v[120:123], v[44:47], v[116:119]
  v_fmac_f32 v158, v79, v127
  v_mfma_f32_16x16x32_bf16 v[132:135], v[136:139], v[44:47], v[132:135]
  v_fmac_f32 v159, v79, v143
  ds_read_b128 v[60:63], v18
  v_mul_f32 v153, v48, v84
  s_nop 0
  v_fmac_f32 v152, v52, v100
  s_nop 0
  v_mul_f32 v154, v52, v116
  s_nop 0
  v_mul_f32 v155, v52, v132
  v_fmac_f32 v153, v49, v85
  v_fmac_f32 v152, v53, v101
  v_fmac_f32 v154, v53, v117
  v_fmac_f32 v155, v53, v133
  v_fmac_f32 v153, v50, v86
  v_fmac_f32 v152, v54, v102
  v_fmac_f32 v154, v54, v118
  v_fmac_f32 v155, v54, v134
  v_fmac_f32 v153, v51, v87
  v_fmac_f32 v152, v55, v103
  v_fmac_f32 v154, v55, v119
  v_fmac_f32 v155, v55, v135
  v_permlane32_swap_b32 v145, v146
  v_permlane32_swap_b32 v144, v147
  v_permlane32_swap_b32 v149, v150
  v_permlane32_swap_b32 v148, v151
  v_permlane32_swap_b32 v153, v154
  v_permlane32_swap_b32 v152, v155
  v_permlane32_swap_b32 v157, v158
  v_permlane32_swap_b32 v156, v159
  v_add_f32 v145, v145, v146
  v_add_f32 v144, v144, v147
  v_add_f32 v149, v149, v150
  v_add_f32 v148, v148, v151
  v_add_f32 v153, v153, v154
  v_add_f32 v152, v152, v155
  v_add_f32 v157, v157, v158
  v_add_f32 v156, v156, v159
  v_permlane16_swap_b32 v145, v144
  v_permlane16_swap_b32 v149, v148
  v_permlane16_swap_b32 v153, v152
  v_permlane16_swap_b32 v157, v156
  v_add_f32 v145, v145, v144
  v_add_f32 v149, v149, v148
  v_add_f32 v153, v153, v152
  v_add_f32 v157, v157, v156
  s_waitcnt lgkmcnt(0)
  s_cmp_lg_u32 s79, 0
  s_cbranch_scc1 EX_fb_X2
  s_cmp_lt_u32 s53, 12
  s_cbranch_scc1 EX_rw_X2
  s_waitcnt vmcnt(12)
EX_rwd_X2:
  s_mov_b32 exec_lo, 0
  v_add_f32 v145, v145, v60
  v_add_f32 v149, v149, v61
  v_add_f32 v153, v153, v62
  v_add_f32 v157, v157, v63
  s_mov_b64 exec, -1
  v_lshlrev_b32 v32, 16, v14
  v_and_b32 v33, 0xffff0000, v14
  v_lshlrev_b32 v34, 16, v15
  v_and_b32 v35, 0xffff0000, v15
  v_add_f32 v32, v32, v145
  v_add_f32 v33, v33, v149
  v_add_f32 v34, v34, v153
  v_add_f32 v35, v35, v157
  v_cvt_pk_bf16_f32 v36, v32, v33
  v_cvt_pk_bf16_f32 v37, v34, v35
  s_add_u32 s80, s80, s60
  s_lshl_b32 s80, s80, 9
  buffer_store_dwordx2 v[36:37], v6, s[24:27], s80 offen
EX_end_X2:
  s_branch XLOOP_0
LI_dead_Yff0:
  s_movk_i32 s46, 0x800
  s_mov_b32 s49, 0
  s_branch LI_end_Yff0
LI_tail_Yff0:
  s_mov_b32 s49, s45
  s_add_u32 s53, s53, s45
  s_cmp_le_u32 s45, 4
  s_cselect_b32 s81, 0x1000, 0
  s_or_b32 s46, s43, s81
  s_cmp_le_u32 s45, 0
  s_cbranch_scc1 LI_last_Yff0
  buffer_load_dwordx4 v[160:163], v[16:17], s[12:15], 0 idxen offen sc1
  s_cmp_le_u32 s45, 1
  s_cbranch_scc1 LI_last_Yff0
  buffer_load_dwordx4 v[164:167], v[18:19], s[12:15], 0 idxen offen sc1
  s_cmp_le_u32 s45, 2
  s_cbranch_scc1 LI_last_Yff0
  buffer_load_dwordx4 v[168:171], v[20:21], s[12:15], 0 idxen offen sc1
  s_cmp_le_u32 s45, 3
  s_cbranch_scc1 LI_last_Yff0
  buffer_load_dwordx4 v[172:175], v[22:23], s[12:15], 0 idxen offen sc1
  s_cmp_le_u32 s45, 4
  s_cbranch_scc1 LI_last_Yff0
  buffer_load_dwordx4 v[176:179], v[24:25], s[12:15], 0 idxen offen sc1
  s_cmp_le_u32 s45, 5
  s_cbranch_scc1 LI_last_Yff0
  buffer_load_dwordx4 v[180:183], v[26:27], s[12:15], 0 idxen offen sc1
  s_cmp_le_u32 s45, 6
  s_cbranch_scc1 LI_last_Yff0
  buffer_load_dwordx4 v[184:187], v[28:29], s[12:15], 0 idxen offen sc1
LI_last_Yff0:
  s_or_b32 s46, s46, 0x200
NS_top_Yff0:
  s_bitcmp1_b32 s55, 0
  s_cselect_b32 s85, s73, s72
  s_mul_i32 s84, s55, s74
  s_add_u32 s84, s84, s85
  s_add_u32 s55, s55, 1
  s_cmp_ge_u32 s84, s75
  s_cbranch_scc1 NS_end_Yff0
  v_readlane_b32 s85, v8, s84
  s_nop 1
  s_and_b32 s86, s85, 63
  s_or_b32 s43, s56, s86
  s_bfe_u32 s44, s85, 0xc0006
  s_lshl_b32 s44, s44, 4
  s_lshr_b32 s45, s85, 18
  v_readlane_b32 s78, v7, s84
  s_branch LI_end_Yff0
NS_end_Yff0:
  s_cmp_eq_u32 s56, 0x100
  s_cbranch_scc0 NS_dead_Yff0
  s_movk_i32 s56, 0x500
  s_mov_b32 s55, 0
  s_mov_b32 s12, s36
  s_mov_b32 s13, s37
  s_branch NS_top_Yff0
NS_dead_Yff0:
  s_movk_i32 s56, 0x800
  s_movk_i32 s43, 0x800
  s_mov_b32 s45, 0
  s_mov_b32 s44, 0
  s_mov_b32 s78, 0
  s_branch LI_end_Yff0
LI_dead_Yrh0:
  s_movk_i32 s46, 0x800
  s_mov_b32 s49, 0
  s_branch LI_end_Yrh0
LI_tail_Yrh0:
  s_mov_b32 s49, s45
  s_add_u32 s53, s53, s45
  s_cmp_le_u32 s45, 4
  s_cselect_b32 s81, 0x1000, 0
  s_or_b32 s46, s43, s81
  s_cmp_le_u32 s45, 0
  s_cbranch_scc1 LI_last_Yrh0
  buffer_load_dwordx4 v[160:163], v[16:17], s[12:15], 0 idxen offen sc1
  s_cmp_le_u32 s45, 1
  s_cbranch_scc1 LI_last_Yrh0
  buffer_load_dwordx4 v[164:167], v[18:19], s[12:15], 0 idxen offen sc1
  s_cmp_le_u32 s45, 2
  s_cbranch_scc1 LI_last_Yrh0
  buffer_load_dwordx4 v[168:171], v[20:21], s[12:15], 0 idxen offen sc1
  s_cmp_le_u32 s45, 3
  s_cbranch_scc1 LI_last_Yrh0
  buffer_load_dwordx4 v[172:175], v[22:23], s[12:15], 0 idxen offen sc1
  s_cmp_le_u32 s45, 4
  s_cbranch_scc1 LI_last_Yrh0
  buffer_load_dwordx4 v[176:179], v[24:25], s[12:15], 0 idxen offen sc1
  s_cmp_le_u32 s45, 5
  s_cbranch_scc1 LI_last_Yrh0
  buffer_load_dwordx4 v[180:183], v[26:27], s[12:15], 0 idxen offen sc1
  s_cmp_le_u32 s45, 6
  s_cbranch_scc1 LI_last_Yrh0
  buffer_load_dwordx4 v[184:187], v[28:29], s[12:15], 0 idxen offen sc1
LI_last_Yrh0:
  s_or_b32 s46, s46, 0x200
NS_top_Yrh0:
  s_bitcmp1_b32 s55, 0
  s_cselect_b32 s85, s73, s72
  s_mul_i32 s84, s55, s74
  s_add_u32 s84, s84, s85
  s_add_u32 s55, s55, 1
  s_cmp_ge_u32 s84, s75
  s_cbranch_scc1 NS_end_Yrh0
  v_readlane_b32 s85, v8, s84
  s_nop 1
  s_and_b32 s86, s85, 63
  s_or_b32 s43, s56, s86
  s_bfe_u32 s44, s85, 0xc0006
  s_lshl_b32 s44, s44, 4
  s_lshr_b32 s45, s85, 18
  v_readlane_b32 s78, v7, s84
  s_branch LI_end_Yrh0
NS_end_Yrh0:
  s_cmp_eq_u32 s56, 0x100
  s_cbranch_scc0 NS_dead_Yrh0
  s_movk_i32 s56, 0x500
  s_mov_b32 s55, 0
  s_mov_b32 s12, s36
  s_mov_b32 s13, s37
  s_branch NS_top_Yrh0
NS_dead_Yrh0:
  s_movk_i32 s56, 0x800
  s_movk_i32 s43, 0x800
  s_mov_b32 s45, 0
  s_mov_b32 s44, 0
  s_mov_b32 s78, 0
  s_branch LI_end_Yrh0
LI_dead_Yfh0:
  s_movk_i32 s46, 0x800
  s_mov_b32 s49, 0
  s_branch LI_end_Yfh0
LI_tail_Yfh0:
  s_mov_b32 s49, s45
  s_add_u32 s53, s53, s45
  s_cmp_le_u32 s45, 4
  s_cselect_b32 s81, 0x1000, 0
  s_or_b32 s46, s43, s81
  s_cmp_le_u32 s45, 0
  s_cbranch_scc1 LI_last_Yfh0
  buffer_load_dwordx4 v[160:163], v[16:17], s[12:15], 0 idxen offen sc1
  s_cmp_le_u32 s45, 1
  s_cbranch_scc1 LI_last_Yfh0
  buffer_load_dwordx4 v[164:167], v[18:19], s[12:15], 0 idxen offen sc1
  s_cmp_le_u32 s45, 2
  s_cbranch_scc1 LI_last_Yfh0
  buffer_load_dwordx4 v[168:171], v[20:21], s[12:15], 0 idxen offen sc1
  s_cmp_le_u32 s45, 3
  s_cbranch_scc1 LI_last_Yfh0
  buffer_load_dwordx4 v[172:175], v[22:23], s[12:15], 0 idxen offen sc1
  s_cmp_le_u32 s45, 4
  s_cbranch_scc1 LI_last_Yfh0
  buffer_load_dwordx4 v[176:179], v[24:25], s[12:15], 0 idxen offen sc1
  s_cmp_le_u32 s45, 5
  s_cbranch_scc1 LI_last_Yfh0
  buffer_load_dwordx4 v[180:183], v[26:27], s[12:15], 0 idxen offen sc1
  s_cmp_le_u32 s45, 6
  s_cbranch_scc1 LI_last_Yfh0
  buffer_load_dwordx4 v[184:187], v[28:29], s[12:15], 0 idxen offen sc1
LI_last_Yfh0:
  s_or_b32 s46, s46, 0x200
NS_top_Yfh0:
  s_bitcmp1_b32 s55, 0
  s_cselect_b32 s85, s73, s72
  s_mul_i32 s84, s55, s74
  s_add_u32 s84, s84, s85
  s_add_u32 s55, s55, 1
  s_cmp_ge_u32 s84, s75
  s_cbranch_scc1 NS_end_Yfh0
  v_readlane_b32 s85, v8, s84
  s_nop 1
  s_and_b32 s86, s85, 63
  s_or_b32 s43, s56, s86
  s_bfe_u32 s44, s85, 0xc0006
  s_lshl_b32 s44, s44, 4
  s_lshr_b32 s45, s85, 18
  v_readlane_b32 s78, v7, s84
  s_branch LI_end_Yfh0
NS_end_Yfh0:
  s_cmp_eq_u32 s56, 0x100
  s_cbranch_scc0 NS_dead_Yfh0
  s_movk_i32 s56, 0x500
  s_mov_b32 s55, 0
  s_mov_b32 s12, s36
  s_mov_b32 s13, s37
  s_branch NS_top_Yfh0
NS_dead_Yfh0:
  s_movk_i32 s56, 0x800
  s_movk_i32 s43, 0x800
  s_mov_b32 s45, 0
  s_mov_b32 s44, 0
  s_mov_b32 s78, 0
  s_branch LI_end_Yfh0
LI_dead_Yff1:
  s_movk_i32 s47, 0x800
  s_mov_b32 s50, 0
  s_branch LI_end_Yff1
LI_tail_Yff1:
  s_mov_b32 s50, s45
  s_add_u32 s53, s53, s45
  s_cmp_le_u32 s45, 4
  s_cselect_b32 s81, 0x1000, 0
  s_or_b32 s47, s43, s81
  s_cmp_le_u32 s45, 0
  s_cbranch_scc1 LI_last_Yff1
  buffer_load_dwordx4 v[192:195], v[16:17], s[12:15], 0 idxen offen sc1
  s_cmp_le_u32 s45, 1
  s_cbranch_scc1 LI_last_Yff1
  buffer_load_dwordx4 v[196:199], v[18:19], s[12:15], 0 idxen offen sc1
  s_cmp_le_u32 s45, 2
  s_cbranch_scc1 LI_last_Yff1
  buffer_load_dwordx4 v[200:203], v[20:21], s[12:15], 0 idxen offen sc1
  s_cmp_le_u32 s45, 3
  s_cbranch_scc1 LI_last_Yff1
  buffer_load_dwordx4 v[204:207], v[22:23], s[12:15], 0 idxen offen sc1
  s_cmp_le_u32 s45, 4
  s_cbranch_scc1 LI_last_Yff1
  buffer_load_dwordx4 v[208:211], v[24:25], s[12:15], 0 idxen offen sc1
  s_cmp_le_u32 s45, 5
  s_cbranch_scc1 LI_last_Yff1
  buffer_load_dwordx4 v[212:215], v[26:27], s[12:15], 0 idxen offen sc1
  s_cmp_le_u32 s45, 6
  s_cbranch_scc1 LI_last_Yff1
  buffer_load_dwordx4 v[216:219], v[28:29], s[12:15], 0 idxen offen sc1
LI_last_Yff1:
  s_or_b32 s47, s47, 0x200
NS_top_Yff1:
  s_bitcmp1_b32 s55, 0
  s_cselect_b32 s85, s73, s72
  s_mul_i32 s84, s55, s74
  s_add_u32 s84, s84, s85
  s_add_u32 s55, s55, 1
  s_cmp_ge_u32 s84, s75
  s_cbranch_scc1 NS_end_Yff1
  v_readlane_b32 s85, v8, s84
  s_nop 1
  s_and_b32 s86, s85, 63
  s_or_b32 s43, s56, s86
  s_bfe_u32 s44, s85, 0xc0006
  s_lshl_b32 s44, s44, 4
  s_lshr_b32 s45, s85, 18
  v_readlane_b32 s78, v7, s84
  s_branch LI_end_Yff1
NS_end_Yff1:
  s_cmp_eq_u32 s56, 0x100
  s_cbranch_scc0 NS_dead_Yff1
  s_movk_i32 s56, 0x500
  s_mov_b32 s55, 0
  s_mov_b32 s12, s36
  s_mov_b32 s13, s37
  s_branch NS_top_Yff1
NS_dead_Yff1:
  s_movk_i32 s56, 0x800
  s_movk_i32 s43, 0x800
  s_mov_b32 s45, 0
  s_mov_b32 s44, 0
  s_mov_b32 s78, 0
  s_branch LI_end_Yff1
LI_dead_Yrh1:
  s_movk_i32 s47, 0x800
  s_mov_b32 s50, 0
  s_branch LI_end_Yrh1
LI_tail_Yrh1:
  s_mov_b32 s50, s45
  s_add_u32 s53, s53, s45
  s_cmp_le_u32 s45, 4
  s_cselect_b32 s81, 0x1000, 0
  s_or_b32 s47, s43, s81
  s_cmp_le_u32 s45, 0
  s_cbranch_scc1 LI_last_Yrh1
  buffer_load_dwordx4 v[192:195], v[16:17], s[12:15], 0 idxen offen sc1
  s_cmp_le_u32 s45, 1
  s_cbranch_scc1 LI_last_Yrh1
  buffer_load_dwordx4 v[196:199], v[18:19], s[12:15], 0 idxen offen sc1
  s_cmp_le_u32 s45, 2
  s_cbranch_scc1 LI_last_Yrh1
  buffer_load_dwordx4 v[200:203], v[20:21], s[12:15], 0 idxen offen sc1
  s_cmp_le_u32 s45, 3
  s_cbranch_scc1 LI_last_Yrh1
  buffer_load_dwordx4 v[204:207], v[22:23], s[12:15], 0 idxen offen sc1
  s_cmp_le_u32 s45, 4
  s_cbranch_scc1 LI_last_Yrh1
  buffer_load_dwordx4 v[208:211], v[24:25], s[12:15], 0 idxen offen sc1
  s_cmp_le_u32 s45, 5
  s_cbranch_scc1 LI_last_Yrh1
  buffer_load_dwordx4 v[212:215], v[26:27], s[12:15], 0 idxen offen sc1
  s_cmp_le_u32 s45, 6
  s_cbranch_scc1 LI_last_Yrh1
  buffer_load_dwordx4 v[216:219], v[28:29], s[12:15], 0 idxen offen sc1
LI_last_Yrh1:
  s_or_b32 s47, s47, 0x200
NS_top_Yrh1:
  s_bitcmp1_b32 s55, 0
  s_cselect_b32 s85, s73, s72
  s_mul_i32 s84, s55, s74
  s_add_u32 s84, s84, s85
  s_add_u32 s55, s55, 1
  s_cmp_ge_u32 s84, s75
  s_cbranch_scc1 NS_end_Yrh1
  v_readlane_b32 s85, v8, s84
  s_nop 1
  s_and_b32 s86, s85, 63
  s_or_b32 s43, s56, s86
  s_bfe_u32 s44, s85, 0xc0006
  s_lshl_b32 s44, s44, 4
  s_lshr_b32 s45, s85, 18
  v_readlane_b32 s78, v7, s84
  s_branch LI_end_Yrh1
NS_end_Yrh1:
  s_cmp_eq_u32 s56, 0x100
  s_cbranch_scc0 NS_dead_Yrh1
  s_movk_i32 s56, 0x500
  s_mov_b32 s55, 0
  s_mov_b32 s12, s36
  s_mov_b32 s13, s37
  s_branch NS_top_Yrh1
NS_dead_Yrh1:
  s_movk_i32 s56, 0x800
  s_movk_i32 s43, 0x800
  s_mov_b32 s45, 0
  s_mov_b32 s44, 0
  s_mov_b32 s78, 0
  s_branch LI_end_Yrh1
LI_dead_Yfh1:
  s_movk_i32 s47, 0x800
  s_mov_b32 s50, 0
  s_branch LI_end_Yfh1
LI_tail_Yfh1:
  s_mov_b32 s50, s45
  s_add_u32 s53, s53, s45
  s_cmp_le_u32 s45, 4
  s_cselect_b32 s81, 0x1000, 0
  s_or_b32 s47, s43, s81
  s_cmp_le_u32 s45, 0
  s_cbranch_scc1 LI_last_Yfh1
  buffer_load_dwordx4 v[192:195], v[16:17], s[12:15], 0 idxen offen sc1
  s_cmp_le_u32 s45, 1
  s_cbranch_scc1 LI_last_Yfh1
  buffer_load_dwordx4 v[196:199], v[18:19], s[12:15], 0 idxen offen sc1
  s_cmp_le_u32 s45, 2
  s_cbranch_scc1 LI_last_Yfh1
  buffer_load_dwordx4 v[200:203], v[20:21], s[12:15], 0 idxen offen sc1
  s_cmp_le_u32 s45, 3
  s_cbranch_scc1 LI_last_Yfh1
  buffer_load_dwordx4 v[204:207], v[22:23], s[12:15], 0 idxen offen sc1
  s_cmp_le_u32 s45, 4
  s_cbranch_scc1 LI_last_Yfh1
  buffer_load_dwordx4 v[208:211], v[24:25], s[12:15], 0 idxen offen sc1
  s_cmp_le_u32 s45, 5
  s_cbranch_scc1 LI_last_Yfh1
  buffer_load_dwordx4 v[212:215], v[26:27], s[12:15], 0 idxen offen sc1
  s_cmp_le_u32 s45, 6
  s_cbranch_scc1 LI_last_Yfh1
  buffer_load_dwordx4 v[216:219], v[28:29], s[12:15], 0 idxen offen sc1
LI_last_Yfh1:
  s_or_b32 s47, s47, 0x200
NS_top_Yfh1:
  s_bitcmp1_b32 s55, 0
  s_cselect_b32 s85, s73, s72
  s_mul_i32 s84, s55, s74
  s_add_u32 s84, s84, s85
  s_add_u32 s55, s55, 1
  s_cmp_ge_u32 s84, s75
  s_cbranch_scc1 NS_end_Yfh1
  v_readlane_b32 s85, v8, s84
  s_nop 1
  s_and_b32 s86, s85, 63
  s_or_b32 s43, s56, s86
  s_bfe_u32 s44, s85, 0xc0006
  s_lshl_b32 s44, s44, 4
  s_lshr_b32 s45, s85, 18
  v_readlane_b32 s78, v7, s84
  s_branch LI_end_Yfh1
NS_end_Yfh1:
  s_cmp_eq_u32 s56, 0x100
  s_cbranch_scc0 NS_dead_Yfh1
  s_movk_i32 s56, 0x500
  s_mov_b32 s55, 0
  s_mov_b32 s12, s36
  s_mov_b32 s13, s37
  s_branch NS_top_Yfh1
NS_dead_Yfh1:
  s_movk_i32 s56, 0x800
  s_movk_i32 s43, 0x800
  s_mov_b32 s45, 0
  s_mov_b32 s44, 0
  s_mov_b32 s78, 0
  s_branch LI_end_Yfh1
LI_dead_Yff2:
  s_movk_i32 s48, 0x800
  s_mov_b32 s51, 0
  s_branch LI_end_Yff2
LI_tail_Yff2:
  s_mov_b32 s51, s45
  s_add_u32 s53, s53, s45
  s_cmp_le_u32 s45, 4
  s_cselect_b32 s81, 0x1000, 0
  s_or_b32 s48, s43, s81
  s_cmp_le_u32 s45, 0
  s_cbranch_scc1 LI_last_Yff2
  buffer_load_dwordx4 v[224:227], v[16:17], s[12:15], 0 idxen offen sc1
  s_cmp_le_u32 s45, 1
  s_cbranch_scc1 LI_last_Yff2
  buffer_load_dwordx4 v[228:231], v[18:19], s[12:15], 0 idxen offen sc1
  s_cmp_le_u32 s45, 2
  s_cbranch_scc1 LI_last_Yff2
  buffer_load_dwordx4 v[232:235], v[20:21], s[12:15], 0 idxen offen sc1
  s_cmp_le_u32 s45, 3
  s_cbranch_scc1 LI_last_Yff2
  buffer_load_dwordx4 v[236:239], v[22:23], s[12:15], 0 idxen offen sc1
  s_cmp_le_u32 s45, 4
  s_cbranch_scc1 LI_last_Yff2
  buffer_load_dwordx4 v[240:243], v[24:25], s[12:15], 0 idxen offen sc1
  s_cmp_le_u32 s45, 5
  s_cbranch_scc1 LI_last_Yff2
  buffer_load_dwordx4 v[244:247], v[26:27], s[12:15], 0 idxen offen sc1
  s_cmp_le_u32 s45, 6
  s_cbranch_scc1 LI_last_Yff2
  buffer_load_dwordx4 v[248:251], v[28:29], s[12:15], 0 idxen offen sc1
LI_last_Yff2:
  s_or_b32 s48, s48, 0x200
NS_top_Yff2:
  s_bitcmp1_b32 s55, 0
  s_cselect_b32 s85, s73, s72
  s_mul_i32 s84, s55, s74
  s_add_u32 s84, s84, s85
  s_add_u32 s55, s55, 1
  s_cmp_ge_u32 s84, s75
  s_cbranch_scc1 NS_end_Yff2
  v_readlane_b32 s85, v8, s84
  s_nop 1
  s_and_b32 s86, s85, 63
  s_or_b32 s43, s56, s86
  s_bfe_u32 s44, s85, 0xc0006
  s_lshl_b32 s44, s44, 4
  s_lshr_b32 s45, s85, 18
  v_readlane_b32 s78, v7, s84
  s_branch LI_end_Yff2
NS_end_Yff2:
  s_cmp_eq_u32 s56, 0x100
  s_cbranch_scc0 NS_dead_Yff2
  s_movk_i32 s56, 0x500
  s_mov_b32 s55, 0
  s_mov_b32 s12, s36
  s_mov_b32 s13, s37
  s_branch NS_top_Yff2
NS_dead_Yff2:
  s_movk_i32 s56, 0x800
  s_movk_i32 s43, 0x800
  s_mov_b32 s45, 0
  s_mov_b32 s44, 0
  s_mov_b32 s78, 0
  s_branch LI_end_Yff2
LI_dead_Yrh2:
  s_movk_i32 s48, 0x800
  s_mov_b32 s51, 0
  s_branch LI_end_Yrh2
LI_tail_Yrh2:
  s_mov_b32 s51, s45
  s_add_u32 s53, s53, s45
  s_cmp_le_u32 s45, 4
  s_cselect_b32 s81, 0x1000, 0
  s_or_b32 s48, s43, s81
  s_cmp_le_u32 s45, 0
  s_cbranch_scc1 LI_last_Yrh2
  buffer_load_dwordx4 v[224:227], v[16:17], s[12:15], 0 idxen offen sc1
  s_cmp_le_u32 s45, 1
  s_cbranch_scc1 LI_last_Yrh2
  buffer_load_dwordx4 v[228:231], v[18:19], s[12:15], 0 idxen offen sc1
  s_cmp_le_u32 s45, 2
  s_cbranch_scc1 LI_last_Yrh2
  buffer_load_dwordx4 v[232:235], v[20:21], s[12:15], 0 idxen offen sc1
  s_cmp_le_u32 s45, 3
  s_cbranch_scc1 LI_last_Yrh2
  buffer_load_dwordx4 v[236:239], v[22:23], s[12:15], 0 idxen offen sc1
  s_cmp_le_u32 s45, 4
  s_cbranch_scc1 LI_last_Yrh2
  buffer_load_dwordx4 v[240:243], v[24:25], s[12:15], 0 idxen offen sc1
  s_cmp_le_u32 s45, 5
  s_cbranch_scc1 LI_last_Yrh2
  buffer_load_dwordx4 v[244:247], v[26:27], s[12:15], 0 idxen offen sc1
  s_cmp_le_u32 s45, 6
  s_cbranch_scc1 LI_last_Yrh2
  buffer_load_dwordx4 v[248:251], v[28:29], s[12:15], 0 idxen offen sc1
LI_last_Yrh2:
  s_or_b32 s48, s48, 0x200
NS_top_Yrh2:
  s_bitcmp1_b32 s55, 0
  s_cselect_b32 s85, s73, s72
  s_mul_i32 s84, s55, s74
  s_add_u32 s84, s84, s85
  s_add_u32 s55, s55, 1
  s_cmp_ge_u32 s84, s75
  s_cbranch_scc1 NS_end_Yrh2
  v_readlane_b32 s85, v8, s84
  s_nop 1
  s_and_b32 s86, s85, 63
  s_or_b32 s43, s56, s86
  s_bfe_u32 s44, s85, 0xc0006
  s_lshl_b32 s44, s44, 4
  s_lshr_b32 s45, s85, 18
  v_readlane_b32 s78, v7, s84
  s_branch LI_end_Yrh2
NS_end_Yrh2:
  s_cmp_eq_u32 s56, 0x100
  s_cbranch_scc0 NS_dead_Yrh2
  s_movk_i32 s56, 0x500
  s_mov_b32 s55, 0
  s_mov_b32 s12, s36
  s_mov_b32 s13, s37
  s_branch NS_top_Yrh2
NS_dead_Yrh2:
  s_movk_i32 s56, 0x800
  s_movk_i32 s43, 0x800
  s_mov_b32 s45, 0
  s_mov_b32 s44, 0
  s_mov_b32 s78, 0
  s_branch LI_end_Yrh2
LI_dead_Yfh2:
  s_movk_i32 s48, 0x800
  s_mov_b32 s51, 0
  s_branch LI_end_Yfh2
LI_tail_Yfh2:
  s_mov_b32 s51, s45
  s_add_u32 s53, s53, s45
  s_cmp_le_u32 s45, 4
  s_cselect_b32 s81, 0x1000, 0
  s_or_b32 s48, s43, s81
  s_cmp_le_u32 s45, 0
  s_cbranch_scc1 LI_last_Yfh2
  buffer_load_dwordx4 v[224:227], v[16:17], s[12:15], 0 idxen offen sc1
  s_cmp_le_u32 s45, 1
  s_cbranch_scc1 LI_last_Yfh2
  buffer_load_dwordx4 v[228:231], v[18:19], s[12:15], 0 idxen offen sc1
  s_cmp_le_u32 s45, 2
  s_cbranch_scc1 LI_last_Yfh2
  buffer_load_dwordx4 v[232:235], v[20:21], s[12:15], 0 idxen offen sc1
  s_cmp_le_u32 s45, 3
  s_cbranch_scc1 LI_last_Yfh2
  buffer_load_dwordx4 v[236:239], v[22:23], s[12:15], 0 idxen offen sc1
  s_cmp_le_u32 s45, 4
  s_cbranch_scc1 LI_last_Yfh2
  buffer_load_dwordx4 v[240:243], v[24:25], s[12:15], 0 idxen offen sc1
  s_cmp_le_u32 s45, 5
  s_cbranch_scc1 LI_last_Yfh2
  buffer_load_dwordx4 v[244:247], v[26:27], s[12:15], 0 idxen offen sc1
  s_cmp_le_u32 s45, 6
  s_cbranch_scc1 LI_last_Yfh2
  buffer_load_dwordx4 v[248:251], v[28:29], s[12:15], 0 idxen offen sc1
LI_last_Yfh2:
  s_or_b32 s48, s48, 0x200
NS_top_Yfh2:
  s_bitcmp1_b32 s55, 0
  s_cselect_b32 s85, s73, s72
  s_mul_i32 s84, s55, s74
  s_add_u32 s84, s84, s85
  s_add_u32 s55, s55, 1
  s_cmp_ge_u32 s84, s75
  s_cbranch_scc1 NS_end_Yfh2
  v_readlane_b32 s85, v8, s84
  s_nop 1
  s_and_b32 s86, s85, 63
  s_or_b32 s43, s56, s86
  s_bfe_u32 s44, s85, 0xc0006
  s_lshl_b32 s44, s44, 4
  s_lshr_b32 s45, s85, 18
  v_readlane_b32 s78, v7, s84
  s_branch LI_end_Yfh2
NS_end_Yfh2:
  s_cmp_eq_u32 s56, 0x100
  s_cbranch_scc0 NS_dead_Yfh2
  s_movk_i32 s56, 0x500
  s_mov_b32 s55, 0
  s_mov_b32 s12, s36
  s_mov_b32 s13, s37
  s_branch NS_top_Yfh2
NS_dead_Yfh2:
  s_movk_i32 s56, 0x800
  s_movk_i32 s43, 0x800
  s_mov_b32 s45, 0
  s_mov_b32 s44, 0
  s_mov_b32 s78, 0
  s_branch LI_end_Yfh2
LI_dead_Xff0:
  s_movk_i32 s46, 0x800
  s_mov_b32 s49, 0
  s_branch LI_end_Xff0
LI_tail_Xff0:
  s_mov_b32 s49, s45
  s_add_u32 s53, s53, s45
  s_cmp_le_u32 s45, 4
  s_cselect_b32 s81, 0x1000, 0
  s_or_b32 s46, s43, s81
  s_cmp_le_u32 s45, 0
  s_cbranch_scc1 LI_last_Xff0
  buffer_load_dwordx4 v[160:163], v[16:17], s[12:15], 0 idxen offen sc1
  s_cmp_le_u32 s45, 1
  s_cbranch_scc1 LI_last_Xff0
  buffer_load_dwordx4 v[164:167], v[18:19], s[12:15], 0 idxen offen sc1
  s_cmp_le_u32 s45, 2
  s_cbranch_scc1 LI_last_Xff0
  buffer_load_dwordx4 v[168:171], v[20:21], s[12:15], 0 idxen offen sc1
  s_cmp_le_u32 s45, 3
  s_cbranch_scc1 LI_last_Xff0
  buffer_load_dwordx4 v[172:175], v[22:23], s[12:15], 0 idxen offen sc1
  s_cmp_le_u32 s45, 4
  s_cbranch_scc1 LI_last_Xff0
  buffer_load_dwordx4 v[176:179], v[24:25], s[12:15], 0 idxen offen sc1
  s_cmp_le_u32 s45, 5
  s_cbranch_scc1 LI_last_Xff0
  buffer_load_dwordx4 v[180:183], v[26:27], s[12:15], 0 idxen offen sc1
  s_cmp_le_u32 s45, 6
  s_cbranch_scc1 LI_last_Xff0
  buffer_load_dwordx4 v[184:187], v[28:29], s[12:15], 0 idxen offen sc1
LI_last_Xff0:
  s_or_b32 s46, s46, 0x200
NS_top_Xff0:
  s_bitcmp1_b32 s55, 0
  s_cselect_b32 s85, s73, s72
  s_mul_i32 s84, s55, s74
  s_add_u32 s84, s84, s85
  s_add_u32 s55, s55, 1
  s_cmp_ge_u32 s84, s75
  s_cbranch_scc1 NS_end_Xff0
  v_readlane_b32 s85, v8, s84
  s_nop 1
  s_and_b32 s86, s85, 63
  s_or_b32 s43, s56, s86
  s_bfe_u32 s44, s85, 0xc0006
  s_lshl_b32 s44, s44, 4
  s_lshr_b32 s45, s85, 18
  v_readlane_b32 s78, v7, s84
  s_branch LI_end_Xff0
NS_end_Xff0:
  s_cmp_eq_u32 s56, 0x100
  s_cbranch_scc0 NS_dead_Xff0
  s_movk_i32 s56, 0x500
  s_mov_b32 s55, 0
  s_mov_b32 s12, s36
  s_mov_b32 s13, s37
  s_branch NS_top_Xff0
NS_dead_Xff0:
  s_movk_i32 s56, 0x800
  s_movk_i32 s43, 0x800
  s_mov_b32 s45, 0
  s_mov_b32 s44, 0
  s_mov_b32 s78, 0
  s_branch LI_end_Xff0
LI_dead_Xrh0:
  s_movk_i32 s46, 0x800
  s_mov_b32 s49, 0
  s_branch LI_end_Xrh0
LI_tail_Xrh0:
  s_mov_b32 s49, s45
  s_add_u32 s53, s53, s45
  s_cmp_le_u32 s45, 4
  s_cselect_b32 s81, 0x1000, 0
  s_or_b32 s46, s43, s81
  s_cmp_le_u32 s45, 0
  s_cbranch_scc1 LI_last_Xrh0
  buffer_load_dwordx4 v[160:163], v[16:17], s[12:15], 0 idxen offen sc1
  s_cmp_le_u32 s45, 1
  s_cbranch_scc1 LI_last_Xrh0
  buffer_load_dwordx4 v[164:167], v[18:19], s[12:15], 0 idxen offen sc1
  s_cmp_le_u32 s45, 2
  s_cbranch_scc1 LI_last_Xrh0
  buffer_load_dwordx4 v[168:171], v[20:21], s[12:15], 0 idxen offen sc1
  s_cmp_le_u32 s45, 3
  s_cbranch_scc1 LI_last_Xrh0
  buffer_load_dwordx4 v[172:175], v[22:23], s[12:15], 0 idxen offen sc1
  s_cmp_le_u32 s45, 4
  s_cbranch_scc1 LI_last_Xrh0
  buffer_load_dwordx4 v[176:179], v[24:25], s[12:15], 0 idxen offen sc1
  s_cmp_le_u32 s45, 5
  s_cbranch_scc1 LI_last_Xrh0
  buffer_load_dwordx4 v[180:183], v[26:27], s[12:15], 0 idxen offen sc1
  s_cmp_le_u32 s45, 6
  s_cbranch_scc1 LI_last_Xrh0
  buffer_load_dwordx4 v[184:187], v[28:29], s[12:15], 0 idxen offen sc1
LI_last_Xrh0:
  s_or_b32 s46, s46, 0x200
NS_top_Xrh0:
  s_bitcmp1_b32 s55, 0
  s_cselect_b32 s85, s73, s72
  s_mul_i32 s84, s55, s74
  s_add_u32 s84, s84, s85
  s_add_u32 s55, s55, 1
  s_cmp_ge_u32 s84, s75
  s_cbranch_scc1 NS_end_Xrh0
  v_readlane_b32 s85, v8, s84
  s_nop 1
  s_and_b32 s86, s85, 63
  s_or_b32 s43, s56, s86
  s_bfe_u32 s44, s85, 0xc0006
  s_lshl_b32 s44, s44, 4
  s_lshr_b32 s45, s85, 18
  v_readlane_b32 s78, v7, s84
  s_branch LI_end_Xrh0
NS_end_Xrh0:
  s_cmp_eq_u32 s56, 0x100
  s_cbranch_scc0 NS_dead_Xrh0
  s_movk_i32 s56, 0x500
  s_mov_b32 s55, 0
  s_mov_b32 s12, s36
  s_mov_b32 s13, s37
  s_branch NS_top_Xrh0
NS_dead_Xrh0:
  s_movk_i32 s56, 0x800
  s_movk_i32 s43, 0x800
  s_mov_b32 s45, 0
  s_mov_b32 s44, 0
  s_mov_b32 s78, 0
  s_branch LI_end_Xrh0
LI_dead_Xfh0:
  s_movk_i32 s46, 0x800
  s_mov_b32 s49, 0
  s_branch LI_end_Xfh0
LI_tail_Xfh0:
  s_mov_b32 s49, s45
  s_add_u32 s53, s53, s45
  s_cmp_le_u32 s45, 4
  s_cselect_b32 s81, 0x1000, 0
  s_or_b32 s46, s43, s81
  s_cmp_le_u32 s45, 0
  s_cbranch_scc1 LI_last_Xfh0
  buffer_load_dwordx4 v[160:163], v[16:17], s[12:15], 0 idxen offen sc1
  s_cmp_le_u32 s45, 1
  s_cbranch_scc1 LI_last_Xfh0
  buffer_load_dwordx4 v[164:167], v[18:19], s[12:15], 0 idxen offen sc1
  s_cmp_le_u32 s45, 2
  s_cbranch_scc1 LI_last_Xfh0
  buffer_load_dwordx4 v[168:171], v[20:21], s[12:15], 0 idxen offen sc1
  s_cmp_le_u32 s45, 3
  s_cbranch_scc1 LI_last_Xfh0
  buffer_load_dwordx4 v[172:175], v[22:23], s[12:15], 0 idxen offen sc1
  s_cmp_le_u32 s45, 4
  s_cbranch_scc1 LI_last_Xfh0
  buffer_load_dwordx4 v[176:179], v[24:25], s[12:15], 0 idxen offen sc1
  s_cmp_le_u32 s45, 5
  s_cbranch_scc1 LI_last_Xfh0
  buffer_load_dwordx4 v[180:183], v[26:27], s[12:15], 0 idxen offen sc1
  s_cmp_le_u32 s45, 6
  s_cbranch_scc1 LI_last_Xfh0
  buffer_load_dwordx4 v[184:187], v[28:29], s[12:15], 0 idxen offen sc1
LI_last_Xfh0:
  s_or_b32 s46, s46, 0x200
NS_top_Xfh0:
  s_bitcmp1_b32 s55, 0
  s_cselect_b32 s85, s73, s72
  s_mul_i32 s84, s55, s74
  s_add_u32 s84, s84, s85
  s_add_u32 s55, s55, 1
  s_cmp_ge_u32 s84, s75
  s_cbranch_scc1 NS_end_Xfh0
  v_readlane_b32 s85, v8, s84
  s_nop 1
  s_and_b32 s86, s85, 63
  s_or_b32 s43, s56, s86
  s_bfe_u32 s44, s85, 0xc0006
  s_lshl_b32 s44, s44, 4
  s_lshr_b32 s45, s85, 18
  v_readlane_b32 s78, v7, s84
  s_branch LI_end_Xfh0
NS_end_Xfh0:
  s_cmp_eq_u32 s56, 0x100
  s_cbranch_scc0 NS_dead_Xfh0
  s_movk_i32 s56, 0x500
  s_mov_b32 s55, 0
  s_mov_b32 s12, s36
  s_mov_b32 s13, s37
  s_branch NS_top_Xfh0
NS_dead_Xfh0:
  s_movk_i32 s56, 0x800
  s_movk_i32 s43, 0x800
  s_mov_b32 s45, 0
  s_mov_b32 s44, 0
  s_mov_b32 s78, 0
  s_branch LI_end_Xfh0
EX_fb_X0:
  s_mov_b32 exec_lo, 0
  v_add_f32 v145, v145, v60
  v_add_f32 v149, v149, v61
  v_add_f32 v153, v153, v62
  v_add_f32 v157, v157, v63
  s_mov_b64 exec, -1
  s_add_u32 s68, s8, 0xc00000
  s_addc_u32 s69, s9, 0
  s_mov_b32 s70, 0xc35000
  s_mov_b32 s71, 0x20000
  s_add_u32 s80, s80, s60
  s_lshl_b32 s81, s80, 10
  v_lshlrev_b32 v40, 1, v6
  v_add_u32 v40, s81, v40
  s_bitcmp1_b32 s79, 0
  s_cbranch_scc1 EX_fb1_X0
  s_waitcnt vmcnt(0)
  v_lshlrev_b32 v32, 16, v14
  v_and_b32 v33, 0xffff0000, v14
  v_lshlrev_b32 v34, 16, v15
  v_and_b32 v35, 0xffff0000, v15
  s_branch EX_fb2_X0
EX_fb1_X0:
  buffer_load_dwordx4 v[32:35], v40, s[68:71], 0 offen sc0 sc1
  s_waitcnt vmcnt(0)
EX_fb2_X0:
  v_add_f32 v32, v32, v145
  v_add_f32 v33, v33, v149
  v_add_f32 v34, v34, v153
  v_add_f32 v35, v35, v157
  s_bitcmp1_b32 s79, 1
  s_cbranch_scc0 EX_fb3_X0
  buffer_store_dwordx4 v[32:35], v40, s[68:71], 0 offen sc0 sc1
  s_waitcnt vmcnt(0)
  s_branch EX_end_X0
EX_fb3_X0:
  v_cvt_pk_bf16_f32 v36, v32, v33
  v_cvt_pk_bf16_f32 v37, v34, v35
  s_lshl_b32 s80, s80, 9
  buffer_store_dwordx2 v[36:37], v6, s[24:27], s80 offen
  s_branch EX_end_X0
EX_rw_X0:
  s_cmp_lt_u32 s53, 7
  s_cbranch_scc1 EX_rw2_X0
  s_waitcnt vmcnt(7)
  s_branch EX_rwd_X0
EX_rw2_X0:
  s_cmp_lt_u32 s53, 3
  s_cbranch_scc1 EX_rw3_X0
  s_waitcnt vmcnt(3)
  s_branch EX_rwd_X0
EX_rw3_X0:
  s_waitcnt vmcnt(0)
  s_branch EX_rwd_X0
LI_dead_Xff1:
  s_movk_i32 s47, 0x800
  s_mov_b32 s50, 0
  s_branch LI_end_Xff1
LI_tail_Xff1:
  s_mov_b32 s50, s45
  s_add_u32 s53, s53, s45
  s_cmp_le_u32 s45, 4
  s_cselect_b32 s81, 0x1000, 0
  s_or_b32 s47, s43, s81
  s_cmp_le_u32 s45, 0
  s_cbranch_scc1 LI_last_Xff1
  buffer_load_dwordx4 v[192:195], v[16:17], s[12:15], 0 idxen offen sc1
  s_cmp_le_u32 s45, 1
  s_cbranch_scc1 LI_last_Xff1
  buffer_load_dwordx4 v[196:199], v[18:19], s[12:15], 0 idxen offen sc1
  s_cmp_le_u32 s45, 2
  s_cbranch_scc1 LI_last_Xff1
  buffer_load_dwordx4 v[200:203], v[20:21], s[12:15], 0 idxen offen sc1
  s_cmp_le_u32 s45, 3
  s_cbranch_scc1 LI_last_Xff1
  buffer_load_dwordx4 v[204:207], v[22:23], s[12:15], 0 idxen offen sc1
  s_cmp_le_u32 s45, 4
  s_cbranch_scc1 LI_last_Xff1
  buffer_load_dwordx4 v[208:211], v[24:25], s[12:15], 0 idxen offen sc1
  s_cmp_le_u32 s45, 5
  s_cbranch_scc1 LI_last_Xff1
  buffer_load_dwordx4 v[212:215], v[26:27], s[12:15], 0 idxen offen sc1
  s_cmp_le_u32 s45, 6
  s_cbranch_scc1 LI_last_Xff1
  buffer_load_dwordx4 v[216:219], v[28:29], s[12:15], 0 idxen offen sc1
LI_last_Xff1:
  s_or_b32 s47, s47, 0x200
NS_top_Xff1:
  s_bitcmp1_b32 s55, 0
  s_cselect_b32 s85, s73, s72
  s_mul_i32 s84, s55, s74
  s_add_u32 s84, s84, s85
  s_add_u32 s55, s55, 1
  s_cmp_ge_u32 s84, s75
  s_cbranch_scc1 NS_end_Xff1
  v_readlane_b32 s85, v8, s84
  s_nop 1
  s_and_b32 s86, s85, 63
  s_or_b32 s43, s56, s86
  s_bfe_u32 s44, s85, 0xc0006
  s_lshl_b32 s44, s44, 4
  s_lshr_b32 s45, s85, 18
  v_readlane_b32 s78, v7, s84
  s_branch LI_end_Xff1
NS_end_Xff1:
  s_cmp_eq_u32 s56, 0x100
  s_cbranch_scc0 NS_dead_Xff1
  s_movk_i32 s56, 0x500
  s_mov_b32 s55, 0
  s_mov_b32 s12, s36
  s_mov_b32 s13, s37
  s_branch NS_top_Xff1
NS_dead_Xff1:
  s_movk_i32 s56, 0x800
  s_movk_i32 s43, 0x800
  s_mov_b32 s45, 0
  s_mov_b32 s44, 0
  s_mov_b32 s78, 0
  s_branch LI_end_Xff1
LI_dead_Xrh1:
  s_movk_i32 s47, 0x800
  s_mov_b32 s50, 0
  s_branch LI_end_Xrh1
LI_tail_Xrh1:
  s_mov_b32 s50, s45
  s_add_u32 s53, s53, s45
  s_cmp_le_u32 s45, 4
  s_cselect_b32 s81, 0x1000, 0
  s_or_b32 s47, s43, s81
  s_cmp_le_u32 s45, 0
  s_cbranch_scc1 LI_last_Xrh1
  buffer_load_dwordx4 v[192:195], v[16:17], s[12:15], 0 idxen offen sc1
  s_cmp_le_u32 s45, 1
  s_cbranch_scc1 LI_last_Xrh1
  buffer_load_dwordx4 v[196:199], v[18:19], s[12:15], 0 idxen offen sc1
  s_cmp_le_u32 s45, 2
  s_cbranch_scc1 LI_last_Xrh1
  buffer_load_dwordx4 v[200:203], v[20:21], s[12:15], 0 idxen offen sc1
  s_cmp_le_u32 s45, 3
  s_cbranch_scc1 LI_last_Xrh1
  buffer_load_dwordx4 v[204:207], v[22:23], s[12:15], 0 idxen offen sc1
  s_cmp_le_u32 s45, 4
  s_cbranch_scc1 LI_last_Xrh1
  buffer_load_dwordx4 v[208:211], v[24:25], s[12:15], 0 idxen offen sc1
  s_cmp_le_u32 s45, 5
  s_cbranch_scc1 LI_last_Xrh1
  buffer_load_dwordx4 v[212:215], v[26:27], s[12:15], 0 idxen offen sc1
  s_cmp_le_u32 s45, 6
  s_cbranch_scc1 LI_last_Xrh1
  buffer_load_dwordx4 v[216:219], v[28:29], s[12:15], 0 idxen offen sc1
LI_last_Xrh1:
  s_or_b32 s47, s47, 0x200
NS_top_Xrh1:
  s_bitcmp1_b32 s55, 0
  s_cselect_b32 s85, s73, s72
  s_mul_i32 s84, s55, s74
  s_add_u32 s84, s84, s85
  s_add_u32 s55, s55, 1
  s_cmp_ge_u32 s84, s75
  s_cbranch_scc1 NS_end_Xrh1
  v_readlane_b32 s85, v8, s84
  s_nop 1
  s_and_b32 s86, s85, 63
  s_or_b32 s43, s56, s86
  s_bfe_u32 s44, s85, 0xc0006
  s_lshl_b32 s44, s44, 4
  s_lshr_b32 s45, s85, 18
  v_readlane_b32 s78, v7, s84
  s_branch LI_end_Xrh1
NS_end_Xrh1:
  s_cmp_eq_u32 s56, 0x100
  s_cbranch_scc0 NS_dead_Xrh1
  s_movk_i32 s56, 0x500
  s_mov_b32 s55, 0
  s_mov_b32 s12, s36
  s_mov_b32 s13, s37
  s_branch NS_top_Xrh1
NS_dead_Xrh1:
  s_movk_i32 s56, 0x800
  s_movk_i32 s43, 0x800
  s_mov_b32 s45, 0
  s_mov_b32 s44, 0
  s_mov_b32 s78, 0
  s_branch LI_end_Xrh1
LI_dead_Xfh1:
  s_movk_i32 s47, 0x800
  s_mov_b32 s50, 0
  s_branch LI_end_Xfh1
LI_tail_Xfh1:
  s_mov_b32 s50, s45
  s_add_u32 s53, s53, s45
  s_cmp_le_u32 s45, 4
  s_cselect_b32 s81, 0x1000, 0
  s_or_b32 s47, s43, s81
  s_cmp_le_u32 s45, 0
  s_cbranch_scc1 LI_last_Xfh1
  buffer_load_dwordx4 v[192:195], v[16:17], s[12:15], 0 idxen offen sc1
  s_cmp_le_u32 s45, 1
  s_cbranch_scc1 LI_last_Xfh1
  buffer_load_dwordx4 v[196:199], v[18:19], s[12:15], 0 idxen offen sc1
  s_cmp_le_u32 s45, 2
  s_cbranch_scc1 LI_last_Xfh1
  buffer_load_dwordx4 v[200:203], v[20:21], s[12:15], 0 idxen offen sc1
  s_cmp_le_u32 s45, 3
  s_cbranch_scc1 LI_last_Xfh1
  buffer_load_dwordx4 v[204:207], v[22:23], s[12:15], 0 idxen offen sc1
  s_cmp_le_u32 s45, 4
  s_cbranch_scc1 LI_last_Xfh1
  buffer_load_dwordx4 v[208:211], v[24:25], s[12:15], 0 idxen offen sc1
  s_cmp_le_u32 s45, 5
  s_cbranch_scc1 LI_last_Xfh1
  buffer_load_dwordx4 v[212:215], v[26:27], s[12:15], 0 idxen offen sc1
  s_cmp_le_u32 s45, 6
  s_cbranch_scc1 LI_last_Xfh1
  buffer_load_dwordx4 v[216:219], v[28:29], s[12:15], 0 idxen offen sc1
LI_last_Xfh1:
  s_or_b32 s47, s47, 0x200
NS_top_Xfh1:
  s_bitcmp1_b32 s55, 0
  s_cselect_b32 s85, s73, s72
  s_mul_i32 s84, s55, s74
  s_add_u32 s84, s84, s85
  s_add_u32 s55, s55, 1
  s_cmp_ge_u32 s84, s75
  s_cbranch_scc1 NS_end_Xfh1
  v_readlane_b32 s85, v8, s84
  s_nop 1
  s_and_b32 s86, s85, 63
  s_or_b32 s43, s56, s86
  s_bfe_u32 s44, s85, 0xc0006
  s_lshl_b32 s44, s44, 4
  s_lshr_b32 s45, s85, 18
  v_readlane_b32 s78, v7, s84
  s_branch LI_end_Xfh1
NS_end_Xfh1:
  s_cmp_eq_u32 s56, 0x100
  s_cbranch_scc0 NS_dead_Xfh1
  s_movk_i32 s56, 0x500
  s_mov_b32 s55, 0
  s_mov_b32 s12, s36
  s_mov_b32 s13, s37
  s_branch NS_top_Xfh1
NS_dead_Xfh1:
  s_movk_i32 s56, 0x800
  s_movk_i32 s43, 0x800
  s_mov_b32 s45, 0
  s_mov_b32 s44, 0
  s_mov_b32 s78, 0
  s_branch LI_end_Xfh1
EX_fb_X1:
  s_mov_b32 exec_lo, 0
  v_add_f32 v145, v145, v60
  v_add_f32 v149, v149, v61
  v_add_f32 v153, v153, v62
  v_add_f32 v157, v157, v63
  s_mov_b64 exec, -1
  s_add_u32 s68, s8, 0xc00000
  s_addc_u32 s69, s9, 0
  s_mov_b32 s70, 0xc35000
  s_mov_b32 s71, 0x20000
  s_add_u32 s80, s80, s60
  s_lshl_b32 s81, s80, 10
  v_lshlrev_b32 v40, 1, v6
  v_add_u32 v40, s81, v40
  s_bitcmp1_b32 s79, 0
  s_cbranch_scc1 EX_fb1_X1
  s_waitcnt vmcnt(0)
  v_lshlrev_b32 v32, 16, v14
  v_and_b32 v33, 0xffff0000, v14
  v_lshlrev_b32 v34, 16, v15
  v_and_b32 v35, 0xffff0000, v15
  s_branch EX_fb2_X1
EX_fb1_X1:
  buffer_load_dwordx4 v[32:35], v40, s[68:71], 0 offen sc0 sc1
  s_waitcnt vmcnt(0)
EX_fb2_X1:
  v_add_f32 v32, v32, v145
  v_add_f32 v33, v33, v149
  v_add_f32 v34, v34, v153
  v_add_f32 v35, v35, v157
  s_bitcmp1_b32 s79, 1
  s_cbranch_scc0 EX_fb3_X1
  buffer_store_dwordx4 v[32:35], v40, s[68:71], 0 offen sc0 sc1
  s_waitcnt vmcnt(0)
  s_branch EX_end_X1
EX_fb3_X1:
  v_cvt_pk_bf16_f32 v36, v32, v33
  v_cvt_pk_bf16_f32 v37, v34, v35
  s_lshl_b32 s80, s80, 9
  buffer_store_dwordx2 v[36:37], v6, s[24:27], s80 offen
  s_branch EX_end_X1
EX_rw_X1:
  s_cmp_lt_u32 s53, 7
  s_cbranch_scc1 EX_rw2_X1
  s_waitcnt vmcnt(7)
  s_branch EX_rwd_X1
EX_rw2_X1:
  s_cmp_lt_u32 s53, 3
  s_cbranch_scc1 EX_rw3_X1
  s_waitcnt vmcnt(3)
  s_branch EX_rwd_X1
EX_rw3_X1:
  s_waitcnt vmcnt(0)
  s_branch EX_rwd_X1
LI_dead_Xff2:
  s_movk_i32 s48, 0x800
  s_mov_b32 s51, 0
  s_branch LI_end_Xff2
LI_tail_Xff2:
  s_mov_b32 s51, s45
  s_add_u32 s53, s53, s45
  s_cmp_le_u32 s45, 4
  s_cselect_b32 s81, 0x1000, 0
  s_or_b32 s48, s43, s81
  s_cmp_le_u32 s45, 0
  s_cbranch_scc1 LI_last_Xff2
  buffer_load_dwordx4 v[224:227], v[16:17], s[12:15], 0 idxen offen sc1
  s_cmp_le_u32 s45, 1
  s_cbranch_scc1 LI_last_Xff2
  buffer_load_dwordx4 v[228:231], v[18:19], s[12:15], 0 idxen offen sc1
  s_cmp_le_u32 s45, 2
  s_cbranch_scc1 LI_last_Xff2
  buffer_load_dwordx4 v[232:235], v[20:21], s[12:15], 0 idxen offen sc1
  s_cmp_le_u32 s45, 3
  s_cbranch_scc1 LI_last_Xff2
  buffer_load_dwordx4 v[236:239], v[22:23], s[12:15], 0 idxen offen sc1
  s_cmp_le_u32 s45, 4
  s_cbranch_scc1 LI_last_Xff2
  buffer_load_dwordx4 v[240:243], v[24:25], s[12:15], 0 idxen offen sc1
  s_cmp_le_u32 s45, 5
  s_cbranch_scc1 LI_last_Xff2
  buffer_load_dwordx4 v[244:247], v[26:27], s[12:15], 0 idxen offen sc1
  s_cmp_le_u32 s45, 6
  s_cbranch_scc1 LI_last_Xff2
  buffer_load_dwordx4 v[248:251], v[28:29], s[12:15], 0 idxen offen sc1
LI_last_Xff2:
  s_or_b32 s48, s48, 0x200
NS_top_Xff2:
  s_bitcmp1_b32 s55, 0
  s_cselect_b32 s85, s73, s72
  s_mul_i32 s84, s55, s74
  s_add_u32 s84, s84, s85
  s_add_u32 s55, s55, 1
  s_cmp_ge_u32 s84, s75
  s_cbranch_scc1 NS_end_Xff2
  v_readlane_b32 s85, v8, s84
  s_nop 1
  s_and_b32 s86, s85, 63
  s_or_b32 s43, s56, s86
  s_bfe_u32 s44, s85, 0xc0006
  s_lshl_b32 s44, s44, 4
  s_lshr_b32 s45, s85, 18
  v_readlane_b32 s78, v7, s84
  s_branch LI_end_Xff2
NS_end_Xff2:
  s_cmp_eq_u32 s56, 0x100
  s_cbranch_scc0 NS_dead_Xff2
  s_movk_i32 s56, 0x500
  s_mov_b32 s55, 0
  s_mov_b32 s12, s36
  s_mov_b32 s13, s37
  s_branch NS_top_Xff2
NS_dead_Xff2:
  s_movk_i32 s56, 0x800
  s_movk_i32 s43, 0x800
  s_mov_b32 s45, 0
  s_mov_b32 s44, 0
  s_mov_b32 s78, 0
  s_branch LI_end_Xff2
LI_dead_Xrh2:
  s_movk_i32 s48, 0x800
  s_mov_b32 s51, 0
  s_branch LI_end_Xrh2
LI_tail_Xrh2:
  s_mov_b32 s51, s45
  s_add_u32 s53, s53, s45
  s_cmp_le_u32 s45, 4
  s_cselect_b32 s81, 0x1000, 0
  s_or_b32 s48, s43, s81
  s_cmp_le_u32 s45, 0
  s_cbranch_scc1 LI_last_Xrh2
  buffer_load_dwordx4 v[224:227], v[16:17], s[12:15], 0 idxen offen sc1
  s_cmp_le_u32 s45, 1
  s_cbranch_scc1 LI_last_Xrh2
  buffer_load_dwordx4 v[228:231], v[18:19], s[12:15], 0 idxen offen sc1
  s_cmp_le_u32 s45, 2
  s_cbranch_scc1 LI_last_Xrh2
  buffer_load_dwordx4 v[232:235], v[20:21], s[12:15], 0 idxen offen sc1
  s_cmp_le_u32 s45, 3
  s_cbranch_scc1 LI_last_Xrh2
  buffer_load_dwordx4 v[236:239], v[22:23], s[12:15], 0 idxen offen sc1
  s_cmp_le_u32 s45, 4
  s_cbranch_scc1 LI_last_Xrh2
  buffer_load_dwordx4 v[240:243], v[24:25], s[12:15], 0 idxen offen sc1
  s_cmp_le_u32 s45, 5
  s_cbranch_scc1 LI_last_Xrh2
  buffer_load_dwordx4 v[244:247], v[26:27], s[12:15], 0 idxen offen sc1
  s_cmp_le_u32 s45, 6
  s_cbranch_scc1 LI_last_Xrh2
  buffer_load_dwordx4 v[248:251], v[28:29], s[12:15], 0 idxen offen sc1
LI_last_Xrh2:
  s_or_b32 s48, s48, 0x200
NS_top_Xrh2:
  s_bitcmp1_b32 s55, 0
  s_cselect_b32 s85, s73, s72
  s_mul_i32 s84, s55, s74
  s_add_u32 s84, s84, s85
  s_add_u32 s55, s55, 1
  s_cmp_ge_u32 s84, s75
  s_cbranch_scc1 NS_end_Xrh2
  v_readlane_b32 s85, v8, s84
  s_nop 1
  s_and_b32 s86, s85, 63
  s_or_b32 s43, s56, s86
  s_bfe_u32 s44, s85, 0xc0006
  s_lshl_b32 s44, s44, 4
  s_lshr_b32 s45, s85, 18
  v_readlane_b32 s78, v7, s84
  s_branch LI_end_Xrh2
NS_end_Xrh2:
  s_cmp_eq_u32 s56, 0x100
  s_cbranch_scc0 NS_dead_Xrh2
  s_movk_i32 s56, 0x500
  s_mov_b32 s55, 0
  s_mov_b32 s12, s36
  s_mov_b32 s13, s37
  s_branch NS_top_Xrh2
NS_dead_Xrh2:
  s_movk_i32 s56, 0x800
  s_movk_i32 s43, 0x800
  s_mov_b32 s45, 0
  s_mov_b32 s44, 0
  s_mov_b32 s78, 0
  s_branch LI_end_Xrh2
LI_dead_Xfh2:
  s_movk_i32 s48, 0x800
  s_mov_b32 s51, 0
  s_branch LI_end_Xfh2
LI_tail_Xfh2:
  s_mov_b32 s51, s45
  s_add_u32 s53, s53, s45
  s_cmp_le_u32 s45, 4
  s_cselect_b32 s81, 0x1000, 0
  s_or_b32 s48, s43, s81
  s_cmp_le_u32 s45, 0
  s_cbranch_scc1 LI_last_Xfh2
  buffer_load_dwordx4 v[224:227], v[16:17], s[12:15], 0 idxen offen sc1
  s_cmp_le_u32 s45, 1
  s_cbranch_scc1 LI_last_Xfh2
  buffer_load_dwordx4 v[228:231], v[18:19], s[12:15], 0 idxen offen sc1
  s_cmp_le_u32 s45, 2
  s_cbranch_scc1 LI_last_Xfh2
  buffer_load_dwordx4 v[232:235], v[20:21], s[12:15], 0 idxen offen sc1
  s_cmp_le_u32 s45, 3
  s_cbranch_scc1 LI_last_Xfh2
  buffer_load_dwordx4 v[236:239], v[22:23], s[12:15], 0 idxen offen sc1
  s_cmp_le_u32 s45, 4
  s_cbranch_scc1 LI_last_Xfh2
  buffer_load_dwordx4 v[240:243], v[24:25], s[12:15], 0 idxen offen sc1
  s_cmp_le_u32 s45, 5
  s_cbranch_scc1 LI_last_Xfh2
  buffer_load_dwordx4 v[244:247], v[26:27], s[12:15], 0 idxen offen sc1
  s_cmp_le_u32 s45, 6
  s_cbranch_scc1 LI_last_Xfh2
  buffer_load_dwordx4 v[248:251], v[28:29], s[12:15], 0 idxen offen sc1
LI_last_Xfh2:
  s_or_b32 s48, s48, 0x200
NS_top_Xfh2:
  s_bitcmp1_b32 s55, 0
  s_cselect_b32 s85, s73, s72
  s_mul_i32 s84, s55, s74
  s_add_u32 s84, s84, s85
  s_add_u32 s55, s55, 1
  s_cmp_ge_u32 s84, s75
  s_cbranch_scc1 NS_end_Xfh2
  v_readlane_b32 s85, v8, s84
  s_nop 1
  s_and_b32 s86, s85, 63
  s_or_b32 s43, s56, s86
  s_bfe_u32 s44, s85, 0xc0006
  s_lshl_b32 s44, s44, 4
  s_lshr_b32 s45, s85, 18
  v_readlane_b32 s78, v7, s84
  s_branch LI_end_Xfh2
NS_end_Xfh2:
  s_cmp_eq_u32 s56, 0x100
  s_cbranch_scc0 NS_dead_Xfh2
  s_movk_i32 s56, 0x500
  s_mov_b32 s55, 0
  s_mov_b32 s12, s36
  s_mov_b32 s13, s37
  s_branch NS_top_Xfh2
NS_dead_Xfh2:
  s_movk_i32 s56, 0x800
  s_movk_i32 s43, 0x800
  s_mov_b32 s45, 0
  s_mov_b32 s44, 0
  s_mov_b32 s78, 0
  s_branch LI_end_Xfh2
EX_fb_X2:
  s_mov_b32 exec_lo, 0
  v_add_f32 v145, v145, v60
  v_add_f32 v149, v149, v61
  v_add_f32 v153, v153, v62
  v_add_f32 v157, v157, v63
  s_mov_b64 exec, -1
  s_add_u32 s68, s8, 0xc00000
  s_addc_u32 s69, s9, 0
  s_mov_b32 s70, 0xc35000
  s_mov_b32 s71, 0x20000
  s_add_u32 s80, s80, s60
  s_lshl_b32 s81, s80, 10
  v_lshlrev_b32 v40, 1, v6
  v_add_u32 v40, s81, v40
  s_bitcmp1_b32 s79, 0
  s_cbranch_scc1 EX_fb1_X2
  s_waitcnt vmcnt(0)
  v_lshlrev_b32 v32, 16, v14
  v_and_b32 v33, 0xffff0000, v14
  v_lshlrev_b32 v34, 16, v15
  v_and_b32 v35, 0xffff0000, v15
  s_branch EX_fb2_X2
EX_fb1_X2:
  buffer_load_dwordx4 v[32:35], v40, s[68:71], 0 offen sc0 sc1
  s_waitcnt vmcnt(0)
EX_fb2_X2:
  v_add_f32 v32, v32, v145
  v_add_f32 v33, v33, v149
  v_add_f32 v34, v34, v153
  v_add_f32 v35, v35, v157
  s_bitcmp1_b32 s79, 1
  s_cbranch_scc0 EX_fb3_X2
  buffer_store_dwordx4 v[32:35], v40, s[68:71], 0 offen sc0 sc1
  s_waitcnt vmcnt(0)
  s_branch EX_end_X2
EX_fb3_X2:
  v_cvt_pk_bf16_f32 v36, v32, v33
  v_cvt_pk_bf16_f32 v37, v34, v35
  s_lshl_b32 s80, s80, 9
  buffer_store_dwordx2 v[36:37], v6, s[24:27], s80 offen
  s_branch EX_end_X2
EX_rw_X2:
  s_cmp_lt_u32 s53, 7
  s_cbranch_scc1 EX_rw2_X2
  s_waitcnt vmcnt(7)
  s_branch EX_rwd_X2
EX_rw2_X2:
  s_cmp_lt_u32 s53, 3
  s_cbranch_scc1 EX_rw3_X2
  s_waitcnt vmcnt(3)
  s_branch EX_rwd_X2
EX_rw3_X2:
  s_waitcnt vmcnt(0)
  s_branch EX_rwd_X2
CODE_END:
  s_endpgm
.section .rodata,"a"
.p2align 6
.amdhsa_kernel gather_scatter__molecular_angular_painn__graph_kernel
  .amdhsa_next_free_vgpr 256
  .amdhsa_next_free_sgpr 102
  .amdhsa_accum_offset 256
  .amdhsa_group_segment_fixed_size 0
  .amdhsa_kernarg_size 88
  .amdhsa_user_sgpr_count 2
  .amdhsa_user_sgpr_kernarg_segment_ptr 1
  .amdhsa_system_sgpr_workgroup_id_x 1
.end_amdhsa_kernel
```
